```python
import torch

def _softmax(x, axis=-1):
    return torch.softmax(x, dim=axis)
def _gelu(x):
    return torch.nn.functional.gelu(x, approximate="tanh")
def _silu(x):
    return torch.nn.functional.silu(x)
def _sigmoid(x):
    return torch.sigmoid(x)
def _layernorm(x, axis=-1, eps=1e-5):
    m = x.mean(dim=axis, keepdim=True)
    v = x.var(dim=axis, keepdim=True, unbiased=False)
    return (x - m) / torch.sqrt(v + eps)
def _scatter_add(tgt, idx, src, axis=0):
    return tgt.clone().index_add_(axis, idx, src)
def _segment_sum(src, seg, n):
    out = torch.zeros((n,) + src.shape[1:], dtype=src.dtype)
    return out.index_add_(0, seg, src)
def _pad(x, pw):
    flat = tuple(v for pair in reversed(pw) for v in pair)
    return torch.nn.functional.pad(x, flat)

kernel_name = 'parallel_sum__sliding_local_dilated__glu_gated_swiglu__prompt'

def setup_inputs():

    _w = (lambda a: (lambda t: t.to(torch.bfloat16) if t.is_floating_point() else t)(torch.as_tensor(a)))
    def _A_setup():
        B, S, D = 1, 2048, 576
        return {
            "x": _w((lambda *s: torch.randn(*s, dtype=torch.bfloat16) * 0.05)(B, S, D)),
            "wqkv": _w((lambda *s: torch.randn(*s, dtype=torch.bfloat16) * 0.05)(D, 3 * D)),
            "wo": _w((lambda *s: torch.randn(*s, dtype=torch.bfloat16) * 0.05)(D, D)),
        }
    _A_in = _A_setup()

    def _B_setup():
        B, S, D, F = 1, 2048, 576, 4608
        return {
            "x": _w((lambda *s: torch.randn(*s, dtype=torch.bfloat16) * 0.05)(B, S, D)),
            "w1": _w((lambda *s: torch.randn(*s, dtype=torch.bfloat16) * 0.8)(D, F) * (2.0 / D) ** 0.5),
            "w3": _w((lambda *s: torch.randn(*s, dtype=torch.bfloat16) * 0.8)(D, F) * (2.0 / D) ** 0.5),
            "w2": _w((lambda *s: torch.randn(*s, dtype=torch.bfloat16) * 0.8)(F, D) * (2.0 / F) ** 0.5),
        }
    _B_in = _B_setup()

    return {
        "A_x": _A_in["x"],
        "A_wqkv": _A_in["wqkv"],
        "A_wo": _A_in["wo"],
        "B_x": _B_in["x"],
        "B_w1": _B_in["w1"],
        "B_w3": _B_in["w3"],
        "B_w2": _B_in["w2"],
    }

def reference(A_x, A_wqkv, A_wo, B_x, B_w1, B_w3, B_w2):
    def _A_ref(x, wqkv, wo):
        B, S, D = x.shape
        H = 32; Dh = D // H
        W, dil = 8, 2
        qkv = (lambda x, *d: x.permute(*d))((x @ wqkv).reshape(B, S, 3, H, Dh), 2, 0, 3, 1, 4)
        q, k, v = qkv[0], qkv[1], qkv[2]
        scale = Dh ** -0.5
        pos = torch.arange(S)
        off = torch.arange(W) * dil
        idx = pos[:, None] - off[None, :]
        mask = idx >= 0
        idx_c = torch.where(mask, idx, 0).reshape(-1)
        kg = k[:, :, idx_c, :].reshape(B, H, S, W, Dh)
        vg = v[:, :, idx_c, :].reshape(B, H, S, W, Dh)
        logits = torch.einsum("bhsd,bhswd->bhsw", q, kg) * scale
        logits = torch.where(mask[None, None, :, :], logits, -1e9)
        attn = _softmax(logits, axis=-1)
        o = torch.einsum("bhsw,bhswd->bhsd", attn, vg)
        return (lambda x, *d: x.permute(*d))(o, 0, 2, 1, 3).reshape(B, S, D) @ wo

    def _B_ref(x, w1, w3, w2):
        gate = torch.einsum("bsd,df->bsf", x, w1)
        up = torch.einsum("bsd,df->bsf", x, w3)
        h = _silu(gate) * up
        out = torch.einsum("bsf,fd->bsd", h, w2)
        return out

    x = A_x
    xn = _layernorm(x, axis=-1)
    return x + _A_ref(xn, A_wqkv, A_wo) + _B_ref(xn, B_w1, B_w3, B_w2)
```

```asm
; @launch grid=(256,1,1) block=(256,1,1) lds=163840
.amdgcn_target "amdgcn-amd-amdhsa--gfx950"
.text
.globl parallel_sum__sliding_local_dilated__glu_gated_swiglu__prompt_kernel
.p2align 8
.type parallel_sum__sliding_local_dilated__glu_gated_swiglu__prompt_kernel,@function
parallel_sum__sliding_local_dilated__glu_gated_swiglu__prompt_kernel:
    s_cmp_ge_u32 s2, 256
    s_cbranch_scc1 LF_end
    s_load_dwordx2 s[36:37], s[0:1], 0
    s_load_dwordx2 s[42:43], s[0:1], 72
    s_load_dwordx2 s[48:49], s[0:1], 8
    s_load_dwordx2 s[12:13], s[0:1], 32
    s_load_dwordx2 s[96:97], s[0:1], 40
    s_load_dwordx2 s[52:53], s[0:1], 56
    s_load_dwordx2 s[82:83], s[0:1], 16
    s_load_dwordx2 s[84:85], s[0:1], 48
    v_lshrrev_b32 v15, 6, v0
    v_and_b32 v14, 63, v0
    v_readfirstlane_b32 s16, v15
    v_lshlrev_b32 v5, 4, v14
    s_mov_b32 s38, 2359296
    s_mov_b32 s39, 0x00020000
    v_and_b32 v12, 7, v14
    v_lshrrev_b32 v13, 3, v14
    v_mul_u32_u24 v11, 1152, v12
    v_lshl_add_u32 v11, v13, 4, v11
    s_mul_i32 s31, s2, 9216
    s_mul_i32 s30, s16, 640
    s_sub_u32 s30, s31, s30
    s_add_u32 s30, s30, 640
    s_lshl_b32 s40, s16, 9
    s_add_u32 s31, s31, s40
    s_cmp_ge_u32 s16, 2
    s_cbranch_scc1 LM_nox
    s_waitcnt lgkmcnt(0)
    buffer_load_dwordx4 v[160:163], v11, s[36:39], s31 offen offset:0
    buffer_load_dwordx4 v[164:167], v11, s[36:39], s31 offen offset:128
    buffer_load_dwordx4 v[168:171], v11, s[36:39], s31 offen offset:256
    buffer_load_dwordx4 v[172:175], v11, s[36:39], s31 offen offset:384
    buffer_load_dwordx4 v[176:179], v11, s[36:39], s31 offen offset:512
    buffer_load_dwordx4 v[180:183], v11, s[36:39], s30 offen offset:0
    buffer_load_dwordx4 v[184:187], v11, s[36:39], s30 offen offset:128
    buffer_load_dwordx4 v[188:191], v11, s[36:39], s30 offen offset:256
    buffer_load_dwordx4 v[192:195], v11, s[36:39], s30 offen offset:384
LM_nox:
    s_getpc_b64 s[32:33]
LM_pc0:
    s_mov_b32 s34, LM_join-LM_pc0
    s_mov_b32 s35, 0x00020000
    v_lshlrev_b32 v7, 3, v5
    s_cmp_lg_u32 s16, 3
    s_cbranch_scc1 LM_nopf0
    buffer_load_dword v61, v7, s[32:35], 0 offen
LM_nopf0:
    s_and_b32 s17, s2, 7
    s_lshl_b32 s17, s17, 2
    s_bfe_u32 s26, s2, 0x20003
    s_add_u32 s17, s17, s26
    s_lshr_b32 s18, s2, 5
    s_mov_b32 s56, s18
    s_lshl_b32 s19, s16, 10
    s_lshl_b32 s26, s17, 8
    s_lshl_b32 s30, s16, 3
    v_add_u32 v6, s30, v13
    v_mul_u32_u24 v6, 9216, v6
    v_and_b32 v7, 2, v13
    s_and_b32 s30, s16, 1
    s_lshl_b32 s30, s30, 2
    v_or_b32 v7, s30, v7
    v_xor_b32 v7, v7, v12
    v_lshl_add_u32 v6, v7, 4, v6
    s_mov_b32 s10, 268435456
    s_mov_b32 s11, 0x00020000
    s_mov_b32 s14, 5308416
    s_mov_b32 s15, 0x00020000
    s_mov_b32 s98, 5308416
    s_mov_b32 s99, 0x00020000
    s_add_u32 s57, s56, 1
    s_cmp_eq_u32 s57, 9
    s_cselect_b32 s57, 0, s57
    s_add_u32 s58, s57, 1
    s_cmp_eq_u32 s58, 9
    s_cselect_b32 s58, 0, s58
    s_add_u32 s59, s58, 1
    s_cmp_eq_u32 s59, 9
    s_cselect_b32 s59, 0, s59
    s_waitcnt lgkmcnt(0)
    s_mov_b32 s8, s42
    s_mov_b32 s9, s43
    s_add_u32 s42, s42, 55676928
    s_addc_u32 s43, s43, 0
    s_load_dwordx2 s[44:45], s[42:43], 0
    s_mov_b32 s92, 1073741824
    s_mul_i32 s41, s16, 12288
    s_add_u32 s41, s41, 36864
    s_cmp_ge_u32 s16, 2
    s_cbranch_scc1 LM_notln
    v_mov_b32 v7, v12
    s_lshr_b32 s30, s2, 3
    s_mul_i32 s30, s30, 73728
    s_bfe_u32 s31, s2, 0x20001
    s_lshl_b32 s31, s31, 10
    s_add_u32 s30, s30, s31
    s_and_b32 s31, s2, 1
    s_lshl_b32 s31, s31, 7
    s_add_u32 s30, s30, s31
    s_lshl_b32 s31, s16, 15
    s_add_u32 s30, s30, s31
    v_lshrrev_b32 v60, 2, v13
    v_lshlrev_b32 v60, 12, v60
    v_and_b32 v8, 3, v13
    v_lshl_add_u32 v60, v8, 8, v60
    v_lshl_add_u32 v60, v7, 4, v60
    s_mov_b32 s40, 0xffff0000
    s_lshl_b32 s31, s2, 1
    s_add_u32 s31, s31, s16
    s_lshl_b32 s31, s31, 6
    s_add_u32 s31, s31, 55541760
    s_lshr_b32 s86, s2, 4
    s_mul_i32 s86, s86, 147456
    s_bfe_u32 s87, s2, 0x20002
    s_mul_i32 s87, s87, 2304
    s_add_u32 s86, s86, s87
    s_and_b32 s87, s2, 1
    s_lshl_b32 s87, s87, 7
    s_add_u32 s86, s86, s87
    s_add_u32 s86, s86, 53051392
    s_lshl_b32 s87, s16, 30
    s_add_u32 s86, s86, s87
    s_bfe_u32 s87, s2, 0x10001
    s_lshl_b32 s88, s87, 10
    s_add_u32 s88, s88, s86
    s_mul_i32 s89, s87, 18432
    s_add_u32 s89, s89, 4294821888
    s_add_u32 s89, s89, s86
    s_mov_b32 s90, 238609295
    s_mov_b32 s91, 36864
    v_add_u32 v8, 0, v13
    v_mul_hi_u32 v9, v8, s90
    v_mul_u32_u24 v10, 18, v9
    v_sub_u32 v8, v8, v10
    v_mul_lo_u32 v9, v9, s91
    v_lshl_add_u32 v9, v7, 4, v9
    v_lshrrev_b32 v10, 2, v8
    v_mul_u32_u24 v10, 9216, v10
    v_and_b32 v11, 3, v8
    v_lshl_add_u32 v10, v11, 8, v10
    v_add_u32 v10, s88, v10
    v_cmp_lt_u32 vcc, 15, v8
    v_mul_u32_u24 v11, 9216, v8
    v_add_u32 v11, s89, v11
    v_cndmask_b32 v10, v10, v11, vcc
    v_add_u32 v196, v9, v10
    v_add_u32 v8, 8, v13
    v_mul_hi_u32 v9, v8, s90
    v_mul_u32_u24 v10, 18, v9
    v_sub_u32 v8, v8, v10
    v_mul_lo_u32 v9, v9, s91
    v_lshl_add_u32 v9, v7, 4, v9
    v_lshrrev_b32 v10, 2, v8
    v_mul_u32_u24 v10, 9216, v10
    v_and_b32 v11, 3, v8
    v_lshl_add_u32 v10, v11, 8, v10
    v_add_u32 v10, s88, v10
    v_cmp_lt_u32 vcc, 15, v8
    v_mul_u32_u24 v11, 9216, v8
    v_add_u32 v11, s89, v11
    v_cndmask_b32 v10, v10, v11, vcc
    v_add_u32 v197, v9, v10
    v_add_u32 v8, 16, v13
    v_mul_hi_u32 v9, v8, s90
    v_mul_u32_u24 v10, 18, v9
    v_sub_u32 v8, v8, v10
    v_mul_lo_u32 v9, v9, s91
    v_lshl_add_u32 v9, v7, 4, v9
    v_lshrrev_b32 v10, 2, v8
    v_mul_u32_u24 v10, 9216, v10
    v_and_b32 v11, 3, v8
    v_lshl_add_u32 v10, v11, 8, v10
    v_add_u32 v10, s88, v10
    v_cmp_lt_u32 vcc, 15, v8
    v_mul_u32_u24 v11, 9216, v8
    v_add_u32 v11, s89, v11
    v_cndmask_b32 v10, v10, v11, vcc
    v_add_u32 v198, v9, v10
    v_add_u32 v8, 24, v13
    v_mul_hi_u32 v9, v8, s90
    v_mul_u32_u24 v10, 18, v9
    v_sub_u32 v8, v8, v10
    v_mul_lo_u32 v9, v9, s91
    v_lshl_add_u32 v9, v7, 4, v9
    v_lshrrev_b32 v10, 2, v8
    v_mul_u32_u24 v10, 9216, v10
    v_and_b32 v11, 3, v8
    v_lshl_add_u32 v10, v11, 8, v10
    v_add_u32 v10, s88, v10
    v_cmp_lt_u32 vcc, 15, v8
    v_mul_u32_u24 v11, 9216, v8
    v_add_u32 v11, s89, v11
    v_cndmask_b32 v10, v10, v11, vcc
    v_add_u32 v199, v9, v10
    v_add_u32 v8, 32, v13
    v_mul_hi_u32 v9, v8, s90
    v_mul_u32_u24 v10, 18, v9
    v_sub_u32 v8, v8, v10
    v_mul_lo_u32 v9, v9, s91
    v_lshl_add_u32 v9, v7, 4, v9
    v_lshrrev_b32 v10, 2, v8
    v_mul_u32_u24 v10, 9216, v10
    v_and_b32 v11, 3, v8
    v_lshl_add_u32 v10, v11, 8, v10
    v_add_u32 v10, s88, v10
    v_cmp_lt_u32 vcc, 15, v8
    v_mul_u32_u24 v11, 9216, v8
    v_add_u32 v11, s89, v11
    v_cndmask_b32 v10, v10, v11, vcc
    v_add_u32 v200, v9, v10
    v_add_u32 v8, 40, v13
    v_mul_hi_u32 v9, v8, s90
    v_mul_u32_u24 v10, 18, v9
    v_sub_u32 v8, v8, v10
    v_mul_lo_u32 v9, v9, s91
    v_lshl_add_u32 v9, v7, 4, v9
    v_lshrrev_b32 v10, 2, v8
    v_mul_u32_u24 v10, 9216, v10
    v_and_b32 v11, 3, v8
    v_lshl_add_u32 v10, v11, 8, v10
    v_add_u32 v10, s88, v10
    v_cmp_lt_u32 vcc, 15, v8
    v_mul_u32_u24 v11, 9216, v8
    v_add_u32 v11, s89, v11
    v_cndmask_b32 v10, v10, v11, vcc
    v_add_u32 v201, v9, v10
    v_add_u32 v8, 48, v13
    v_mul_hi_u32 v9, v8, s90
    v_mul_u32_u24 v10, 18, v9
    v_sub_u32 v8, v8, v10
    v_mul_lo_u32 v9, v9, s91
    v_lshl_add_u32 v9, v7, 4, v9
    v_lshrrev_b32 v10, 2, v8
    v_mul_u32_u24 v10, 9216, v10
    v_and_b32 v11, 3, v8
    v_lshl_add_u32 v10, v11, 8, v10
    v_add_u32 v10, s88, v10
    v_cmp_lt_u32 vcc, 15, v8
    v_mul_u32_u24 v11, 9216, v8
    v_add_u32 v11, s89, v11
    v_cndmask_b32 v10, v10, v11, vcc
    v_add_u32 v202, v9, v10
    v_add_u32 v8, 56, v13
    v_mul_hi_u32 v9, v8, s90
    v_mul_u32_u24 v10, 18, v9
    v_sub_u32 v8, v8, v10
    v_mul_lo_u32 v9, v9, s91
    v_lshl_add_u32 v9, v7, 4, v9
    v_lshrrev_b32 v10, 2, v8
    v_mul_u32_u24 v10, 9216, v10
    v_and_b32 v11, 3, v8
    v_lshl_add_u32 v10, v11, 8, v10
    v_add_u32 v10, s88, v10
    v_cmp_lt_u32 vcc, 15, v8
    v_mul_u32_u24 v11, 9216, v8
    v_add_u32 v11, s89, v11
    v_cndmask_b32 v10, v10, v11, vcc
    v_add_u32 v203, v9, v10
    v_add_u32 v8, 64, v13
    v_mul_hi_u32 v9, v8, s90
    v_mul_u32_u24 v10, 18, v9
    v_sub_u32 v8, v8, v10
    v_mul_lo_u32 v9, v9, s91
    v_lshl_add_u32 v9, v7, 4, v9
    v_lshrrev_b32 v10, 2, v8
    v_mul_u32_u24 v10, 9216, v10
    v_and_b32 v11, 3, v8
    v_lshl_add_u32 v10, v11, 8, v10
    v_add_u32 v10, s88, v10
    v_cmp_lt_u32 vcc, 15, v8
    v_mul_u32_u24 v11, 9216, v8
    v_add_u32 v11, s89, v11
    v_cndmask_b32 v10, v10, v11, vcc
    v_add_u32 v204, v9, v10
    s_waitcnt vmcnt(8)
    v_lshlrev_b32 v64, 16, v160
    v_and_b32 v65, s40, v160
    v_lshlrev_b32 v66, 16, v161
    v_and_b32 v67, s40, v161
    v_lshlrev_b32 v68, 16, v162
    v_and_b32 v69, s40, v162
    v_pk_add_f32 v[8:9], v[64:65], v[68:69]
    v_lshlrev_b32 v70, 16, v163
    v_and_b32 v71, s40, v163
    v_pk_add_f32 v[10:11], v[66:67], v[70:71]
    s_waitcnt vmcnt(7)
    v_lshlrev_b32 v72, 16, v164
    v_and_b32 v73, s40, v164
    v_pk_add_f32 v[8:9], v[8:9], v[72:73]
    v_lshlrev_b32 v74, 16, v165
    v_and_b32 v75, s40, v165
    v_pk_add_f32 v[10:11], v[10:11], v[74:75]
    v_lshlrev_b32 v76, 16, v166
    v_and_b32 v77, s40, v166
    v_pk_add_f32 v[8:9], v[8:9], v[76:77]
    v_lshlrev_b32 v78, 16, v167
    v_and_b32 v79, s40, v167
    v_pk_add_f32 v[10:11], v[10:11], v[78:79]
    s_waitcnt vmcnt(6)
    v_lshlrev_b32 v80, 16, v168
    v_and_b32 v81, s40, v168
    v_pk_add_f32 v[8:9], v[8:9], v[80:81]
    v_lshlrev_b32 v82, 16, v169
    v_and_b32 v83, s40, v169
    v_pk_add_f32 v[10:11], v[10:11], v[82:83]
    v_lshlrev_b32 v84, 16, v170
    v_and_b32 v85, s40, v170
    v_pk_add_f32 v[8:9], v[8:9], v[84:85]
    v_lshlrev_b32 v86, 16, v171
    v_and_b32 v87, s40, v171
    v_pk_add_f32 v[10:11], v[10:11], v[86:87]
    s_waitcnt vmcnt(5)
    v_lshlrev_b32 v88, 16, v172
    v_and_b32 v89, s40, v172
    v_pk_add_f32 v[8:9], v[8:9], v[88:89]
    v_lshlrev_b32 v90, 16, v173
    v_and_b32 v91, s40, v173
    v_pk_add_f32 v[10:11], v[10:11], v[90:91]
    v_lshlrev_b32 v92, 16, v174
    v_and_b32 v93, s40, v174
    v_pk_add_f32 v[8:9], v[8:9], v[92:93]
    v_lshlrev_b32 v94, 16, v175
    v_and_b32 v95, s40, v175
    v_pk_add_f32 v[10:11], v[10:11], v[94:95]
    s_waitcnt vmcnt(4)
    v_lshlrev_b32 v96, 16, v176
    v_and_b32 v97, s40, v176
    v_pk_add_f32 v[8:9], v[8:9], v[96:97]
    v_lshlrev_b32 v98, 16, v177
    v_and_b32 v99, s40, v177
    v_pk_add_f32 v[10:11], v[10:11], v[98:99]
    v_lshlrev_b32 v100, 16, v178
    v_and_b32 v101, s40, v178
    v_pk_add_f32 v[8:9], v[8:9], v[100:101]
    v_lshlrev_b32 v102, 16, v179
    v_and_b32 v103, s40, v179
    v_pk_add_f32 v[10:11], v[10:11], v[102:103]
    s_waitcnt vmcnt(3)
    v_lshlrev_b32 v104, 16, v180
    v_and_b32 v105, s40, v180
    v_pk_add_f32 v[8:9], v[8:9], v[104:105]
    v_lshlrev_b32 v106, 16, v181
    v_and_b32 v107, s40, v181
    v_pk_add_f32 v[10:11], v[10:11], v[106:107]
    v_lshlrev_b32 v108, 16, v182
    v_and_b32 v109, s40, v182
    v_pk_add_f32 v[8:9], v[8:9], v[108:109]
    v_lshlrev_b32 v110, 16, v183
    v_and_b32 v111, s40, v183
    v_pk_add_f32 v[10:11], v[10:11], v[110:111]
    s_waitcnt vmcnt(2)
    v_lshlrev_b32 v112, 16, v184
    v_and_b32 v113, s40, v184
    v_pk_add_f32 v[8:9], v[8:9], v[112:113]
    v_lshlrev_b32 v114, 16, v185
    v_and_b32 v115, s40, v185
    v_pk_add_f32 v[10:11], v[10:11], v[114:115]
    v_lshlrev_b32 v116, 16, v186
    v_and_b32 v117, s40, v186
    v_pk_add_f32 v[8:9], v[8:9], v[116:117]
    v_lshlrev_b32 v118, 16, v187
    v_and_b32 v119, s40, v187
    v_pk_add_f32 v[10:11], v[10:11], v[118:119]
    s_waitcnt vmcnt(1)
    v_lshlrev_b32 v120, 16, v188
    v_and_b32 v121, s40, v188
    v_pk_add_f32 v[8:9], v[8:9], v[120:121]
    v_lshlrev_b32 v122, 16, v189
    v_and_b32 v123, s40, v189
    v_pk_add_f32 v[10:11], v[10:11], v[122:123]
    v_lshlrev_b32 v124, 16, v190
    v_and_b32 v125, s40, v190
    v_pk_add_f32 v[8:9], v[8:9], v[124:125]
    v_lshlrev_b32 v126, 16, v191
    v_and_b32 v127, s40, v191
    v_pk_add_f32 v[10:11], v[10:11], v[126:127]
    s_waitcnt vmcnt(0)
    v_lshlrev_b32 v128, 16, v192
    v_and_b32 v129, s40, v192
    v_pk_add_f32 v[8:9], v[8:9], v[128:129]
    v_lshlrev_b32 v130, 16, v193
    v_and_b32 v131, s40, v193
    v_pk_add_f32 v[10:11], v[10:11], v[130:131]
    v_lshlrev_b32 v132, 16, v194
    v_and_b32 v133, s40, v194
    v_pk_add_f32 v[8:9], v[8:9], v[132:133]
    v_lshlrev_b32 v134, 16, v195
    v_and_b32 v135, s40, v195
    v_pk_add_f32 v[10:11], v[10:11], v[134:135]
    v_pk_add_f32 v[8:9], v[8:9], v[10:11]
    v_add_f32 v8, v8, v9
    s_nop 1
    v_add_f32_dpp v8, v8, v8 row_ror:8 row_mask:0xf bank_mask:0xf
    v_mov_b32 v9, v8
    s_nop 1
    v_permlane16_swap_b32 v8, v9
    v_add_f32 v8, v8, v9
    v_mov_b32 v9, v8
    s_nop 1
    v_permlane32_swap_b32 v8, v9
    v_add_f32 v8, v8, v9
    v_mul_f32 v8, 0xbae38e39, v8
    v_mov_b32 v9, v8
    v_mov_b32 v10, 0
    v_mov_b32 v11, 0
    v_mov_b32 v12, 0
    v_mov_b32 v13, 0
    v_pk_add_f32 v[136:137], v[64:65], v[8:9]
    v_pk_fma_f32 v[10:11], v[136:137], v[136:137], v[10:11]
    v_pk_add_f32 v[138:139], v[66:67], v[8:9]
    v_pk_fma_f32 v[12:13], v[138:139], v[138:139], v[12:13]
    v_pk_add_f32 v[140:141], v[68:69], v[8:9]
    v_pk_fma_f32 v[10:11], v[140:141], v[140:141], v[10:11]
    v_pk_add_f32 v[142:143], v[70:71], v[8:9]
    v_pk_fma_f32 v[12:13], v[142:143], v[142:143], v[12:13]
    v_pk_add_f32 v[136:137], v[72:73], v[8:9]
    v_pk_fma_f32 v[10:11], v[136:137], v[136:137], v[10:11]
    v_pk_add_f32 v[138:139], v[74:75], v[8:9]
    v_pk_fma_f32 v[12:13], v[138:139], v[138:139], v[12:13]
    v_pk_add_f32 v[140:141], v[76:77], v[8:9]
    v_pk_fma_f32 v[10:11], v[140:141], v[140:141], v[10:11]
    v_pk_add_f32 v[142:143], v[78:79], v[8:9]
    v_pk_fma_f32 v[12:13], v[142:143], v[142:143], v[12:13]
    v_pk_add_f32 v[136:137], v[80:81], v[8:9]
    v_pk_fma_f32 v[10:11], v[136:137], v[136:137], v[10:11]
    v_pk_add_f32 v[138:139], v[82:83], v[8:9]
    v_pk_fma_f32 v[12:13], v[138:139], v[138:139], v[12:13]
    v_pk_add_f32 v[140:141], v[84:85], v[8:9]
    v_pk_fma_f32 v[10:11], v[140:141], v[140:141], v[10:11]
    v_pk_add_f32 v[142:143], v[86:87], v[8:9]
    v_pk_fma_f32 v[12:13], v[142:143], v[142:143], v[12:13]
    v_pk_add_f32 v[136:137], v[88:89], v[8:9]
    v_pk_fma_f32 v[10:11], v[136:137], v[136:137], v[10:11]
    v_pk_add_f32 v[138:139], v[90:91], v[8:9]
    v_pk_fma_f32 v[12:13], v[138:139], v[138:139], v[12:13]
    v_pk_add_f32 v[140:141], v[92:93], v[8:9]
    v_pk_fma_f32 v[10:11], v[140:141], v[140:141], v[10:11]
    v_pk_add_f32 v[142:143], v[94:95], v[8:9]
    v_pk_fma_f32 v[12:13], v[142:143], v[142:143], v[12:13]
    v_pk_add_f32 v[136:137], v[96:97], v[8:9]
    v_pk_fma_f32 v[10:11], v[136:137], v[136:137], v[10:11]
    v_pk_add_f32 v[138:139], v[98:99], v[8:9]
    v_pk_fma_f32 v[12:13], v[138:139], v[138:139], v[12:13]
    v_pk_add_f32 v[140:141], v[100:101], v[8:9]
    v_pk_fma_f32 v[10:11], v[140:141], v[140:141], v[10:11]
    v_pk_add_f32 v[142:143], v[102:103], v[8:9]
    v_pk_fma_f32 v[12:13], v[142:143], v[142:143], v[12:13]
    v_pk_add_f32 v[136:137], v[104:105], v[8:9]
    v_pk_fma_f32 v[10:11], v[136:137], v[136:137], v[10:11]
    v_pk_add_f32 v[138:139], v[106:107], v[8:9]
    v_pk_fma_f32 v[12:13], v[138:139], v[138:139], v[12:13]
    v_pk_add_f32 v[140:141], v[108:109], v[8:9]
    v_pk_fma_f32 v[10:11], v[140:141], v[140:141], v[10:11]
    v_pk_add_f32 v[142:143], v[110:111], v[8:9]
    v_pk_fma_f32 v[12:13], v[142:143], v[142:143], v[12:13]
    v_pk_add_f32 v[136:137], v[112:113], v[8:9]
    v_pk_fma_f32 v[10:11], v[136:137], v[136:137], v[10:11]
    v_pk_add_f32 v[138:139], v[114:115], v[8:9]
    v_pk_fma_f32 v[12:13], v[138:139], v[138:139], v[12:13]
    v_pk_add_f32 v[140:141], v[116:117], v[8:9]
    v_pk_fma_f32 v[10:11], v[140:141], v[140:141], v[10:11]
    v_pk_add_f32 v[142:143], v[118:119], v[8:9]
    v_pk_fma_f32 v[12:13], v[142:143], v[142:143], v[12:13]
    v_pk_add_f32 v[136:137], v[120:121], v[8:9]
    v_pk_fma_f32 v[10:11], v[136:137], v[136:137], v[10:11]
    v_pk_add_f32 v[138:139], v[122:123], v[8:9]
    v_pk_fma_f32 v[12:13], v[138:139], v[138:139], v[12:13]
    v_pk_add_f32 v[140:141], v[124:125], v[8:9]
    v_pk_fma_f32 v[10:11], v[140:141], v[140:141], v[10:11]
    v_pk_add_f32 v[142:143], v[126:127], v[8:9]
    v_pk_fma_f32 v[12:13], v[142:143], v[142:143], v[12:13]
    v_pk_add_f32 v[136:137], v[128:129], v[8:9]
    v_pk_fma_f32 v[10:11], v[136:137], v[136:137], v[10:11]
    v_pk_add_f32 v[138:139], v[130:131], v[8:9]
    v_pk_fma_f32 v[12:13], v[138:139], v[138:139], v[12:13]
    v_pk_add_f32 v[140:141], v[132:133], v[8:9]
    v_pk_fma_f32 v[10:11], v[140:141], v[140:141], v[10:11]
    v_pk_add_f32 v[142:143], v[134:135], v[8:9]
    v_pk_fma_f32 v[12:13], v[142:143], v[142:143], v[12:13]
    v_pk_add_f32 v[10:11], v[10:11], v[12:13]
    v_add_f32 v10, v10, v11
    s_nop 1
    v_add_f32_dpp v10, v10, v10 row_ror:8 row_mask:0xf bank_mask:0xf
    v_mov_b32 v11, v10
    s_nop 1
    v_permlane16_swap_b32 v10, v11
    v_add_f32 v10, v10, v11
    v_mov_b32 v11, v10
    s_nop 1
    v_permlane32_swap_b32 v10, v11
    v_add_f32 v10, v10, v11
    v_mul_f32 v10, 0x3ae38e39, v10
    v_cvt_pk_bf16_f32 v12, v8, v10
    v_lshlrev_b32 v8, 16, v12
    v_and_b32 v10, s40, v12
    v_mov_b32 v9, v8
    v_add_f32 v10, 0x3727c5ac, v10
    v_cvt_pk_bf16_f32 v10, v10, v10
    v_and_b32 v10, s40, v10
    v_sqrt_f32 v10, v10
    s_nop 0
    v_cvt_pk_bf16_f32 v10, v10, v10
    v_and_b32 v10, s40, v10
    v_rcp_f32 v10, v10
    s_nop 0
    v_mov_b32 v11, v10
    v_pk_add_f32 v[64:65], v[64:65], v[8:9]
    v_pk_add_f32 v[66:67], v[66:67], v[8:9]
    v_pk_add_f32 v[68:69], v[68:69], v[8:9]
    v_pk_add_f32 v[70:71], v[70:71], v[8:9]
    v_cvt_pk_bf16_f32 v136, v64, v65
    v_cvt_pk_bf16_f32 v137, v66, v67
    v_cvt_pk_bf16_f32 v138, v68, v69
    v_cvt_pk_bf16_f32 v139, v70, v71
    v_lshlrev_b32 v64, 16, v136
    v_and_b32 v65, s40, v136
    v_lshlrev_b32 v66, 16, v137
    v_and_b32 v67, s40, v137
    v_lshlrev_b32 v68, 16, v138
    v_and_b32 v69, s40, v138
    v_lshlrev_b32 v70, 16, v139
    v_and_b32 v71, s40, v139
    v_pk_mul_f32 v[64:65], v[64:65], v[10:11]
    v_pk_mul_f32 v[66:67], v[66:67], v[10:11]
    v_pk_mul_f32 v[68:69], v[68:69], v[10:11]
    v_pk_mul_f32 v[70:71], v[70:71], v[10:11]
    v_cvt_pk_bf16_f32 v16, v64, v65
    v_cvt_pk_bf16_f32 v17, v66, v67
    v_cvt_pk_bf16_f32 v18, v68, v69
    v_cvt_pk_bf16_f32 v19, v70, v71
    s_lshl_b32 s87, s16, 30
    s_add_u32 s87, s87, s30
    buffer_store_dwordx4 v[16:19], v60, s[8:11], s87 offen sc1
    s_add_u32 s30, s30, 8192
    v_pk_add_f32 v[72:73], v[72:73], v[8:9]
    v_pk_add_f32 v[74:75], v[74:75], v[8:9]
    v_pk_add_f32 v[76:77], v[76:77], v[8:9]
    v_pk_add_f32 v[78:79], v[78:79], v[8:9]
    v_cvt_pk_bf16_f32 v136, v72, v73
    v_cvt_pk_bf16_f32 v137, v74, v75
    v_cvt_pk_bf16_f32 v138, v76, v77
    v_cvt_pk_bf16_f32 v139, v78, v79
    v_lshlrev_b32 v72, 16, v136
    v_and_b32 v73, s40, v136
    v_lshlrev_b32 v74, 16, v137
    v_and_b32 v75, s40, v137
    v_lshlrev_b32 v76, 16, v138
    v_and_b32 v77, s40, v138
    v_lshlrev_b32 v78, 16, v139
    v_and_b32 v79, s40, v139
    v_pk_mul_f32 v[72:73], v[72:73], v[10:11]
    v_pk_mul_f32 v[74:75], v[74:75], v[10:11]
    v_pk_mul_f32 v[76:77], v[76:77], v[10:11]
    v_pk_mul_f32 v[78:79], v[78:79], v[10:11]
    v_cvt_pk_bf16_f32 v20, v72, v73
    v_cvt_pk_bf16_f32 v21, v74, v75
    v_cvt_pk_bf16_f32 v22, v76, v77
    v_cvt_pk_bf16_f32 v23, v78, v79
    buffer_store_dwordx4 v[20:23], v60, s[8:11], s30 offen sc1
    s_add_u32 s30, s30, 8192
    v_pk_add_f32 v[80:81], v[80:81], v[8:9]
    v_pk_add_f32 v[82:83], v[82:83], v[8:9]
    v_pk_add_f32 v[84:85], v[84:85], v[8:9]
    v_pk_add_f32 v[86:87], v[86:87], v[8:9]
    v_cvt_pk_bf16_f32 v136, v80, v81
    v_cvt_pk_bf16_f32 v137, v82, v83
    v_cvt_pk_bf16_f32 v138, v84, v85
    v_cvt_pk_bf16_f32 v139, v86, v87
    v_lshlrev_b32 v80, 16, v136
    v_and_b32 v81, s40, v136
    v_lshlrev_b32 v82, 16, v137
    v_and_b32 v83, s40, v137
    v_lshlrev_b32 v84, 16, v138
    v_and_b32 v85, s40, v138
    v_lshlrev_b32 v86, 16, v139
    v_and_b32 v87, s40, v139
    v_pk_mul_f32 v[80:81], v[80:81], v[10:11]
    v_pk_mul_f32 v[82:83], v[82:83], v[10:11]
    v_pk_mul_f32 v[84:85], v[84:85], v[10:11]
    v_pk_mul_f32 v[86:87], v[86:87], v[10:11]
    v_cvt_pk_bf16_f32 v24, v80, v81
    v_cvt_pk_bf16_f32 v25, v82, v83
    v_cvt_pk_bf16_f32 v26, v84, v85
    v_cvt_pk_bf16_f32 v27, v86, v87
    buffer_store_dwordx4 v[24:27], v60, s[8:11], s30 offen sc1
    s_add_u32 s30, s30, 8192
    v_pk_add_f32 v[88:89], v[88:89], v[8:9]
    v_pk_add_f32 v[90:91], v[90:91], v[8:9]
    v_pk_add_f32 v[92:93], v[92:93], v[8:9]
    v_pk_add_f32 v[94:95], v[94:95], v[8:9]
    v_cvt_pk_bf16_f32 v136, v88, v89
    v_cvt_pk_bf16_f32 v137, v90, v91
    v_cvt_pk_bf16_f32 v138, v92, v93
    v_cvt_pk_bf16_f32 v139, v94, v95
    v_lshlrev_b32 v88, 16, v136
    v_and_b32 v89, s40, v136
    v_lshlrev_b32 v90, 16, v137
    v_and_b32 v91, s40, v137
    v_lshlrev_b32 v92, 16, v138
    v_and_b32 v93, s40, v138
    v_lshlrev_b32 v94, 16, v139
    v_and_b32 v95, s40, v139
    v_pk_mul_f32 v[88:89], v[88:89], v[10:11]
    v_pk_mul_f32 v[90:91], v[90:91], v[10:11]
    v_pk_mul_f32 v[92:93], v[92:93], v[10:11]
    v_pk_mul_f32 v[94:95], v[94:95], v[10:11]
    v_cvt_pk_bf16_f32 v28, v88, v89
    v_cvt_pk_bf16_f32 v29, v90, v91
    v_cvt_pk_bf16_f32 v30, v92, v93
    v_cvt_pk_bf16_f32 v31, v94, v95
    buffer_store_dwordx4 v[28:31], v60, s[8:11], s30 offen sc1
    s_add_u32 s30, s30, 8192
    v_pk_add_f32 v[96:97], v[96:97], v[8:9]
    v_pk_add_f32 v[98:99], v[98:99], v[8:9]
    v_pk_add_f32 v[100:101], v[100:101], v[8:9]
    v_pk_add_f32 v[102:103], v[102:103], v[8:9]
    v_cvt_pk_bf16_f32 v136, v96, v97
    v_cvt_pk_bf16_f32 v137, v98, v99
    v_cvt_pk_bf16_f32 v138, v100, v101
    v_cvt_pk_bf16_f32 v139, v102, v103
    v_lshlrev_b32 v96, 16, v136
    v_and_b32 v97, s40, v136
    v_lshlrev_b32 v98, 16, v137
    v_and_b32 v99, s40, v137
    v_lshlrev_b32 v100, 16, v138
    v_and_b32 v101, s40, v138
    v_lshlrev_b32 v102, 16, v139
    v_and_b32 v103, s40, v139
    v_pk_mul_f32 v[96:97], v[96:97], v[10:11]
    v_pk_mul_f32 v[98:99], v[98:99], v[10:11]
    v_pk_mul_f32 v[100:101], v[100:101], v[10:11]
    v_pk_mul_f32 v[102:103], v[102:103], v[10:11]
    v_cvt_pk_bf16_f32 v32, v96, v97
    v_cvt_pk_bf16_f32 v33, v98, v99
    v_cvt_pk_bf16_f32 v34, v100, v101
    v_cvt_pk_bf16_f32 v35, v102, v103
    buffer_store_dwordx4 v[32:35], v60, s[8:11], s30 offen sc1
    s_add_u32 s30, s30, 8192
    s_waitcnt lgkmcnt(0)
    s_add_u32 s44, s44, 8
    s_addc_u32 s45, s45, 0
    v_mov_b32 v8, s44
    v_mov_b32 v9, s45
    s_waitcnt vmcnt(0)
    buffer_store_dwordx2 v[8:9], off, s[8:11], s31 sc1
    s_add_u32 m0, s19, 0
    s_mul_i32 s20, s56, 589824
    s_add_u32 s20, s20, s26
    buffer_load_dwordx4 v6, s[12:15], s20 offen lds
    s_add_u32 m0, s19, 4096
    s_add_u32 s20, s20, 294912
    buffer_load_dwordx4 v6, s[12:15], s20 offen lds
    s_add_u32 m0, s19, 8192
    s_mul_i32 s21, s56, 589824
    s_add_u32 s21, s21, s26
    buffer_load_dwordx4 v6, s[96:99], s21 offen lds
    s_add_u32 m0, s19, 12288
    s_add_u32 s21, s21, 294912
    buffer_load_dwordx4 v6, s[96:99], s21 offen lds
    s_add_u32 m0, s19, 16384
    s_mul_i32 s20, s57, 589824
    s_add_u32 s20, s20, s26
    buffer_load_dwordx4 v6, s[12:15], s20 offen lds
    s_add_u32 m0, s19, 20480
    s_add_u32 s20, s20, 294912
    buffer_load_dwordx4 v6, s[12:15], s20 offen lds
    s_add_u32 m0, s19, 24576
    s_mul_i32 s21, s57, 589824
    s_add_u32 s21, s21, s26
    buffer_load_dwordx4 v6, s[96:99], s21 offen lds
    s_add_u32 m0, s19, 28672
    s_add_u32 s21, s21, 294912
    buffer_load_dwordx4 v6, s[96:99], s21 offen lds
    s_waitcnt vmcnt(0)
    s_branch LM_join
    s_waitcnt vmcnt(0) lgkmcnt(0)
LM_notln:
    v_mov_b32 v204, 1073741824
    v_lshrrev_b32 v8, 4, v14
    v_lshlrev_b32 v8, 10, v8
    v_bfe_u32 v9, v14, 2, 2
    v_lshl_add_u32 v8, v9, 7, v8
    v_add_u32 v8, s41, v8
    v_and_b32 v9, 3, v14
    s_getpc_b64 s[32:33]
LM_pc:
    s_mov_b32 s34, LF_codeend-LM_pc
    s_mov_b32 s35, 0x00020000
    s_lshr_b32 s30, s2, 3
    s_lshl_b32 s30, s30, 1
    s_add_u32 s30, s30, s16
    s_sub_u32 s30, s30, 2
    s_lshl_b32 s30, s30, 10
    v_lshlrev_b32 v7, 7, v12
    buffer_load_dword v62, v7, s[32:35], s30 offen
    s_mov_b32 s30, s2
    s_cmp_eq_u32 s16, 2
    s_cbranch_scc1 LM_wq
    s_sub_u32 s88, 255, s2
    s_add_u32 s30, s88, 256
    s_cmp_ge_u32 s88, 32
    s_cbranch_scc1 LM_wr
LM_wq:
    s_lshr_b32 s86, s30, 4
    s_and_b32 s87, s30, 7
    s_lshl_b32 s87, s87, 1
    s_bfe_u32 s31, s30, 0x10003
    s_add_u32 s87, s87, s31
    s_mul_i32 s30, s86, 110592
    s_mul_i32 s31, s87, 72
    s_add_u32 s30, s30, s31
    v_mul_u32_u24 v7, 3456, v13
    v_bfe_u32 v10, v14, 2, 1
    v_mul_u32_u24 v10, 36, v10
    v_add_u32 v7, v7, v10
    v_min_u32 v10, 2, v9
    v_lshl_add_u32 v7, v10, 4, v7
    s_mov_b32 s32, s48
    s_mov_b32 s33, s49
    s_mov_b32 s34, 1990656
    s_mov_b32 s35, 0x00020000
    s_add_u32 m0, s41, 0
    s_add_u32 s31, s30, 1152
    buffer_load_dwordx4 v7, s[32:35], s31 offen lds
    s_add_u32 m0, s41, 1024
    s_add_u32 s31, s30, 28800
    buffer_load_dwordx4 v7, s[32:35], s31 offen lds
    s_add_u32 m0, s41, 2048
    s_add_u32 s31, s30, 56448
    buffer_load_dwordx4 v7, s[32:35], s31 offen lds
    s_add_u32 m0, s41, 3072
    s_add_u32 s31, s30, 84096
    buffer_load_dwordx4 v7, s[32:35], s31 offen lds
    s_add_u32 m0, s41, 4096
    s_add_u32 s31, s30, 0
    buffer_load_dwordx4 v7, s[32:35], s31 offen lds
    s_add_u32 m0, s41, 5120
    s_add_u32 s31, s30, 27648
    buffer_load_dwordx4 v7, s[32:35], s31 offen lds
    s_add_u32 m0, s41, 6144
    s_add_u32 s31, s30, 55296
    buffer_load_dwordx4 v7, s[32:35], s31 offen lds
    s_add_u32 m0, s41, 7168
    s_add_u32 s31, s30, 82944
    buffer_load_dwordx4 v7, s[32:35], s31 offen lds
    s_add_u32 m0, s41, 8192
    s_add_u32 s31, s30, 2304
    buffer_load_dwordx4 v7, s[32:35], s31 offen lds
    s_add_u32 m0, s41, 9216
    s_add_u32 s31, s30, 29952
    buffer_load_dwordx4 v7, s[32:35], s31 offen lds
    s_add_u32 m0, s41, 10240
    s_add_u32 s31, s30, 57600
    buffer_load_dwordx4 v7, s[32:35], s31 offen lds
    s_add_u32 m0, s41, 11264
    s_add_u32 s31, s30, 85248
    buffer_load_dwordx4 v7, s[32:35], s31 offen lds
    v_lshl_add_u32 v56, v9, 3, v8
    v_add_u32 v57, 4096, v56
    v_add_u32 v58, 8192, v56
    v_lshl_add_u32 v59, v10, 12, v8
    v_add_u32 v59, 32, v59
    s_mul_i32 s30, s87, 221184
    s_lshl_b32 s31, s86, 12
    s_add_u32 s30, s30, s31
    s_add_u32 s30, s30, 2359296
    s_lshl_b32 s92, s87, 5
    s_add_u32 s92, s92, s86
    s_lshl_b32 s92, s92, 6
    s_add_u32 s92, s92, 55574528
    v_add_u32 v196, s30, v5
    v_add_u32 v197, 1024, v196
    v_add_u32 v198, 2048, v196
    v_add_u32 v199, 3072, v196
    v_add_u32 v200, 110592, v196
    v_add_u32 v201, 111616, v196
    v_add_u32 v202, 112640, v196
    v_add_u32 v203, 113664, v196
    s_waitcnt vmcnt(0)
    s_add_u32 m0, s19, 0
    s_mul_i32 s20, s56, 589824
    s_add_u32 s20, s20, s26
    buffer_load_dwordx4 v6, s[12:15], s20 offen lds
    s_add_u32 m0, s19, 4096
    s_add_u32 s20, s20, 294912
    buffer_load_dwordx4 v6, s[12:15], s20 offen lds
    s_add_u32 m0, s19, 8192
    s_mul_i32 s21, s56, 589824
    s_add_u32 s21, s21, s26
    buffer_load_dwordx4 v6, s[96:99], s21 offen lds
    s_add_u32 m0, s19, 12288
    s_add_u32 s21, s21, 294912
    buffer_load_dwordx4 v6, s[96:99], s21 offen lds
    s_add_u32 m0, s19, 16384
    s_mul_i32 s20, s57, 589824
    s_add_u32 s20, s20, s26
    buffer_load_dwordx4 v6, s[12:15], s20 offen lds
    s_add_u32 m0, s19, 20480
    s_add_u32 s20, s20, 294912
    buffer_load_dwordx4 v6, s[12:15], s20 offen lds
    s_add_u32 m0, s19, 24576
    s_mul_i32 s21, s57, 589824
    s_add_u32 s21, s21, s26
    buffer_load_dwordx4 v6, s[96:99], s21 offen lds
    s_add_u32 m0, s19, 28672
    s_add_u32 s21, s21, 294912
    buffer_load_dwordx4 v6, s[96:99], s21 offen lds
    ds_read_b64_tr_b16 v[160:161], v56 offset:0
    ds_read_b64_tr_b16 v[162:163], v56 offset:512
    ds_read_b64_tr_b16 v[164:165], v57 offset:0
    ds_read_b64_tr_b16 v[166:167], v57 offset:512
    ds_read_b64_tr_b16 v[168:169], v58 offset:0
    ds_read_b64_tr_b16 v[170:171], v58 offset:512
    ds_read_b64_tr_b16 v[172:173], v59 offset:0
    ds_read_b64_tr_b16 v[174:175], v59 offset:512
    ds_read_b64_tr_b16 v[176:177], v56 offset:64
    ds_read_b64_tr_b16 v[178:179], v56 offset:576
    ds_read_b64_tr_b16 v[180:181], v57 offset:64
    ds_read_b64_tr_b16 v[182:183], v57 offset:576
    ds_read_b64_tr_b16 v[184:185], v58 offset:64
    ds_read_b64_tr_b16 v[186:187], v58 offset:576
    ds_read_b64_tr_b16 v[188:189], v59 offset:64
    ds_read_b64_tr_b16 v[190:191], v59 offset:576
    s_branch LM_tag
    s_waitcnt vmcnt(0) lgkmcnt(0)
LM_wr:
    s_cmp_ge_u32 s88, 176
    s_cbranch_scc1 LM_only
    s_sub_u32 s30, s88, 32
    s_lshr_b32 s86, s30, 3
    s_and_b32 s87, s30, 7
    s_mul_i32 s30, s86, 294912
    s_lshl_b32 s31, s87, 7
    s_add_u32 s30, s30, s31
    s_add_u32 s30, s30, 8192
    v_mul_u32_u24 v7, 9216, v13
    v_lshl_add_u32 v7, v12, 4, v7
    s_add_u32 m0, s41, 0
    s_add_u32 s31, s30, 0
    buffer_load_dwordx4 v7, s[12:15], s31 offen lds
    s_add_u32 m0, s41, 1024
    s_add_u32 s31, s30, 73728
    buffer_load_dwordx4 v7, s[12:15], s31 offen lds
    s_add_u32 m0, s41, 2048
    s_add_u32 s31, s30, 147456
    buffer_load_dwordx4 v7, s[12:15], s31 offen lds
    s_add_u32 m0, s41, 3072
    s_add_u32 s31, s30, 221184
    buffer_load_dwordx4 v7, s[12:15], s31 offen lds
    s_add_u32 m0, s41, 4096
    s_add_u32 s31, s30, 0
    buffer_load_dwordx4 v7, s[96:99], s31 offen lds
    s_add_u32 m0, s41, 5120
    s_add_u32 s31, s30, 73728
    buffer_load_dwordx4 v7, s[96:99], s31 offen lds
    s_add_u32 m0, s41, 6144
    s_add_u32 s31, s30, 147456
    buffer_load_dwordx4 v7, s[96:99], s31 offen lds
    s_add_u32 m0, s41, 7168
    s_add_u32 s31, s30, 221184
    buffer_load_dwordx4 v7, s[96:99], s31 offen lds
    v_lshl_add_u32 v10, v9, 3, v8
    s_mul_i32 s30, s87, 442368
    s_lshl_b32 s31, s86, 11
    s_add_u32 s30, s30, s31
    s_add_u32 s30, s30, 2433024
    s_lshl_b32 s92, s87, 5
    s_add_u32 s92, s92, s86
    s_lshl_b32 s92, s92, 6
    s_add_u32 s92, s92, 55607296
    v_add_u32 v196, s30, v5
    v_add_u32 v197, 1024, v196
    v_add_u32 v198, 110592, v196
    v_add_u32 v199, 111616, v196
    v_add_u32 v200, 221184, v196
    v_add_u32 v201, 222208, v196
    v_add_u32 v202, 331776, v196
    v_add_u32 v203, 332800, v196
    s_waitcnt vmcnt(0)
    s_add_u32 m0, s19, 0
    s_mul_i32 s20, s56, 589824
    s_add_u32 s20, s20, s26
    buffer_load_dwordx4 v6, s[12:15], s20 offen lds
    s_add_u32 m0, s19, 4096
    s_add_u32 s20, s20, 294912
    buffer_load_dwordx4 v6, s[12:15], s20 offen lds
    s_add_u32 m0, s19, 8192
    s_mul_i32 s21, s56, 589824
    s_add_u32 s21, s21, s26
    buffer_load_dwordx4 v6, s[96:99], s21 offen lds
    s_add_u32 m0, s19, 12288
    s_add_u32 s21, s21, 294912
    buffer_load_dwordx4 v6, s[96:99], s21 offen lds
    s_add_u32 m0, s19, 16384
    s_mul_i32 s20, s57, 589824
    s_add_u32 s20, s20, s26
    buffer_load_dwordx4 v6, s[12:15], s20 offen lds
    s_add_u32 m0, s19, 20480
    s_add_u32 s20, s20, 294912
    buffer_load_dwordx4 v6, s[12:15], s20 offen lds
    s_add_u32 m0, s19, 24576
    s_mul_i32 s21, s57, 589824
    s_add_u32 s21, s21, s26
    buffer_load_dwordx4 v6, s[96:99], s21 offen lds
    s_add_u32 m0, s19, 28672
    s_add_u32 s21, s21, 294912
    buffer_load_dwordx4 v6, s[96:99], s21 offen lds
    ds_read_b64_tr_b16 v[160:161], v10 offset:0
    ds_read_b64_tr_b16 v[162:163], v10 offset:512
    ds_read_b64_tr_b16 v[164:165], v10 offset:4096
    ds_read_b64_tr_b16 v[166:167], v10 offset:4608
    ds_read_b64_tr_b16 v[168:169], v10 offset:32
    ds_read_b64_tr_b16 v[170:171], v10 offset:544
    ds_read_b64_tr_b16 v[172:173], v10 offset:4128
    ds_read_b64_tr_b16 v[174:175], v10 offset:4640
    ds_read_b64_tr_b16 v[176:177], v10 offset:64
    ds_read_b64_tr_b16 v[178:179], v10 offset:576
    ds_read_b64_tr_b16 v[180:181], v10 offset:4160
    ds_read_b64_tr_b16 v[182:183], v10 offset:4672
    ds_read_b64_tr_b16 v[184:185], v10 offset:96
    ds_read_b64_tr_b16 v[186:187], v10 offset:608
    ds_read_b64_tr_b16 v[188:189], v10 offset:4192
    ds_read_b64_tr_b16 v[190:191], v10 offset:4704
    s_branch LM_tag
    s_waitcnt vmcnt(0) lgkmcnt(0)
LM_only:
    s_waitcnt vmcnt(0)
    s_add_u32 m0, s19, 0
    s_mul_i32 s20, s56, 589824
    s_add_u32 s20, s20, s26
    buffer_load_dwordx4 v6, s[12:15], s20 offen lds
    s_add_u32 m0, s19, 4096
    s_add_u32 s20, s20, 294912
    buffer_load_dwordx4 v6, s[12:15], s20 offen lds
    s_add_u32 m0, s19, 8192
    s_mul_i32 s21, s56, 589824
    s_add_u32 s21, s21, s26
    buffer_load_dwordx4 v6, s[96:99], s21 offen lds
    s_add_u32 m0, s19, 12288
    s_add_u32 s21, s21, 294912
    buffer_load_dwordx4 v6, s[96:99], s21 offen lds
    s_add_u32 m0, s19, 16384
    s_mul_i32 s20, s57, 589824
    s_add_u32 s20, s20, s26
    buffer_load_dwordx4 v6, s[12:15], s20 offen lds
    s_add_u32 m0, s19, 20480
    s_add_u32 s20, s20, 294912
    buffer_load_dwordx4 v6, s[12:15], s20 offen lds
    s_add_u32 m0, s19, 24576
    s_mul_i32 s21, s57, 589824
    s_add_u32 s21, s21, s26
    buffer_load_dwordx4 v6, s[96:99], s21 offen lds
    s_add_u32 m0, s19, 28672
    s_add_u32 s21, s21, 294912
    buffer_load_dwordx4 v6, s[96:99], s21 offen lds
    v_mov_b32 v196, 1073741824
    v_mov_b32 v197, 1073741824
    v_mov_b32 v198, 1073741824
    v_mov_b32 v199, 1073741824
    v_mov_b32 v200, 1073741824
    v_mov_b32 v201, 1073741824
    v_mov_b32 v202, 1073741824
    v_mov_b32 v203, 1073741824
LM_tag:
    s_waitcnt vmcnt(0) lgkmcnt(0)
    s_add_u32 s44, s44, 8
    s_addc_u32 s45, s45, 0
LM_join:
    s_add_u32 s60, s59, 1
    s_cmp_eq_u32 s60, 9
    s_cselect_b32 s60, 0, s60
    s_add_u32 s61, s60, 1
    s_cmp_eq_u32 s61, 9
    s_cselect_b32 s61, 0, s61
    s_add_u32 s62, s61, 1
    s_cmp_eq_u32 s62, 9
    s_cselect_b32 s62, 0, s62
    s_add_u32 s63, s62, 1
    s_cmp_eq_u32 s63, 9
    s_cselect_b32 s63, 0, s63
    s_add_u32 s64, s63, 1
    s_cmp_eq_u32 s64, 9
    s_cselect_b32 s64, 0, s64
    s_lshl_b32 s25, s18, 3
    s_lshl_b32 s30, s16, 1
    s_add_u32 s25, s25, s30
    s_mul_i32 s3, s25, 36864
    s_lshl_b32 s30, s25, 9
    s_add_u32 s30, s30, 55541760
    v_and_b32 v8, 0xf0, v5
    v_lshlrev_b32 v8, 2, v8
    v_lshrrev_b32 v9, 4, v14
    v_lshlrev_b32 v1, 10, v9
    v_bfe_u32 v10, v14, 2, 2
    v_lshl_add_u32 v1, v10, 7, v1
    v_bfe_u32 v10, v14, 3, 2
    v_lshl_add_u32 v1, v10, 5, v1
    v_and_b32 v10, 3, v14
    v_lshl_add_u32 v1, v10, 3, v1
    v_xor_b32 v2, 32, v1
    v_xor_b32 v3, 64, v1
    v_xor_b32 v4, 96, v1
    v_add_u32 v7, 0x10000, v5
    v_add_u32 v12, 0x20000, v5
    s_mov_b32 s28, 0
    s_barrier
    ds_read_b64_tr_b16 v[16:17], v1 offset:0
    ds_read_b64_tr_b16 v[18:19], v1 offset:512
    ds_read_b64_tr_b16 v[20:21], v1 offset:4096
    ds_read_b64_tr_b16 v[22:23], v1 offset:4608
    ds_read_b64_tr_b16 v[24:25], v2 offset:0
    ds_read_b64_tr_b16 v[26:27], v2 offset:512
    ds_read_b64_tr_b16 v[28:29], v2 offset:4096
    ds_read_b64_tr_b16 v[30:31], v2 offset:4608
LM_poll:
    s_sleep 2
    buffer_load_dwordx2 v[10:11], v8, s[8:11], s30 offen sc1
    s_add_u32 s28, s28, 1
    s_cmp_gt_u32 s28, 0x80000
    s_waitcnt vmcnt(0)
    s_cbranch_scc1 LM_go
    v_cmp_ne_u64 vcc, s[44:45], v[10:11]
    s_nop 0
    s_cbranch_vccnz LM_poll
LM_go:
    s_lshl_b32 s22, s56, 13
    s_add_u32 s22, s22, s3
    buffer_load_dwordx4 a[0:3], v5, s[8:11], s22 offen offset:0 sc1
    buffer_load_dwordx4 a[4:7], v5, s[8:11], s22 offen offset:1024 sc1
    buffer_load_dwordx4 a[8:11], v5, s[8:11], s22 offen offset:2048 sc1
    buffer_load_dwordx4 a[12:15], v5, s[8:11], s22 offen offset:3072 sc1
    s_add_u32 s22, s22, 4096
    buffer_load_dwordx4 a[16:19], v5, s[8:11], s22 offen offset:0 sc1
    buffer_load_dwordx4 a[20:23], v5, s[8:11], s22 offen offset:1024 sc1
    buffer_load_dwordx4 a[24:27], v5, s[8:11], s22 offen offset:2048 sc1
    buffer_load_dwordx4 a[28:31], v5, s[8:11], s22 offen offset:3072 sc1
    s_lshl_b32 s22, s57, 13
    s_add_u32 s22, s22, s3
    buffer_load_dwordx4 a[32:35], v5, s[8:11], s22 offen offset:0 sc1
    buffer_load_dwordx4 a[36:39], v5, s[8:11], s22 offen offset:1024 sc1
    buffer_load_dwordx4 a[40:43], v5, s[8:11], s22 offen offset:2048 sc1
    buffer_load_dwordx4 a[44:47], v5, s[8:11], s22 offen offset:3072 sc1
    s_add_u32 s22, s22, 4096
    buffer_load_dwordx4 a[48:51], v5, s[8:11], s22 offen offset:0 sc1
    buffer_load_dwordx4 a[52:55], v5, s[8:11], s22 offen offset:1024 sc1
    s_waitcnt vmcnt(13) lgkmcnt(6)
    v_mfma_f32_16x16x32_bf16 v[32:35], v[16:19], a[0:3], 0
    s_waitcnt vmcnt(9) lgkmcnt(4)
    buffer_load_dwordx4 a[56:59], v5, s[8:11], s22 offen offset:2048 sc1
    s_mov_b32 s54, 2359296
    v_mfma_f32_16x16x32_bf16 v[32:35], v[20:23], a[16:19], v[32:35]
    s_waitcnt vmcnt(9)
    s_add_u32 s28, s44, 1
    v_mov_b32 v15, s28
    v_mfma_f32_16x16x32_bf16 v[48:51], v[20:23], a[20:23], 0
    s_mov_b32 s55, 0x00020000
    v_mov_b32 v218, s44
    v_mov_b32 v219, s45
    v_mfma_f32_16x16x32_bf16 v[48:51], v[16:19], a[4:7], v[48:51]
    buffer_load_dwordx4 a[60:63], v5, s[8:11], s22 offen offset:3072 sc1
    s_mul_i32 s27, s17, 110592
    v_mfma_f32_16x16x32_bf16 v[64:67], v[16:19], a[8:11], 0
    s_waitcnt vmcnt(9)
    s_add_u32 s27, s27, s19
    s_add_u32 s27, s27, 2359296
    v_mfma_f32_16x16x32_bf16 v[64:67], v[20:23], a[24:27], v[64:67]
    s_waitcnt vmcnt(8)
    s_add_u32 s69, s27, 73728
    s_lshr_b32 s32, s17, 3
    v_mfma_f32_16x16x32_bf16 v[80:83], v[20:23], a[28:31], 0
    s_add_u32 m0, s19, 32768
    ds_read_b64_tr_b16 v[20:21], v1 offset:12288
    ds_read_b64_tr_b16 v[22:23], v1 offset:12800
    v_mfma_f32_16x16x32_bf16 v[80:83], v[16:19], a[12:15], v[80:83]
    s_waitcnt lgkmcnt(4)
    ds_read_b64_tr_b16 v[16:17], v1 offset:8192
    ds_read_b64_tr_b16 v[18:19], v1 offset:8704
    v_mfma_f32_16x16x32_bf16 v[84:87], v[24:27], a[12:15], 0
    s_waitcnt lgkmcnt(4)
    s_mul_i32 s20, s58, 589824
    s_add_u32 s20, s20, s26
    buffer_load_dwordx4 v6, s[12:15], s20 offen lds
    v_mfma_f32_16x16x32_bf16 v[84:87], v[28:31], a[28:31], v[84:87]
    s_lshl_b32 s33, s32, 6
    s_add_u32 s33, s33, s25
    s_mul_i32 s33, s33, 86144
    v_mfma_f32_16x16x32_bf16 v[68:71], v[28:31], a[24:27], 0
    s_add_u32 s33, s33, 12124160
    s_and_b32 s34, s17, 7
    s_lshl_b32 s35, s34, 11
    v_mfma_f32_16x16x32_bf16 v[68:71], v[24:27], a[8:11], v[68:71]
    s_add_u32 s30, s33, s35
    s_lshr_b32 s35, s34, 1
    s_lshl_b32 s35, s35, 11
    v_mfma_f32_16x16x32_bf16 v[52:55], v[24:27], a[4:7], 0
    s_add_u32 m0, s19, 36864
    s_add_u32 s20, s20, 294912
    buffer_load_dwordx4 v6, s[12:15], s20 offen lds
    v_mfma_f32_16x16x32_bf16 v[52:55], v[28:31], a[20:23], v[52:55]
    s_add_u32 s31, s33, s35
    s_and_b32 s35, s34, 1
    s_lshl_b32 s35, s35, 9
    v_mfma_f32_16x16x32_bf16 v[36:39], v[28:31], a[16:19], 0
    s_add_u32 m0, s19, 40960
    ds_read_b64_tr_b16 v[28:29], v2 offset:12288
    ds_read_b64_tr_b16 v[30:31], v2 offset:12800
    v_mfma_f32_16x16x32_bf16 v[36:39], v[24:27], a[0:3], v[36:39]
    s_waitcnt lgkmcnt(2)
    ds_read_b64_tr_b16 v[24:25], v2 offset:8192
    ds_read_b64_tr_b16 v[26:27], v2 offset:8704
    v_mfma_f32_16x16x32_bf16 v[40:43], v[16:19], a[0:3], 0
    s_add_u32 s31, s31, s35
    s_lshl_b32 s46, s18, 2
    s_add_u32 s46, s46, s32
    v_mfma_f32_16x16x32_bf16 v[40:43], v[20:23], a[16:19], v[40:43]
    s_mul_i32 s21, s58, 589824
    s_add_u32 s21, s21, s26
    buffer_load_dwordx4 v6, s[96:99], s21 offen lds
    v_mfma_f32_16x16x32_bf16 v[56:59], v[20:23], a[20:23], 0
    s_lshl_b32 s46, s46, 2
    s_add_u32 s46, s46, s16
    s_lshl_b32 s46, s46, 3
    v_mfma_f32_16x16x32_bf16 v[56:59], v[16:19], a[4:7], v[56:59]
    s_add_u32 s46, s46, s34
    s_lshl_b32 s46, s46, 6
    s_add_u32 s46, s46, 55476224
    v_mfma_f32_16x16x32_bf16 v[72:75], v[16:19], a[8:11], 0
    s_add_u32 m0, s19, 45056
    buffer_store_dwordx4 v[160:163], v196, s[8:11], 0 offen sc1
    s_mul_i32 s34, s34, 3
    v_mfma_f32_16x16x32_bf16 v[72:75], v[20:23], a[24:27], v[72:75]
    s_add_u32 s21, s21, 294912
    buffer_load_dwordx4 v6, s[96:99], s21 offen lds
    s_add_u32 s33, s33, 32768
    v_mfma_f32_16x16x32_bf16 v[88:91], v[20:23], a[28:31], 0
    s_lshl_b32 s22, s58, 13
    ds_read_b64_tr_b16 v[20:21], v3 offset:4096
    ds_read_b64_tr_b16 v[22:23], v3 offset:4608
    v_mfma_f32_16x16x32_bf16 v[88:91], v[16:19], a[12:15], v[88:91]
    s_waitcnt lgkmcnt(2)
    ds_read_b64_tr_b16 v[16:17], v3 offset:0
    ds_read_b64_tr_b16 v[18:19], v3 offset:512
    v_mfma_f32_16x16x32_bf16 v[92:95], v[24:27], a[12:15], 0
    s_lshr_b32 s35, s34, 2
    s_lshl_b32 s35, s35, 11
    s_add_u32 s36, s33, s35
    v_mfma_f32_16x16x32_bf16 v[92:95], v[28:31], a[28:31], v[92:95]
    s_and_b32 s35, s34, 3
    s_lshl_b32 s35, s35, 8
    s_add_u32 s36, s36, s35
    v_mfma_f32_16x16x32_bf16 v[76:79], v[28:31], a[24:27], 0
    s_add_u32 s22, s22, s3
    buffer_load_dwordx4 a[64:67], v5, s[8:11], s22 offen offset:0 sc1
    s_add_u32 s34, s34, 1
    v_mfma_f32_16x16x32_bf16 v[76:79], v[24:27], a[8:11], v[76:79]
    s_lshr_b32 s35, s34, 2
    s_lshl_b32 s35, s35, 11
    s_add_u32 s37, s33, s35
    v_mfma_f32_16x16x32_bf16 v[60:63], v[24:27], a[4:7], 0
    s_and_b32 s35, s34, 3
    s_lshl_b32 s35, s35, 8
    s_add_u32 s37, s37, s35
    v_mfma_f32_16x16x32_bf16 v[60:63], v[28:31], a[20:23], v[60:63]
    s_add_u32 s34, s34, 1
    s_lshr_b32 s35, s34, 2
    s_lshl_b32 s35, s35, 11
    v_mfma_f32_16x16x32_bf16 v[44:47], v[28:31], a[16:19], 0
    s_add_u32 s38, s33, s35
    ds_read_b64_tr_b16 v[28:29], v4 offset:4096
    ds_read_b64_tr_b16 v[30:31], v4 offset:4608
    v_mfma_f32_16x16x32_bf16 v[44:47], v[24:27], a[0:3], v[44:47]
    s_waitcnt lgkmcnt(2)
    ds_read_b64_tr_b16 v[24:25], v4 offset:0
    ds_read_b64_tr_b16 v[26:27], v4 offset:512
    v_mfma_f32_16x16x32_bf16 v[96:99], v[16:19], a[0:3], 0
    s_and_b32 s35, s34, 3
    buffer_load_dwordx4 a[68:71], v5, s[8:11], s22 offen offset:1024 sc1
    buffer_store_dwordx4 v[164:167], v197, s[8:11], 0 offen sc1
    v_mfma_f32_16x16x32_bf16 v[96:99], v[20:23], a[16:19], v[96:99]
    s_lshl_b32 s35, s35, 8
    s_add_u32 s38, s38, s35
    s_add_u32 s34, s34, 1
    v_mfma_f32_16x16x32_bf16 v[112:115], v[20:23], a[20:23], 0
    s_mov_b32 s40, 0xbfb8aa3b
    s_mov_b32 s41, 0x3eae1a93
    s_mov_b32 s47, 0xffff0000
    v_mfma_f32_16x16x32_bf16 v[112:115], v[16:19], a[4:7], v[112:115]
    s_mov_b32 s43, 0xffff
    buffer_load_dwordx4 a[72:75], v5, s[8:11], s22 offen offset:2048 sc1
    s_mov_b32 s42, -1
    v_mfma_f32_16x16x32_bf16 v[128:131], v[16:19], a[8:11], 0
    s_mov_b32 s100, -1
    s_add_u32 s101, s16, 1
    s_lshr_b32 s101, s101, 2
    v_mfma_f32_16x16x32_bf16 v[128:131], v[20:23], a[24:27], v[128:131]
    s_sub_u32 s101, s101, 1
    s_or_b32 s101, s101, 0xffff
    s_bfe_u32 s32, s2, 0x20001
    v_mfma_f32_16x16x32_bf16 v[144:147], v[20:23], a[28:31], 0
    s_and_b32 s33, s2, 1
    ds_read_b64_tr_b16 v[20:21], v3 offset:12288
    ds_read_b64_tr_b16 v[22:23], v3 offset:12800
    v_mfma_f32_16x16x32_bf16 v[144:147], v[16:19], a[12:15], v[144:147]
    s_waitcnt lgkmcnt(2)
    ds_read_b64_tr_b16 v[16:17], v3 offset:8192
    ds_read_b64_tr_b16 v[18:19], v3 offset:8704
    v_mfma_f32_16x16x32_bf16 v[148:151], v[24:27], a[12:15], 0
    s_lshr_b32 s34, s2, 5
    buffer_load_dwordx4 a[76:79], v5, s[8:11], s22 offen offset:3072 sc1
    s_lshl_b32 s33, s33, 3
    v_mfma_f32_16x16x32_bf16 v[148:151], v[28:31], a[28:31], v[148:151]
    s_add_u32 s33, s33, s34
    s_lshl_b32 s34, s33, 2
    s_add_u32 s34, s34, s16
    v_mfma_f32_16x16x32_bf16 v[132:135], v[28:31], a[24:27], 0
    s_lshl_b32 s93, s34, 8
    s_lshl_b32 s65, s32, 6
    s_add_u32 s65, s65, s34
    v_mfma_f32_16x16x32_bf16 v[132:135], v[24:27], a[8:11], v[132:135]
    s_mul_i32 s65, s65, 86144
    s_add_u32 s65, s65, 12124160
    s_lshr_b32 s67, s33, 1
    v_mfma_f32_16x16x32_bf16 v[116:119], v[24:27], a[4:7], 0
    s_add_u32 s22, s22, 4096
    buffer_load_dwordx4 a[80:83], v5, s[8:11], s22 offen offset:0 sc1
    s_lshl_b32 s67, s67, 2
    v_mfma_f32_16x16x32_bf16 v[116:119], v[28:31], a[20:23], v[116:119]
    buffer_store_dwordx4 v[168:171], v198, s[8:11], 0 offen sc1
    s_add_u32 s67, s67, s32
    v_mfma_f32_16x16x32_bf16 v[100:103], v[28:31], a[16:19], 0
    s_lshl_b32 s67, s67, 2
    ds_read_b64_tr_b16 v[28:29], v4 offset:12288
    ds_read_b64_tr_b16 v[30:31], v4 offset:12800
    v_mfma_f32_16x16x32_bf16 v[100:103], v[24:27], a[0:3], v[100:103]
    s_waitcnt lgkmcnt(2)
    ds_read_b64_tr_b16 v[24:25], v4 offset:8192
    ds_read_b64_tr_b16 v[26:27], v4 offset:8704
    v_mfma_f32_16x16x32_bf16 v[104:107], v[16:19], a[0:3], 0
    s_bfe_u32 s35, s34, 0x20001
    s_add_u32 s67, s67, s35
    s_lshl_b32 s67, s67, 9
    v_mfma_f32_16x16x32_bf16 v[104:107], v[20:23], a[16:19], v[104:107]
    s_bfe_u32 s35, s2, 0x20003
    buffer_load_dwordx4 a[84:87], v5, s[8:11], s22 offen offset:1024 sc1
    s_add_u32 s67, s67, 55476224
    v_mfma_f32_16x16x32_bf16 v[120:123], v[20:23], a[20:23], 0
    s_lshl_b32 s33, s33, 2
    s_add_u32 s33, s33, s35
    s_lshl_b32 s66, s32, 2
    v_mfma_f32_16x16x32_bf16 v[120:123], v[16:19], a[4:7], v[120:123]
    s_add_u32 s66, s66, s35
    s_mul_i32 s66, s66, 389120
    s_add_u32 s66, s66, s19
    v_mfma_f32_16x16x32_bf16 v[136:139], v[16:19], a[8:11], 0
    s_add_u32 s66, s66, 5894144
    s_mul_i32 s34, s34, 36864
    s_mul_i32 s35, s35, 288
    v_mfma_f32_16x16x32_bf16 v[136:139], v[20:23], a[24:27], v[136:139]
    buffer_load_dwordx4 a[88:91], v5, s[8:11], s22 offen offset:2048 sc1
    s_add_u32 s34, s34, s35
    v_mfma_f32_16x16x32_bf16 v[152:155], v[20:23], a[28:31], 0
    s_lshr_b32 s35, s32, 1
    ds_read_b64_tr_b16 v[20:21], v1 offset:20480
    ds_read_b64_tr_b16 v[22:23], v1 offset:20992
    v_mfma_f32_16x16x32_bf16 v[152:155], v[16:19], a[12:15], v[152:155]
    s_waitcnt lgkmcnt(2)
    ds_read_b64_tr_b16 v[16:17], v1 offset:16384
    ds_read_b64_tr_b16 v[18:19], v1 offset:16896
    v_mfma_f32_16x16x32_bf16 v[156:159], v[24:27], a[12:15], 0
    s_lshl_b32 s68, s32, 4
    buffer_store_dwordx4 v[172:175], v199, s[8:11], 0 offen sc1
    s_mul_i32 s35, s35, 18400
    v_mfma_f32_16x16x32_bf16 v[156:159], v[28:31], a[28:31], v[156:159]
    s_add_u32 s35, s35, s68
    s_add_u32 s35, s35, s34
    s_add_u32 s35, s35, 256
    v_mfma_f32_16x16x32_bf16 v[140:143], v[28:31], a[24:27], 0
    buffer_load_dwordx4 a[92:95], v5, s[8:11], s22 offen offset:3072 sc1
    s_lshl_b32 s68, s32, 6
    v_mfma_f32_16x16x32_bf16 v[140:143], v[24:27], a[8:11], v[140:143]
    s_add_u32 s34, s34, s68
    s_add_u32 s68, s34, 18432
    s_lshl_b32 s48, s33, 2
    v_mfma_f32_16x16x32_bf16 v[124:127], v[24:27], a[4:7], 0
    s_add_u32 s48, s48, s32
    s_lshl_b32 s48, s48, 2
    s_add_u32 s48, s48, s16
    v_mfma_f32_16x16x32_bf16 v[124:127], v[28:31], a[20:23], v[124:127]
    s_mul_i32 s48, s48, 2304
    s_add_u32 s48, s48, 53051392
    s_lshl_b32 s89, s18, 12
    v_mfma_f32_16x16x32_bf16 v[108:111], v[28:31], a[16:19], 0
    s_add_u32 m0, s19, 49152
    ds_read_b64_tr_b16 v[28:29], v2 offset:20480
    ds_read_b64_tr_b16 v[30:31], v2 offset:20992
    v_mfma_f32_16x16x32_bf16 v[108:111], v[24:27], a[0:3], v[108:111]
    s_waitcnt vmcnt(23) lgkmcnt(2)
    ds_read_b64_tr_b16 v[24:25], v2 offset:16384
    ds_read_b64_tr_b16 v[26:27], v2 offset:16896
    v_mfma_f32_16x16x32_bf16 v[32:35], v[16:19], a[32:35], v[32:35]
    s_waitcnt vmcnt(19)
    s_mul_i32 s20, s59, 589824
    s_add_u32 s20, s20, s26
    buffer_load_dwordx4 v6, s[12:15], s20 offen lds
    v_mfma_f32_16x16x32_bf16 v[32:35], v[20:23], a[48:51], v[32:35]
    s_waitcnt vmcnt(19)
    s_add_u32 s89, s89, 55540352
    s_add_u32 m0, s19, 53248
    v_mfma_f32_16x16x32_bf16 v[48:51], v[20:23], a[52:55], v[48:51]
    s_cmp_eq_u32 s18, 0
    s_cselect_b32 s89, 55540608, s89
    s_lshr_b32 s90, s17, 1
    v_mfma_f32_16x16x32_bf16 v[48:51], v[16:19], a[36:39], v[48:51]
    s_add_u32 s20, s20, 294912
    buffer_load_dwordx4 v6, s[12:15], s20 offen lds
    s_lshl_b32 s90, s90, 11
    v_mfma_f32_16x16x32_bf16 v[64:67], v[16:19], a[40:43], v[64:67]
    s_waitcnt vmcnt(19)
    buffer_store_dwordx4 v[176:179], v200, s[8:11], 0 offen sc1
    s_add_u32 s90, s90, 55574528
    v_mfma_f32_16x16x32_bf16 v[64:67], v[20:23], a[56:59], v[64:67]
    s_waitcnt vmcnt(19)
    s_lshl_b32 s79, s16, 4
    v_lshl_add_u32 v206, v5, 2, s79
    v_mfma_f32_16x16x32_bf16 v[80:83], v[20:23], a[60:63], v[80:83]
    s_add_u32 m0, s19, 57344
    ds_read_b64_tr_b16 v[20:21], v1 offset:28672
    ds_read_b64_tr_b16 v[22:23], v1 offset:29184
    v_mfma_f32_16x16x32_bf16 v[80:83], v[16:19], a[44:47], v[80:83]
    s_waitcnt lgkmcnt(2)
    ds_read_b64_tr_b16 v[16:17], v1 offset:24576
    ds_read_b64_tr_b16 v[18:19], v1 offset:25088
    v_mfma_f32_16x16x32_bf16 v[84:87], v[24:27], a[44:47], v[84:87]
    s_mul_i32 s21, s59, 589824
    s_add_u32 s21, s21, s26
    buffer_load_dwordx4 v6, s[96:99], s21 offen lds
    v_mfma_f32_16x16x32_bf16 v[84:87], v[28:31], a[60:63], v[84:87]
    s_lshl_b32 s22, s59, 13
    v_min_u32 v206, 624, v206
    v_mov_b32 v207, s90
    v_mfma_f32_16x16x32_bf16 v[68:71], v[28:31], a[56:59], v[68:71]
    s_add_u32 s22, s22, s3
    v_mov_b32 v208, s89
    v_cmp_gt_u32 vcc, 288, v206
    v_mfma_f32_16x16x32_bf16 v[68:71], v[24:27], a[40:43], v[68:71]
    v_lshlrev_b32 v206, 2, v206
    v_min_u32 v8, 1088, v206
    v_mfma_f32_16x16x32_bf16 v[52:55], v[24:27], a[36:39], v[52:55]
    s_lshr_b32 s49, s17, 2
    buffer_load_dwordx4 a[96:99], v5, s[8:11], s22 offen offset:0 sc1
    v_cndmask_b32 v207, v208, v207, vcc
    v_mfma_f32_16x16x32_bf16 v[52:55], v[28:31], a[52:55], v[52:55]
    s_lshl_b32 s49, s49, 11
    s_add_u32 s49, s49, 55605888
    v_cmp_gt_u32 vcc, 1408, v206
    v_mfma_f32_16x16x32_bf16 v[36:39], v[28:31], a[48:51], v[36:39]
    ds_read_b64_tr_b16 v[28:29], v2 offset:28672
    ds_read_b64_tr_b16 v[30:31], v2 offset:29184
    v_mfma_f32_16x16x32_bf16 v[36:39], v[24:27], a[32:35], v[36:39]
    s_waitcnt lgkmcnt(2)
    ds_read_b64_tr_b16 v[24:25], v2 offset:24576
    ds_read_b64_tr_b16 v[26:27], v2 offset:25088
    v_mfma_f32_16x16x32_bf16 v[40:43], v[16:19], a[32:35], v[40:43]
    buffer_store_dwordx4 v[180:183], v201, s[8:11], 0 offen sc1
    v_mov_b32 v208, s49
    v_mfma_f32_16x16x32_bf16 v[40:43], v[20:23], a[48:51], v[40:43]
    buffer_load_dwordx4 a[100:103], v5, s[8:11], s22 offen offset:1024 sc1
    v_cndmask_b32 v207, v208, v207, vcc
    v_mfma_f32_16x16x32_bf16 v[56:59], v[20:23], a[52:55], v[56:59]
    v_add_u32 v206, v206, v207
    s_mul_i32 s86, s2, 1561
    v_mfma_f32_16x16x32_bf16 v[56:59], v[16:19], a[36:39], v[56:59]
    s_lshr_b32 s86, s86, 16
    s_mul_i32 s87, s86, 42
    s_sub_u32 s87, s2, s87
    v_mfma_f32_16x16x32_bf16 v[72:75], v[16:19], a[40:43], v[72:75]
    s_sub_u32 s88, s87, 16
    s_lshl_b32 s88, s88, 2
    s_add_u32 s88, s88, s16
    v_mfma_f32_16x16x32_bf16 v[72:75], v[20:23], a[56:59], v[72:75]
    buffer_load_dwordx4 a[104:107], v5, s[8:11], s22 offen offset:2048 sc1
    s_mul_i32 s89, s88, 43
    v_mfma_f32_16x16x32_bf16 v[88:91], v[20:23], a[60:63], v[88:91]
    s_lshr_b32 s89, s89, 7
    ds_read_b64_tr_b16 v[20:21], v3 offset:20480
    ds_read_b64_tr_b16 v[22:23], v3 offset:20992
    v_mfma_f32_16x16x32_bf16 v[88:91], v[16:19], a[44:47], v[88:91]
    s_waitcnt lgkmcnt(2)
    ds_read_b64_tr_b16 v[16:17], v3 offset:16384
    ds_read_b64_tr_b16 v[18:19], v3 offset:16896
    v_mfma_f32_16x16x32_bf16 v[92:95], v[24:27], a[44:47], v[92:95]
    s_mul_i32 s90, s89, 3
    s_sub_u32 s88, s88, s90
    s_mul_i32 s88, s88, s88
    v_mfma_f32_16x16x32_bf16 v[92:95], v[28:31], a[60:63], v[92:95]
    s_lshl_b32 s88, s88, 2
    s_mul_i32 s89, s89, 18
    s_add_u32 s88, s88, s89
    v_mfma_f32_16x16x32_bf16 v[76:79], v[28:31], a[56:59], v[76:79]
    buffer_load_dwordx4 a[108:111], v5, s[8:11], s22 offen offset:3072 sc1
    s_mul_i32 s89, s86, 144
    v_mfma_f32_16x16x32_bf16 v[76:79], v[24:27], a[40:43], v[76:79]
    s_add_u32 s88, s88, s89
    s_lshl_b32 s89, s86, 2
    s_add_u32 s89, s89, s87
    v_mfma_f32_16x16x32_bf16 v[60:63], v[24:27], a[36:39], v[60:63]
    s_add_u32 s22, s22, 4096
    buffer_store_dwordx4 v[184:187], v202, s[8:11], 0 offen sc1
    s_lshl_b32 s89, s89, 1
    v_mfma_f32_16x16x32_bf16 v[60:63], v[28:31], a[52:55], v[60:63]
    s_add_u32 s89, s89, 212
    s_lshr_b32 s90, s16, 1
    s_add_u32 s89, s89, s90
    v_mfma_f32_16x16x32_bf16 v[44:47], v[28:31], a[48:51], v[44:47]
    s_lshl_b32 s89, s89, 2
    ds_read_b64_tr_b16 v[28:29], v4 offset:20480
    ds_read_b64_tr_b16 v[30:31], v4 offset:20992
    v_mfma_f32_16x16x32_bf16 v[44:47], v[24:27], a[32:35], v[44:47]
    s_waitcnt lgkmcnt(2)
    ds_read_b64_tr_b16 v[24:25], v4 offset:16384
    ds_read_b64_tr_b16 v[26:27], v4 offset:16896
    v_mfma_f32_16x16x32_bf16 v[96:99], v[16:19], a[32:35], v[96:99]
    buffer_load_dwordx4 a[112:115], v5, s[8:11], s22 offen offset:0 sc1
    s_and_b32 s90, s16, 1
    v_mfma_f32_16x16x32_bf16 v[96:99], v[20:23], a[48:51], v[96:99]
    s_add_u32 s89, s89, s90
    s_cmp_ge_u32 s87, 26
    s_cselect_b32 s90, 10, 0
    v_mfma_f32_16x16x32_bf16 v[112:115], v[20:23], a[52:55], v[112:115]
    s_sub_u32 s90, s87, s90
    s_and_b32 s91, s90, 7
    s_lshl_b32 s91, s91, 5
    v_mfma_f32_16x16x32_bf16 v[112:115], v[16:19], a[36:39], v[112:115]
    buffer_load_dwordx4 a[116:119], v5, s[8:11], s22 offen offset:1024 sc1
    s_and_b32 s90, s90, 24
    v_mfma_f32_16x16x32_bf16 v[128:131], v[16:19], a[40:43], v[128:131]
    s_add_u32 s90, s90, s91
    s_lshl_b32 s91, s86, 8
    s_add_u32 s90, s90, s91
    v_mfma_f32_16x16x32_bf16 v[128:131], v[20:23], a[56:59], v[128:131]
    s_add_u32 s90, s90, s16
    s_sub_u32 s91, s87, 22
    v_mfma_f32_16x16x32_bf16 v[144:147], v[20:23], a[60:63], v[144:147]
    ds_read_b64_tr_b16 v[20:21], v3 offset:28672
    ds_read_b64_tr_b16 v[22:23], v3 offset:29184
    v_mfma_f32_16x16x32_bf16 v[144:147], v[16:19], a[44:47], v[144:147]
    s_waitcnt lgkmcnt(2)
    ds_read_b64_tr_b16 v[16:17], v3 offset:24576
    ds_read_b64_tr_b16 v[18:19], v3 offset:25088
    v_mfma_f32_16x16x32_bf16 v[148:151], v[24:27], a[44:47], v[148:151]
    buffer_load_dwordx4 a[120:123], v5, s[8:11], s22 offen offset:2048 sc1
    buffer_store_dwordx4 v[188:191], v203, s[8:11], 0 offen sc1
    v_mfma_f32_16x16x32_bf16 v[148:151], v[28:31], a[60:63], v[148:151]
    s_cmp_lt_u32 s91, 4
    s_cselect_b32 s89, s89, s90
    s_cselect_b32 s81, 1, 3
    v_mfma_f32_16x16x32_bf16 v[132:135], v[28:31], a[56:59], v[132:135]
    s_lshl_b32 s89, s89, 2
    s_sub_u32 s91, s87, 16
    s_mov_b32 s6, 5308416
    v_mfma_f32_16x16x32_bf16 v[132:135], v[24:27], a[40:43], v[132:135]
    s_cmp_lt_u32 s91, 6
    s_cselect_b32 s88, s88, s89
    s_cselect_b32 s81, 1, s81
    v_mfma_f32_16x16x32_bf16 v[116:119], v[24:27], a[36:39], v[116:119]
    buffer_load_dwordx4 a[124:127], v5, s[8:11], s22 offen offset:3072 sc1
    v_mfma_f32_16x16x32_bf16 v[116:119], v[28:31], a[52:55], v[116:119]
    s_cmp_lt_u32 s91, 6
    s_cselect_b32 s4, s82, s84
    s_cselect_b32 s5, s83, s85
    v_mfma_f32_16x16x32_bf16 v[100:103], v[28:31], a[48:51], v[100:103]
    s_lshl_b32 s22, s60, 13
    ds_read_b64_tr_b16 v[28:29], v4 offset:28672
    ds_read_b64_tr_b16 v[30:31], v4 offset:29184
    v_mfma_f32_16x16x32_bf16 v[100:103], v[24:27], a[32:35], v[100:103]
    s_waitcnt lgkmcnt(2)
    ds_read_b64_tr_b16 v[24:25], v4 offset:24576
    ds_read_b64_tr_b16 v[26:27], v4 offset:25088
    v_mfma_f32_16x16x32_bf16 v[104:107], v[16:19], a[32:35], v[104:107]
    s_cmp_lt_u32 s91, 6
    s_cselect_b32 s6, 663552, s6
    s_mov_b32 s7, 0x00020000
    v_mfma_f32_16x16x32_bf16 v[104:107], v[20:23], a[48:51], v[104:107]
    s_add_u32 s22, s22, s3
    buffer_load_dwordx4 a[128:131], v5, s[8:11], s22 offen offset:0 sc1
    s_mul_i32 s88, s88, 1152
    v_mfma_f32_16x16x32_bf16 v[120:123], v[20:23], a[52:55], v[120:123]
    s_lshl_b32 s89, s86, 2
    s_add_u32 s89, s89, s16
    s_mul_i32 s90, s89, 389120
    v_mfma_f32_16x16x32_bf16 v[120:123], v[16:19], a[36:39], v[120:123]
    s_add_u32 s90, s90, 5898240
    v_mfma_f32_16x16x32_bf16 v[136:139], v[16:19], a[40:43], v[136:139]
    buffer_store_dwordx4 v[192:195], v204, s[8:11], 0 offen sc1
    v_mfma_f32_16x16x32_bf16 v[136:139], v[20:23], a[56:59], v[136:139]
    buffer_load_dwordx4 a[132:135], v5, s[8:11], s22 offen offset:1024 sc1
    v_mfma_f32_16x16x32_bf16 v[152:155], v[20:23], a[60:63], v[152:155]
    s_waitcnt vmcnt(29)
    s_barrier
    ds_read_b64_tr_b16 v[20:21], v1 offset:36864
    ds_read_b64_tr_b16 v[22:23], v1 offset:37376
    v_mfma_f32_16x16x32_bf16 v[152:155], v[16:19], a[44:47], v[152:155]
    s_waitcnt lgkmcnt(2)
    ds_read_b64_tr_b16 v[16:17], v1 offset:32768
    ds_read_b64_tr_b16 v[18:19], v1 offset:33280
    v_mfma_f32_16x16x32_bf16 v[156:159], v[24:27], a[44:47], v[156:159]
    s_cmp_ge_u32 s2, 168
    s_cselect_b32 s88, 1073741824, s88
    s_cselect_b32 s90, 1073741824, s90
    v_mfma_f32_16x16x32_bf16 v[156:159], v[28:31], a[60:63], v[156:159]
    s_mul_i32 s91, s87, 2048
    s_add_u32 s91, s91, 301056
    s_mul_i32 s83, s87, 2048
    v_mfma_f32_16x16x32_bf16 v[140:143], v[28:31], a[56:59], v[140:143]
    s_add_u32 m0, s19, 0
    s_add_u32 s21, s21, 294912
    buffer_load_dwordx4 v6, s[96:99], s21 offen lds
    v_mfma_f32_16x16x32_bf16 v[140:143], v[24:27], a[40:43], v[140:143]
    s_add_u32 s83, s83, 301056
    s_cmp_lt_u32 s87, 32
    s_cselect_b32 s91, s91, s83
    v_mfma_f32_16x16x32_bf16 v[124:127], v[24:27], a[36:39], v[124:127]
    s_add_u32 s74, s91, s90
    s_mul_i32 s91, s87, 5120
    s_add_u32 s91, s91, 1024
    v_mfma_f32_16x16x32_bf16 v[124:127], v[28:31], a[52:55], v[124:127]
    s_mul_i32 s83, s87, 3072
    s_add_u32 s83, s83, 66560
    v_mfma_f32_16x16x32_bf16 v[108:111], v[28:31], a[48:51], v[108:111]
    s_add_u32 m0, s19, 4096
    ds_read_b64_tr_b16 v[28:29], v2 offset:36864
    ds_read_b64_tr_b16 v[30:31], v2 offset:37376
    v_mfma_f32_16x16x32_bf16 v[108:111], v[24:27], a[32:35], v[108:111]
    s_waitcnt vmcnt(29) lgkmcnt(2)
    ds_read_b64_tr_b16 v[24:25], v2 offset:32768
    ds_read_b64_tr_b16 v[26:27], v2 offset:33280
    v_mfma_f32_16x16x32_bf16 v[32:35], v[16:19], a[64:67], v[32:35]
    s_waitcnt vmcnt(24)
    s_mul_i32 s20, s60, 589824
    s_add_u32 s20, s20, s26
    buffer_load_dwordx4 v6, s[12:15], s20 offen lds
    v_mfma_f32_16x16x32_bf16 v[32:35], v[20:23], a[80:83], v[32:35]
    s_waitcnt vmcnt(23)
    s_cmp_lt_u32 s87, 32
    s_cselect_b32 s91, s91, s83
    v_mfma_f32_16x16x32_bf16 v[48:51], v[20:23], a[84:87], v[48:51]
    s_add_u32 s75, s91, s90
    s_mul_i32 s91, s87, 5120
    s_add_u32 s91, s91, 3072
    v_mfma_f32_16x16x32_bf16 v[48:51], v[16:19], a[68:71], v[48:51]
    s_add_u32 m0, s19, 8192
    s_add_u32 s20, s20, 294912
    buffer_load_dwordx4 v6, s[12:15], s20 offen lds
    v_mfma_f32_16x16x32_bf16 v[64:67], v[16:19], a[72:75], v[64:67]
    s_waitcnt vmcnt(23)
    s_mul_i32 s83, s87, 2048
    s_add_u32 s83, s83, 129024
    v_mfma_f32_16x16x32_bf16 v[64:67], v[20:23], a[88:91], v[64:67]
    s_waitcnt vmcnt(21)
    s_cmp_lt_u32 s87, 32
    s_cselect_b32 s91, s91, s83
    v_mfma_f32_16x16x32_bf16 v[80:83], v[20:23], a[92:95], v[80:83]
    s_add_u32 m0, s19, 12288
    ds_read_b64_tr_b16 v[20:21], v1 offset:45056
    ds_read_b64_tr_b16 v[22:23], v1 offset:45568
    v_mfma_f32_16x16x32_bf16 v[80:83], v[16:19], a[76:79], v[80:83]
    s_waitcnt lgkmcnt(2)
    ds_read_b64_tr_b16 v[16:17], v1 offset:40960
    ds_read_b64_tr_b16 v[18:19], v1 offset:41472
    v_mfma_f32_16x16x32_bf16 v[84:87], v[24:27], a[76:79], v[84:87]
    s_mul_i32 s21, s60, 589824
    s_add_u32 s21, s21, s26
    buffer_load_dwordx4 v6, s[96:99], s21 offen lds
    v_mfma_f32_16x16x32_bf16 v[84:87], v[28:31], a[92:95], v[84:87]
    s_add_u32 s76, s91, s90
    s_mul_i32 s91, s87, 2048
    s_add_u32 s91, s91, 215040
    v_mfma_f32_16x16x32_bf16 v[68:71], v[28:31], a[88:91], v[68:71]
    s_mul_i32 s83, s87, 2048
    s_add_u32 s83, s83, 215040
    v_mfma_f32_16x16x32_bf16 v[68:71], v[24:27], a[72:75], v[68:71]
    s_cmp_lt_u32 s87, 32
    s_cselect_b32 s91, s91, s83
    s_add_u32 s77, s91, s90
    v_mfma_f32_16x16x32_bf16 v[52:55], v[24:27], a[68:71], v[52:55]
    s_add_u32 m0, s19, 16384
    s_add_u32 s21, s21, 294912
    buffer_load_dwordx4 v6, s[96:99], s21 offen lds
    v_mfma_f32_16x16x32_bf16 v[52:55], v[28:31], a[84:87], v[52:55]
    s_mul_i32 s91, s87, 5120
    s_add_u32 s91, s91, 0
    s_mul_i32 s83, s87, 3072
    v_mfma_f32_16x16x32_bf16 v[36:39], v[28:31], a[80:83], v[36:39]
    s_add_u32 s83, s83, 65536
    ds_read_b64_tr_b16 v[28:29], v2 offset:45056
    ds_read_b64_tr_b16 v[30:31], v2 offset:45568
    v_mfma_f32_16x16x32_bf16 v[36:39], v[24:27], a[64:67], v[36:39]
    s_waitcnt lgkmcnt(2)
    ds_read_b64_tr_b16 v[24:25], v2 offset:40960
    ds_read_b64_tr_b16 v[26:27], v2 offset:41472
    v_mfma_f32_16x16x32_bf16 v[40:43], v[16:19], a[64:67], v[40:43]
    s_cmp_lt_u32 s87, 32
    s_cselect_b32 s91, s91, s83
    s_add_u32 s78, s91, s90
    v_mfma_f32_16x16x32_bf16 v[40:43], v[20:23], a[80:83], v[40:43]
    buffer_load_dwordx4 a[136:139], v5, s[8:11], s22 offen offset:2048 sc1
    s_lshl_b32 s80, s2, 6
    v_mfma_f32_16x16x32_bf16 v[56:59], v[20:23], a[84:87], v[56:59]
    s_add_u32 s80, s80, 55623680
    s_lshl_b32 s91, s16, 28
    s_add_u32 s80, s80, s91
    v_mfma_f32_16x16x32_bf16 v[56:59], v[16:19], a[68:71], v[56:59]
    v_lshrrev_b32 v205, 7, v5
    v_and_b32 v13, 4, v205
    v_mfma_f32_16x16x32_bf16 v[72:75], v[16:19], a[72:75], v[72:75]
    v_mul_u32_u24 v13, s81, v13
    v_add_u32 v13, v13, v205
    v_mfma_f32_16x16x32_bf16 v[72:75], v[20:23], a[88:91], v[72:75]
    buffer_load_dwordx4 a[140:143], v5, s[8:11], s22 offen offset:3072 sc1
    v_mul_u32_u24 v13, 1152, v13
    v_mfma_f32_16x16x32_bf16 v[88:91], v[20:23], a[92:95], v[88:91]
    s_add_u32 s22, s22, 4096
    ds_read_b64_tr_b16 v[20:21], v3 offset:36864
    ds_read_b64_tr_b16 v[22:23], v3 offset:37376
    v_mfma_f32_16x16x32_bf16 v[88:91], v[16:19], a[76:79], v[88:91]
    s_waitcnt lgkmcnt(2)
    ds_read_b64_tr_b16 v[16:17], v3 offset:32768
    ds_read_b64_tr_b16 v[18:19], v3 offset:33280
    v_mfma_f32_16x16x32_bf16 v[92:95], v[24:27], a[76:79], v[92:95]
    s_lshl_b32 s82, s16, 12
    v_and_b32 v205, 0x70, v5
    v_add_u32 v13, v13, v205
    v_mfma_f32_16x16x32_bf16 v[92:95], v[28:31], a[92:95], v[92:95]
    s_add_u32 s82, s82, 55623680
    v_mfma_f32_16x16x32_bf16 v[76:79], v[28:31], a[88:91], v[76:79]
    buffer_load_dwordx4 a[144:147], v5, s[8:11], s22 offen offset:0 sc1
    v_mfma_f32_16x16x32_bf16 v[76:79], v[24:27], a[72:75], v[76:79]
    s_cmp_eq_u32 s2, 0
    s_cselect_b64 s[84:85], -1, 0
    s_cselect_b32 s82, s82, 1073741824
    v_mfma_f32_16x16x32_bf16 v[60:63], v[24:27], a[68:71], v[60:63]
    s_or_b32 s83, s2, s16
    s_cmp_eq_u32 s83, 0
    s_cselect_b32 s83, 0, 1073741824
    v_mfma_f32_16x16x32_bf16 v[60:63], v[28:31], a[84:87], v[60:63]
    s_add_u32 s83, s83, 55676928
    s_mul_i32 s89, s18, 294912
    s_sub_u32 s89, s89, 70656
    v_mfma_f32_16x16x32_bf16 v[44:47], v[28:31], a[80:83], v[44:47]
    ds_read_b64_tr_b16 v[28:29], v4 offset:36864
    ds_read_b64_tr_b16 v[30:31], v4 offset:37376
    v_mfma_f32_16x16x32_bf16 v[44:47], v[24:27], a[64:67], v[44:47]
    s_waitcnt lgkmcnt(2)
    ds_read_b64_tr_b16 v[24:25], v4 offset:32768
    ds_read_b64_tr_b16 v[26:27], v4 offset:33280
    v_mfma_f32_16x16x32_bf16 v[96:99], v[16:19], a[64:67], v[96:99]
    buffer_load_dwordx4 a[148:151], v5, s[8:11], s22 offen offset:1024 sc1
    v_mfma_f32_16x16x32_bf16 v[96:99], v[20:23], a[80:83], v[96:99]
    s_cmp_eq_u32 s18, 0
    s_cselect_b32 s89, 1073741824, s89
    s_lshl_b32 s50, s56, 1
    v_mfma_f32_16x16x32_bf16 v[112:115], v[20:23], a[84:87], v[112:115]
    s_add_u32 s50, s50, s16
    s_cmp_ge_u32 s50, 18
    s_cselect_b32 s23, 18, 0
    v_mfma_f32_16x16x32_bf16 v[112:115], v[16:19], a[68:71], v[112:115]
    buffer_load_dwordx4 a[152:155], v5, s[8:11], s22 offen offset:2048 sc1
    s_sub_u32 s23, s50, s23
    v_mfma_f32_16x16x32_bf16 v[128:131], v[16:19], a[72:75], v[128:131]
    s_lshl_b32 s23, s23, 12
    s_add_u32 s23, s23, s89
    s_add_u32 s50, s50, 4
    v_mfma_f32_16x16x32_bf16 v[128:131], v[20:23], a[88:91], v[128:131]
    s_cmp_ge_u32 s50, 18
    s_cselect_b32 s24, 18, 0
    s_sub_u32 s24, s50, s24
    v_mfma_f32_16x16x32_bf16 v[144:147], v[20:23], a[92:95], v[144:147]
    s_lshl_b32 s24, s24, 12
    ds_read_b64_tr_b16 v[20:21], v3 offset:45056
    ds_read_b64_tr_b16 v[22:23], v3 offset:45568
    v_mfma_f32_16x16x32_bf16 v[144:147], v[16:19], a[76:79], v[144:147]
    s_waitcnt lgkmcnt(2)
    ds_read_b64_tr_b16 v[16:17], v3 offset:40960
    ds_read_b64_tr_b16 v[18:19], v3 offset:41472
    v_mfma_f32_16x16x32_bf16 v[148:151], v[24:27], a[76:79], v[148:151]
    s_add_u32 s50, s50, 4
    buffer_load_dwordx4 a[156:159], v5, s[8:11], s22 offen offset:3072 sc1
    s_add_u32 s24, s24, s89
    v_mfma_f32_16x16x32_bf16 v[148:151], v[28:31], a[92:95], v[148:151]
    s_cmp_ge_u32 s50, 18
    s_cselect_b32 s29, 18, 0
    s_sub_u32 s29, s50, s29
    v_mfma_f32_16x16x32_bf16 v[132:135], v[28:31], a[88:91], v[132:135]
    s_lshl_b32 s29, s29, 12
    s_add_u32 s29, s29, s89
    s_add_u32 s50, s50, 4
    v_mfma_f32_16x16x32_bf16 v[132:135], v[24:27], a[72:75], v[132:135]
    s_cmp_ge_u32 s50, 18
    s_cselect_b32 s90, 18, 0
    s_sub_u32 s90, s50, s90
    v_mfma_f32_16x16x32_bf16 v[116:119], v[24:27], a[68:71], v[116:119]
    s_lshl_b32 s90, s90, 12
    s_add_u32 s90, s90, s89
    s_add_u32 s50, s50, 4
    v_mfma_f32_16x16x32_bf16 v[116:119], v[28:31], a[84:87], v[116:119]
    s_cmp_ge_u32 s50, 18
    s_cselect_b32 s91, 18, 0
    s_sub_u32 s91, s50, s91
    v_mfma_f32_16x16x32_bf16 v[100:103], v[28:31], a[80:83], v[100:103]
    s_add_u32 m0, s19, 20480
    ds_read_b64_tr_b16 v[28:29], v4 offset:45056
    ds_read_b64_tr_b16 v[30:31], v4 offset:45568
    v_mfma_f32_16x16x32_bf16 v[100:103], v[24:27], a[64:67], v[100:103]
    s_waitcnt lgkmcnt(2)
    s_mul_i32 s20, s61, 589824
    s_add_u32 s20, s20, s26
    ds_read_b64_tr_b16 v[24:25], v4 offset:40960
    ds_read_b64_tr_b16 v[26:27], v4 offset:41472
    buffer_load_dwordx4 v6, s[12:15], s20 offen lds
    v_mfma_f32_16x16x32_bf16 v[104:107], v[16:19], a[64:67], v[104:107]
    s_lshl_b32 s91, s91, 12
    s_add_u32 s91, s91, s89
    s_add_u32 s50, s50, 4
    v_mfma_f32_16x16x32_bf16 v[104:107], v[20:23], a[80:83], v[104:107]
    s_lshl_b32 s22, s61, 13
    s_add_u32 s22, s22, s3
    v_mfma_f32_16x16x32_bf16 v[120:123], v[20:23], a[84:87], v[120:123]
    buffer_load_dwordx4 a[160:163], v5, s[8:11], s22 offen offset:0 sc1
    v_mfma_f32_16x16x32_bf16 v[120:123], v[16:19], a[68:71], v[120:123]
    v_mfma_f32_16x16x32_bf16 v[136:139], v[16:19], a[72:75], v[136:139]
    v_mfma_f32_16x16x32_bf16 v[136:139], v[20:23], a[88:91], v[136:139]
    v_mfma_f32_16x16x32_bf16 v[152:155], v[20:23], a[92:95], v[152:155]
    s_waitcnt vmcnt(12)
    s_barrier
    ds_read_b64_tr_b16 v[20:21], v1 offset:53248
    ds_read_b64_tr_b16 v[22:23], v1 offset:53760
    v_mfma_f32_16x16x32_bf16 v[152:155], v[16:19], a[76:79], v[152:155]
    s_waitcnt lgkmcnt(2)
    ds_read_b64_tr_b16 v[16:17], v1 offset:49152
    ds_read_b64_tr_b16 v[18:19], v1 offset:49664
    v_mfma_f32_16x16x32_bf16 v[156:159], v[24:27], a[76:79], v[156:159]
    buffer_load_dwordx4 a[164:167], v5, s[8:11], s22 offen offset:1024 sc1
    v_mfma_f32_16x16x32_bf16 v[156:159], v[28:31], a[92:95], v[156:159]
    s_add_u32 m0, s19, 24576
    s_add_u32 s20, s20, 294912
    v_mfma_f32_16x16x32_bf16 v[140:143], v[28:31], a[88:91], v[140:143]
    v_mfma_f32_16x16x32_bf16 v[140:143], v[24:27], a[72:75], v[140:143]
    buffer_load_dwordx4 v6, s[12:15], s20 offen lds
    v_mfma_f32_16x16x32_bf16 v[124:127], v[24:27], a[68:71], v[124:127]
    s_add_u32 m0, s19, 28672
    s_mul_i32 s21, s61, 589824
    s_add_u32 s21, s21, s26
    v_mfma_f32_16x16x32_bf16 v[124:127], v[28:31], a[84:87], v[124:127]
    v_mfma_f32_16x16x32_bf16 v[108:111], v[28:31], a[80:83], v[108:111]
    ds_read_b64_tr_b16 v[28:29], v2 offset:53248
    ds_read_b64_tr_b16 v[30:31], v2 offset:53760
    v_mfma_f32_16x16x32_bf16 v[108:111], v[24:27], a[64:67], v[108:111]
    s_waitcnt lgkmcnt(2)
    ds_read_b64_tr_b16 v[24:25], v2 offset:49152
    ds_read_b64_tr_b16 v[26:27], v2 offset:49664
    v_mfma_f32_16x16x32_bf16 v[32:35], v[16:19], a[96:99], v[32:35]
    buffer_load_dwordx4 v6, s[96:99], s21 offen lds
    v_mfma_f32_16x16x32_bf16 v[32:35], v[20:23], a[112:115], v[32:35]
    s_add_u32 m0, s19, 32768
    s_add_u32 s21, s21, 294912
    v_mfma_f32_16x16x32_bf16 v[48:51], v[20:23], a[116:119], v[48:51]
    v_mfma_f32_16x16x32_bf16 v[48:51], v[16:19], a[100:103], v[48:51]
    v_mfma_f32_16x16x32_bf16 v[64:67], v[16:19], a[104:107], v[64:67]
    buffer_load_dwordx4 v6, s[96:99], s21 offen lds
    v_mfma_f32_16x16x32_bf16 v[64:67], v[20:23], a[120:123], v[64:67]
    v_mfma_f32_16x16x32_bf16 v[80:83], v[20:23], a[124:127], v[80:83]
    ds_read_b64_tr_b16 v[20:21], v1 offset:0
    ds_read_b64_tr_b16 v[22:23], v1 offset:512
    v_mfma_f32_16x16x32_bf16 v[80:83], v[16:19], a[108:111], v[80:83]
    s_waitcnt lgkmcnt(2)
    ds_read_b64_tr_b16 v[16:17], v1 offset:57344
    ds_read_b64_tr_b16 v[18:19], v1 offset:57856
    v_mfma_f32_16x16x32_bf16 v[84:87], v[24:27], a[108:111], v[84:87]
    buffer_store_dwordx2 v[218:219], off, s[8:11], s92 sc1
    v_mfma_f32_16x16x32_bf16 v[84:87], v[28:31], a[124:127], v[84:87]
    buffer_load_dwordx4 a[168:171], v5, s[8:11], s22 offen offset:2048 sc1
    v_mfma_f32_16x16x32_bf16 v[68:71], v[28:31], a[120:123], v[68:71]
    v_mfma_f32_16x16x32_bf16 v[68:71], v[24:27], a[104:107], v[68:71]
    v_mfma_f32_16x16x32_bf16 v[52:55], v[24:27], a[100:103], v[52:55]
    v_mfma_f32_16x16x32_bf16 v[52:55], v[28:31], a[116:119], v[52:55]
    buffer_load_dwordx4 a[172:175], v5, s[8:11], s22 offen offset:3072 sc1
    v_mfma_f32_16x16x32_bf16 v[36:39], v[28:31], a[112:115], v[36:39]
    s_add_u32 s22, s22, 4096
    ds_read_b64_tr_b16 v[28:29], v2 offset:0
    ds_read_b64_tr_b16 v[30:31], v2 offset:512
    v_mfma_f32_16x16x32_bf16 v[36:39], v[24:27], a[96:99], v[36:39]
    s_waitcnt lgkmcnt(2)
    ds_read_b64_tr_b16 v[24:25], v2 offset:57344
    ds_read_b64_tr_b16 v[26:27], v2 offset:57856
    v_mfma_f32_16x16x32_bf16 v[40:43], v[16:19], a[96:99], v[40:43]
    v_mfma_f32_16x16x32_bf16 v[40:43], v[20:23], a[112:115], v[40:43]
    v_mfma_f32_16x16x32_bf16 v[56:59], v[20:23], a[116:119], v[56:59]
    buffer_load_dwordx4 a[176:179], v5, s[8:11], s22 offen offset:0 sc1
    v_mfma_f32_16x16x32_bf16 v[56:59], v[16:19], a[100:103], v[56:59]
    v_mfma_f32_16x16x32_bf16 v[72:75], v[16:19], a[104:107], v[72:75]
    v_mfma_f32_16x16x32_bf16 v[72:75], v[20:23], a[120:123], v[72:75]
    v_mfma_f32_16x16x32_bf16 v[88:91], v[20:23], a[124:127], v[88:91]
    ds_read_b64_tr_b16 v[20:21], v3 offset:53248
    ds_read_b64_tr_b16 v[22:23], v3 offset:53760
    v_mfma_f32_16x16x32_bf16 v[88:91], v[16:19], a[108:111], v[88:91]
    s_waitcnt lgkmcnt(2)
    ds_read_b64_tr_b16 v[16:17], v3 offset:49152
    ds_read_b64_tr_b16 v[18:19], v3 offset:49664
    v_mfma_f32_16x16x32_bf16 v[92:95], v[24:27], a[108:111], v[92:95]
    buffer_load_dwordx4 a[180:183], v5, s[8:11], s22 offen offset:1024 sc1
    v_mfma_f32_16x16x32_bf16 v[92:95], v[28:31], a[124:127], v[92:95]
    v_mfma_f32_16x16x32_bf16 v[76:79], v[28:31], a[120:123], v[76:79]
    v_mfma_f32_16x16x32_bf16 v[76:79], v[24:27], a[104:107], v[76:79]
    buffer_load_dwordx4 a[184:187], v5, s[8:11], s22 offen offset:2048 sc1
    v_mfma_f32_16x16x32_bf16 v[60:63], v[24:27], a[100:103], v[60:63]
    v_mfma_f32_16x16x32_bf16 v[60:63], v[28:31], a[116:119], v[60:63]
    v_mfma_f32_16x16x32_bf16 v[44:47], v[28:31], a[112:115], v[44:47]
    ds_read_b64_tr_b16 v[28:29], v4 offset:53248
    ds_read_b64_tr_b16 v[30:31], v4 offset:53760
    v_mfma_f32_16x16x32_bf16 v[44:47], v[24:27], a[96:99], v[44:47]
    s_waitcnt lgkmcnt(2)
    ds_read_b64_tr_b16 v[24:25], v4 offset:49152
    ds_read_b64_tr_b16 v[26:27], v4 offset:49664
    v_mfma_f32_16x16x32_bf16 v[96:99], v[16:19], a[96:99], v[96:99]
    buffer_load_dwordx4 a[188:191], v5, s[8:11], s22 offen offset:3072 sc1
    v_mfma_f32_16x16x32_bf16 v[96:99], v[20:23], a[112:115], v[96:99]
    s_add_u32 m0, s19, 36864
    s_mul_i32 s20, s62, 589824
    s_add_u32 s20, s20, s26
    v_mfma_f32_16x16x32_bf16 v[112:115], v[20:23], a[116:119], v[112:115]
    v_mfma_f32_16x16x32_bf16 v[112:115], v[16:19], a[100:103], v[112:115]
    v_mfma_f32_16x16x32_bf16 v[128:131], v[16:19], a[104:107], v[128:131]
    buffer_load_dwordx4 v6, s[12:15], s20 offen lds
    v_mfma_f32_16x16x32_bf16 v[128:131], v[20:23], a[120:123], v[128:131]
    s_lshl_b32 s22, s62, 13
    s_add_u32 s22, s22, s3
    v_mfma_f32_16x16x32_bf16 v[144:147], v[20:23], a[124:127], v[144:147]
    ds_read_b64_tr_b16 v[20:21], v3 offset:0
    ds_read_b64_tr_b16 v[22:23], v3 offset:512
    v_mfma_f32_16x16x32_bf16 v[144:147], v[16:19], a[108:111], v[144:147]
    s_waitcnt lgkmcnt(2)
    ds_read_b64_tr_b16 v[16:17], v3 offset:57344
    ds_read_b64_tr_b16 v[18:19], v3 offset:57856
    v_mfma_f32_16x16x32_bf16 v[148:151], v[24:27], a[108:111], v[148:151]
    v_mfma_f32_16x16x32_bf16 v[148:151], v[28:31], a[124:127], v[148:151]
    buffer_load_dwordx4 a[192:195], v5, s[8:11], s22 offen offset:0 sc1
    v_mfma_f32_16x16x32_bf16 v[132:135], v[28:31], a[120:123], v[132:135]
    v_mfma_f32_16x16x32_bf16 v[132:135], v[24:27], a[104:107], v[132:135]
    v_mfma_f32_16x16x32_bf16 v[116:119], v[24:27], a[100:103], v[116:119]
    v_mfma_f32_16x16x32_bf16 v[116:119], v[28:31], a[116:119], v[116:119]
    buffer_load_dwordx4 a[196:199], v5, s[8:11], s22 offen offset:1024 sc1
    v_mfma_f32_16x16x32_bf16 v[100:103], v[28:31], a[112:115], v[100:103]
    ds_read_b64_tr_b16 v[28:29], v4 offset:0
    ds_read_b64_tr_b16 v[30:31], v4 offset:512
    v_mfma_f32_16x16x32_bf16 v[100:103], v[24:27], a[96:99], v[100:103]
    s_waitcnt lgkmcnt(2)
    ds_read_b64_tr_b16 v[24:25], v4 offset:57344
    ds_read_b64_tr_b16 v[26:27], v4 offset:57856
    v_mfma_f32_16x16x32_bf16 v[104:107], v[16:19], a[96:99], v[104:107]
    v_mfma_f32_16x16x32_bf16 v[104:107], v[20:23], a[112:115], v[104:107]
    v_mfma_f32_16x16x32_bf16 v[120:123], v[20:23], a[116:119], v[120:123]
    buffer_load_dwordx4 a[200:203], v5, s[8:11], s22 offen offset:2048 sc1
    v_mfma_f32_16x16x32_bf16 v[120:123], v[16:19], a[100:103], v[120:123]
    v_mfma_f32_16x16x32_bf16 v[136:139], v[16:19], a[104:107], v[136:139]
    v_mfma_f32_16x16x32_bf16 v[136:139], v[20:23], a[120:123], v[136:139]
    v_mfma_f32_16x16x32_bf16 v[152:155], v[20:23], a[124:127], v[152:155]
    s_waitcnt vmcnt(23)
    s_barrier
    ds_read_b64_tr_b16 v[20:21], v1 offset:8192
    ds_read_b64_tr_b16 v[22:23], v1 offset:8704
    v_mfma_f32_16x16x32_bf16 v[152:155], v[16:19], a[108:111], v[152:155]
    s_waitcnt lgkmcnt(2)
    ds_read_b64_tr_b16 v[16:17], v1 offset:4096
    ds_read_b64_tr_b16 v[18:19], v1 offset:4608
    v_mfma_f32_16x16x32_bf16 v[156:159], v[24:27], a[108:111], v[156:159]
    buffer_load_dwordx4 a[204:207], v5, s[8:11], s22 offen offset:3072 sc1
    v_mfma_f32_16x16x32_bf16 v[156:159], v[28:31], a[124:127], v[156:159]
    s_add_u32 m0, s19, 40960
    s_add_u32 s20, s20, 294912
    v_mfma_f32_16x16x32_bf16 v[140:143], v[28:31], a[120:123], v[140:143]
    v_mfma_f32_16x16x32_bf16 v[140:143], v[24:27], a[104:107], v[140:143]
    buffer_load_dwordx4 v6, s[12:15], s20 offen lds
    v_mfma_f32_16x16x32_bf16 v[124:127], v[24:27], a[100:103], v[124:127]
    s_add_u32 m0, s19, 45056
    s_mul_i32 s21, s62, 589824
    s_add_u32 s21, s21, s26
    v_mfma_f32_16x16x32_bf16 v[124:127], v[28:31], a[116:119], v[124:127]
    v_mfma_f32_16x16x32_bf16 v[108:111], v[28:31], a[112:115], v[108:111]
    ds_read_b64_tr_b16 v[28:29], v2 offset:8192
    ds_read_b64_tr_b16 v[30:31], v2 offset:8704
    v_mfma_f32_16x16x32_bf16 v[108:111], v[24:27], a[96:99], v[108:111]
    s_waitcnt lgkmcnt(2)
    ds_read_b64_tr_b16 v[24:25], v2 offset:4096
    ds_read_b64_tr_b16 v[26:27], v2 offset:4608
    v_mfma_f32_16x16x32_bf16 v[32:35], v[16:19], a[128:131], v[32:35]
    s_waitcnt vmcnt(22)
    buffer_load_dwordx4 v6, s[96:99], s21 offen lds
    v_mfma_f32_16x16x32_bf16 v[32:35], v[20:23], a[144:147], v[32:35]
    s_waitcnt vmcnt(22)
    s_add_u32 m0, s19, 49152
    s_add_u32 s21, s21, 294912
    v_mfma_f32_16x16x32_bf16 v[48:51], v[20:23], a[148:151], v[48:51]
    v_mfma_f32_16x16x32_bf16 v[48:51], v[16:19], a[132:135], v[48:51]
    v_mfma_f32_16x16x32_bf16 v[64:67], v[16:19], a[136:139], v[64:67]
    s_waitcnt vmcnt(21)
    buffer_load_dwordx4 v6, s[96:99], s21 offen lds
    v_mfma_f32_16x16x32_bf16 v[64:67], v[20:23], a[152:155], v[64:67]
    s_waitcnt vmcnt(21)
    s_add_u32 s22, s22, 4096
    v_mfma_f32_16x16x32_bf16 v[80:83], v[20:23], a[156:159], v[80:83]
    ds_read_b64_tr_b16 v[20:21], v1 offset:16384
    ds_read_b64_tr_b16 v[22:23], v1 offset:16896
    v_mfma_f32_16x16x32_bf16 v[80:83], v[16:19], a[140:143], v[80:83]
    s_waitcnt lgkmcnt(2)
    ds_read_b64_tr_b16 v[16:17], v1 offset:12288
    ds_read_b64_tr_b16 v[18:19], v1 offset:12800
    v_mfma_f32_16x16x32_bf16 v[84:87], v[24:27], a[140:143], v[84:87]
    v_mfma_f32_16x16x32_bf16 v[84:87], v[28:31], a[156:159], v[84:87]
    buffer_load_dwordx4 a[208:211], v5, s[8:11], s22 offen offset:0 sc1
    v_mfma_f32_16x16x32_bf16 v[68:71], v[28:31], a[152:155], v[68:71]
    v_mfma_f32_16x16x32_bf16 v[68:71], v[24:27], a[136:139], v[68:71]
    v_mfma_f32_16x16x32_bf16 v[52:55], v[24:27], a[132:135], v[52:55]
    v_mfma_f32_16x16x32_bf16 v[52:55], v[28:31], a[148:151], v[52:55]
    buffer_load_dwordx4 a[212:215], v5, s[8:11], s22 offen offset:1024 sc1
    v_mfma_f32_16x16x32_bf16 v[36:39], v[28:31], a[144:147], v[36:39]
    ds_read_b64_tr_b16 v[28:29], v2 offset:16384
    ds_read_b64_tr_b16 v[30:31], v2 offset:16896
    v_mfma_f32_16x16x32_bf16 v[36:39], v[24:27], a[128:131], v[36:39]
    s_waitcnt lgkmcnt(2)
    ds_read_b64_tr_b16 v[24:25], v2 offset:12288
    ds_read_b64_tr_b16 v[26:27], v2 offset:12800
    v_mfma_f32_16x16x32_bf16 v[40:43], v[16:19], a[128:131], v[40:43]
    v_mfma_f32_16x16x32_bf16 v[40:43], v[20:23], a[144:147], v[40:43]
    v_mfma_f32_16x16x32_bf16 v[56:59], v[20:23], a[148:151], v[56:59]
    buffer_load_dwordx4 a[216:219], v5, s[8:11], s22 offen offset:2048 sc1
    v_mfma_f32_16x16x32_bf16 v[56:59], v[16:19], a[132:135], v[56:59]
    v_mfma_f32_16x16x32_bf16 v[72:75], v[16:19], a[136:139], v[72:75]
    v_mfma_f32_16x16x32_bf16 v[72:75], v[20:23], a[152:155], v[72:75]
    v_mfma_f32_16x16x32_bf16 v[88:91], v[20:23], a[156:159], v[88:91]
    ds_read_b64_tr_b16 v[20:21], v3 offset:8192
    ds_read_b64_tr_b16 v[22:23], v3 offset:8704
    v_mfma_f32_16x16x32_bf16 v[88:91], v[16:19], a[140:143], v[88:91]
    s_waitcnt lgkmcnt(2)
    ds_read_b64_tr_b16 v[16:17], v3 offset:4096
    ds_read_b64_tr_b16 v[18:19], v3 offset:4608
    v_mfma_f32_16x16x32_bf16 v[92:95], v[24:27], a[140:143], v[92:95]
    buffer_load_dwordx4 a[220:223], v5, s[8:11], s22 offen offset:3072 sc1
    v_mfma_f32_16x16x32_bf16 v[92:95], v[28:31], a[156:159], v[92:95]
    s_add_u32 m0, s19, 53248
    s_mul_i32 s20, s63, 589824
    s_add_u32 s20, s20, s26
    v_mfma_f32_16x16x32_bf16 v[76:79], v[28:31], a[152:155], v[76:79]
    v_mfma_f32_16x16x32_bf16 v[76:79], v[24:27], a[136:139], v[76:79]
    buffer_load_dwordx4 v6, s[12:15], s20 offen lds
    v_mfma_f32_16x16x32_bf16 v[60:63], v[24:27], a[132:135], v[60:63]
    s_lshl_b32 s22, s63, 13
    s_add_u32 s22, s22, s3
    v_mfma_f32_16x16x32_bf16 v[60:63], v[28:31], a[148:151], v[60:63]
    v_mfma_f32_16x16x32_bf16 v[44:47], v[28:31], a[144:147], v[44:47]
    ds_read_b64_tr_b16 v[28:29], v4 offset:8192
    ds_read_b64_tr_b16 v[30:31], v4 offset:8704
    v_mfma_f32_16x16x32_bf16 v[44:47], v[24:27], a[128:131], v[44:47]
    s_waitcnt lgkmcnt(2)
    ds_read_b64_tr_b16 v[24:25], v4 offset:4096
    ds_read_b64_tr_b16 v[26:27], v4 offset:4608
    v_mfma_f32_16x16x32_bf16 v[96:99], v[16:19], a[128:131], v[96:99]
    buffer_load_dwordx4 a[224:227], v5, s[8:11], s22 offen offset:0 sc1
    v_mfma_f32_16x16x32_bf16 v[96:99], v[20:23], a[144:147], v[96:99]
    v_mfma_f32_16x16x32_bf16 v[112:115], v[20:23], a[148:151], v[112:115]
    v_mfma_f32_16x16x32_bf16 v[112:115], v[16:19], a[132:135], v[112:115]
    v_mfma_f32_16x16x32_bf16 v[128:131], v[16:19], a[136:139], v[128:131]
    buffer_load_dwordx4 a[228:231], v5, s[8:11], s22 offen offset:1024 sc1
    v_mfma_f32_16x16x32_bf16 v[128:131], v[20:23], a[152:155], v[128:131]
    v_mfma_f32_16x16x32_bf16 v[144:147], v[20:23], a[156:159], v[144:147]
    ds_read_b64_tr_b16 v[20:21], v3 offset:16384
    ds_read_b64_tr_b16 v[22:23], v3 offset:16896
    v_mfma_f32_16x16x32_bf16 v[144:147], v[16:19], a[140:143], v[144:147]
    s_waitcnt lgkmcnt(2)
    ds_read_b64_tr_b16 v[16:17], v3 offset:12288
    ds_read_b64_tr_b16 v[18:19], v3 offset:12800
    v_mfma_f32_16x16x32_bf16 v[148:151], v[24:27], a[140:143], v[148:151]
    v_mfma_f32_16x16x32_bf16 v[148:151], v[28:31], a[156:159], v[148:151]
    buffer_load_dwordx4 a[232:235], v5, s[8:11], s22 offen offset:2048 sc1
    v_mfma_f32_16x16x32_bf16 v[132:135], v[28:31], a[152:155], v[132:135]
    v_mfma_f32_16x16x32_bf16 v[132:135], v[24:27], a[136:139], v[132:135]
    v_mfma_f32_16x16x32_bf16 v[116:119], v[24:27], a[132:135], v[116:119]
    v_mfma_f32_16x16x32_bf16 v[116:119], v[28:31], a[148:151], v[116:119]
    buffer_load_dwordx4 a[236:239], v5, s[8:11], s22 offen offset:3072 sc1
    v_mfma_f32_16x16x32_bf16 v[100:103], v[28:31], a[144:147], v[100:103]
    s_add_u32 s22, s22, 4096
    ds_read_b64_tr_b16 v[28:29], v4 offset:16384
    ds_read_b64_tr_b16 v[30:31], v4 offset:16896
    v_mfma_f32_16x16x32_bf16 v[100:103], v[24:27], a[128:131], v[100:103]
    s_waitcnt lgkmcnt(2)
    ds_read_b64_tr_b16 v[24:25], v4 offset:12288
    ds_read_b64_tr_b16 v[26:27], v4 offset:12800
    v_mfma_f32_16x16x32_bf16 v[104:107], v[16:19], a[128:131], v[104:107]
    v_mfma_f32_16x16x32_bf16 v[104:107], v[20:23], a[144:147], v[104:107]
    v_mfma_f32_16x16x32_bf16 v[120:123], v[20:23], a[148:151], v[120:123]
    buffer_load_dwordx4 a[240:243], v5, s[8:11], s22 offen offset:0 sc1
    v_mfma_f32_16x16x32_bf16 v[120:123], v[16:19], a[132:135], v[120:123]
    v_mfma_f32_16x16x32_bf16 v[136:139], v[16:19], a[136:139], v[136:139]
    v_mfma_f32_16x16x32_bf16 v[136:139], v[20:23], a[152:155], v[136:139]
    v_mfma_f32_16x16x32_bf16 v[152:155], v[20:23], a[156:159], v[152:155]
    s_waitcnt vmcnt(25)
    s_barrier
    ds_read_b64_tr_b16 v[20:21], v1 offset:24576
    ds_read_b64_tr_b16 v[22:23], v1 offset:25088
    v_mfma_f32_16x16x32_bf16 v[152:155], v[16:19], a[140:143], v[152:155]
    s_waitcnt lgkmcnt(2)
    ds_read_b64_tr_b16 v[16:17], v1 offset:20480
    ds_read_b64_tr_b16 v[18:19], v1 offset:20992
    v_mfma_f32_16x16x32_bf16 v[156:159], v[24:27], a[140:143], v[156:159]
    buffer_load_dwordx4 a[244:247], v5, s[8:11], s22 offen offset:1024 sc1
    v_mfma_f32_16x16x32_bf16 v[156:159], v[28:31], a[156:159], v[156:159]
    s_add_u32 m0, s19, 57344
    s_add_u32 s20, s20, 294912
    v_mfma_f32_16x16x32_bf16 v[140:143], v[28:31], a[152:155], v[140:143]
    v_mfma_f32_16x16x32_bf16 v[140:143], v[24:27], a[136:139], v[140:143]
    buffer_load_dwordx4 v6, s[12:15], s20 offen lds
    v_mfma_f32_16x16x32_bf16 v[124:127], v[24:27], a[132:135], v[124:127]
    s_add_u32 m0, s19, 0
    s_mul_i32 s21, s63, 589824
    s_add_u32 s21, s21, s26
    v_mfma_f32_16x16x32_bf16 v[124:127], v[28:31], a[148:151], v[124:127]
    v_mfma_f32_16x16x32_bf16 v[108:111], v[28:31], a[144:147], v[108:111]
    ds_read_b64_tr_b16 v[28:29], v2 offset:24576
    ds_read_b64_tr_b16 v[30:31], v2 offset:25088
    v_mfma_f32_16x16x32_bf16 v[108:111], v[24:27], a[128:131], v[108:111]
    s_waitcnt lgkmcnt(2)
    ds_read_b64_tr_b16 v[24:25], v2 offset:20480
    ds_read_b64_tr_b16 v[26:27], v2 offset:20992
    v_mfma_f32_16x16x32_bf16 v[32:35], v[16:19], a[160:163], v[32:35]
    s_waitcnt vmcnt(23)
    buffer_load_dwordx4 v6, s[96:99], s21 offen lds
    v_mfma_f32_16x16x32_bf16 v[32:35], v[20:23], a[176:179], v[32:35]
    s_waitcnt vmcnt(23)
    s_add_u32 m0, s19, 4096
    s_add_u32 s21, s21, 294912
    v_mfma_f32_16x16x32_bf16 v[48:51], v[20:23], a[180:183], v[48:51]
    v_mfma_f32_16x16x32_bf16 v[48:51], v[16:19], a[164:167], v[48:51]
    v_mfma_f32_16x16x32_bf16 v[64:67], v[16:19], a[168:171], v[64:67]
    s_waitcnt vmcnt(22)
    buffer_load_dwordx4 v6, s[96:99], s21 offen lds
    v_mfma_f32_16x16x32_bf16 v[64:67], v[20:23], a[184:187], v[64:67]
    s_waitcnt vmcnt(22)
    v_mfma_f32_16x16x32_bf16 v[80:83], v[20:23], a[188:191], v[80:83]
    ds_read_b64_tr_b16 v[20:21], v1 offset:32768
    ds_read_b64_tr_b16 v[22:23], v1 offset:33280
    v_mfma_f32_16x16x32_bf16 v[80:83], v[16:19], a[172:175], v[80:83]
    s_waitcnt lgkmcnt(2)
    ds_read_b64_tr_b16 v[16:17], v1 offset:28672
    ds_read_b64_tr_b16 v[18:19], v1 offset:29184
    v_mfma_f32_16x16x32_bf16 v[84:87], v[24:27], a[172:175], v[84:87]
    v_mfma_f32_16x16x32_bf16 v[84:87], v[28:31], a[188:191], v[84:87]
    buffer_load_dwordx4 a[248:251], v5, s[8:11], s22 offen offset:2048 sc1
    v_mfma_f32_16x16x32_bf16 v[68:71], v[28:31], a[184:187], v[68:71]
    v_mfma_f32_16x16x32_bf16 v[68:71], v[24:27], a[168:171], v[68:71]
    v_mfma_f32_16x16x32_bf16 v[52:55], v[24:27], a[164:167], v[52:55]
    v_mfma_f32_16x16x32_bf16 v[52:55], v[28:31], a[180:183], v[52:55]
    buffer_load_dwordx4 a[252:255], v5, s[8:11], s22 offen offset:3072 sc1
    v_mfma_f32_16x16x32_bf16 v[36:39], v[28:31], a[176:179], v[36:39]
    s_add_u32 m0, s19, 8192
    ds_read_b64_tr_b16 v[28:29], v2 offset:32768
    ds_read_b64_tr_b16 v[30:31], v2 offset:33280
    v_mfma_f32_16x16x32_bf16 v[36:39], v[24:27], a[160:163], v[36:39]
    s_waitcnt lgkmcnt(2)
    ds_read_b64_tr_b16 v[24:25], v2 offset:28672
    ds_read_b64_tr_b16 v[26:27], v2 offset:29184
    v_mfma_f32_16x16x32_bf16 v[40:43], v[16:19], a[160:163], v[40:43]
    s_mul_i32 s20, s64, 589824
    s_add_u32 s20, s20, s26
    v_mfma_f32_16x16x32_bf16 v[40:43], v[20:23], a[176:179], v[40:43]
    v_mfma_f32_16x16x32_bf16 v[56:59], v[20:23], a[180:183], v[56:59]
    buffer_load_dwordx4 v6, s[12:15], s20 offen lds
    v_mfma_f32_16x16x32_bf16 v[56:59], v[16:19], a[164:167], v[56:59]
    s_lshl_b32 s22, s64, 13
    s_add_u32 s22, s22, s3
    v_mfma_f32_16x16x32_bf16 v[72:75], v[16:19], a[168:171], v[72:75]
    v_mfma_f32_16x16x32_bf16 v[72:75], v[20:23], a[184:187], v[72:75]
    v_mfma_f32_16x16x32_bf16 v[88:91], v[20:23], a[188:191], v[88:91]
    ds_read_b64_tr_b16 v[20:21], v3 offset:24576
    ds_read_b64_tr_b16 v[22:23], v3 offset:25088
    v_mfma_f32_16x16x32_bf16 v[88:91], v[16:19], a[172:175], v[88:91]
    s_waitcnt lgkmcnt(2)
    ds_read_b64_tr_b16 v[16:17], v3 offset:20480
    ds_read_b64_tr_b16 v[18:19], v3 offset:20992
    v_mfma_f32_16x16x32_bf16 v[92:95], v[24:27], a[172:175], v[92:95]
    buffer_load_dwordx4 v[224:227], v5, s[8:11], s22 offen offset:0 sc1
    v_mfma_f32_16x16x32_bf16 v[92:95], v[28:31], a[188:191], v[92:95]
    v_mfma_f32_16x16x32_bf16 v[76:79], v[28:31], a[184:187], v[76:79]
    v_mfma_f32_16x16x32_bf16 v[76:79], v[24:27], a[168:171], v[76:79]
    buffer_load_dwordx4 v[228:231], v5, s[8:11], s22 offen offset:1024 sc1
    v_mfma_f32_16x16x32_bf16 v[60:63], v[24:27], a[164:167], v[60:63]
    v_mfma_f32_16x16x32_bf16 v[60:63], v[28:31], a[180:183], v[60:63]
    v_mfma_f32_16x16x32_bf16 v[44:47], v[28:31], a[176:179], v[44:47]
    ds_read_b64_tr_b16 v[28:29], v4 offset:24576
    ds_read_b64_tr_b16 v[30:31], v4 offset:25088
    v_mfma_f32_16x16x32_bf16 v[44:47], v[24:27], a[160:163], v[44:47]
    s_waitcnt lgkmcnt(2)
    ds_read_b64_tr_b16 v[24:25], v4 offset:20480
    ds_read_b64_tr_b16 v[26:27], v4 offset:20992
    v_mfma_f32_16x16x32_bf16 v[96:99], v[16:19], a[160:163], v[96:99]
    buffer_load_dwordx4 v[232:235], v5, s[8:11], s22 offen offset:2048 sc1
    buffer_load_dwordx2 v[210:211], v206, s[8:11], 0 offen sc1
    v_mfma_f32_16x16x32_bf16 v[96:99], v[20:23], a[176:179], v[96:99]
    v_mfma_f32_16x16x32_bf16 v[112:115], v[20:23], a[180:183], v[112:115]
    v_mfma_f32_16x16x32_bf16 v[112:115], v[16:19], a[164:167], v[112:115]
    v_mfma_f32_16x16x32_bf16 v[128:131], v[16:19], a[168:171], v[128:131]
    buffer_load_dwordx4 v[236:239], v5, s[8:11], s22 offen offset:3072 sc1
    v_mfma_f32_16x16x32_bf16 v[128:131], v[20:23], a[184:187], v[128:131]
    s_add_u32 s22, s22, 4096
    v_mfma_f32_16x16x32_bf16 v[144:147], v[20:23], a[188:191], v[144:147]
    ds_read_b64_tr_b16 v[20:21], v3 offset:32768
    ds_read_b64_tr_b16 v[22:23], v3 offset:33280
    v_mfma_f32_16x16x32_bf16 v[144:147], v[16:19], a[172:175], v[144:147]
    s_waitcnt lgkmcnt(2)
    ds_read_b64_tr_b16 v[16:17], v3 offset:28672
    ds_read_b64_tr_b16 v[18:19], v3 offset:29184
    v_mfma_f32_16x16x32_bf16 v[148:151], v[24:27], a[172:175], v[148:151]
    v_mfma_f32_16x16x32_bf16 v[148:151], v[28:31], a[188:191], v[148:151]
    buffer_load_dwordx4 v[240:243], v5, s[8:11], s22 offen offset:0 sc1
    v_mfma_f32_16x16x32_bf16 v[132:135], v[28:31], a[184:187], v[132:135]
    v_mfma_f32_16x16x32_bf16 v[132:135], v[24:27], a[168:171], v[132:135]
    v_mfma_f32_16x16x32_bf16 v[116:119], v[24:27], a[164:167], v[116:119]
    v_mfma_f32_16x16x32_bf16 v[116:119], v[28:31], a[180:183], v[116:119]
    buffer_load_dwordx4 v[244:247], v5, s[8:11], s22 offen offset:1024 sc1
    v_mfma_f32_16x16x32_bf16 v[100:103], v[28:31], a[176:179], v[100:103]
    ds_read_b64_tr_b16 v[28:29], v4 offset:32768
    ds_read_b64_tr_b16 v[30:31], v4 offset:33280
    v_mfma_f32_16x16x32_bf16 v[100:103], v[24:27], a[160:163], v[100:103]
    s_waitcnt lgkmcnt(2)
    ds_read_b64_tr_b16 v[24:25], v4 offset:28672
    ds_read_b64_tr_b16 v[26:27], v4 offset:29184
    v_mfma_f32_16x16x32_bf16 v[104:107], v[16:19], a[160:163], v[104:107]
    v_mfma_f32_16x16x32_bf16 v[104:107], v[20:23], a[176:179], v[104:107]
    v_mfma_f32_16x16x32_bf16 v[120:123], v[20:23], a[180:183], v[120:123]
    buffer_load_dwordx4 v[248:251], v5, s[8:11], s22 offen offset:2048 sc1
    v_mfma_f32_16x16x32_bf16 v[120:123], v[16:19], a[164:167], v[120:123]
    v_mfma_f32_16x16x32_bf16 v[136:139], v[16:19], a[168:171], v[136:139]
    v_mfma_f32_16x16x32_bf16 v[136:139], v[20:23], a[184:187], v[136:139]
    v_mfma_f32_16x16x32_bf16 v[152:155], v[20:23], a[188:191], v[152:155]
    s_waitcnt vmcnt(25)
    s_barrier
    ds_read_b64_tr_b16 v[20:21], v1 offset:40960
    ds_read_b64_tr_b16 v[22:23], v1 offset:41472
    v_mfma_f32_16x16x32_bf16 v[152:155], v[16:19], a[172:175], v[152:155]
    s_waitcnt lgkmcnt(2)
    ds_read_b64_tr_b16 v[16:17], v1 offset:36864
    ds_read_b64_tr_b16 v[18:19], v1 offset:37376
    v_mfma_f32_16x16x32_bf16 v[156:159], v[24:27], a[172:175], v[156:159]
    buffer_load_dwordx4 v[252:255], v5, s[8:11], s22 offen offset:3072 sc1
    v_mfma_f32_16x16x32_bf16 v[156:159], v[28:31], a[188:191], v[156:159]
    s_add_u32 m0, s19, 12288
    s_add_u32 s20, s20, 294912
    v_mfma_f32_16x16x32_bf16 v[140:143], v[28:31], a[184:187], v[140:143]
    v_mfma_f32_16x16x32_bf16 v[140:143], v[24:27], a[168:171], v[140:143]
    v_mfma_f32_16x16x32_bf16 v[124:127], v[24:27], a[164:167], v[124:127]
    v_mfma_f32_16x16x32_bf16 v[124:127], v[28:31], a[180:183], v[124:127]
    buffer_load_dwordx4 v6, s[12:15], s20 offen lds
    v_mfma_f32_16x16x32_bf16 v[108:111], v[28:31], a[176:179], v[108:111]
    s_add_u32 m0, s19, 16384
    ds_read_b64_tr_b16 v[28:29], v2 offset:40960
    ds_read_b64_tr_b16 v[30:31], v2 offset:41472
    v_mfma_f32_16x16x32_bf16 v[108:111], v[24:27], a[160:163], v[108:111]
    s_waitcnt lgkmcnt(2)
    ds_read_b64_tr_b16 v[24:25], v2 offset:36864
    ds_read_b64_tr_b16 v[26:27], v2 offset:37376
    v_mfma_f32_16x16x32_bf16 v[32:35], v[16:19], a[192:195], v[32:35]
    s_waitcnt vmcnt(26)
    s_mul_i32 s21, s64, 589824
    s_add_u32 s21, s21, s26
    v_mfma_f32_16x16x32_bf16 v[32:35], v[20:23], a[208:211], v[32:35]
    s_waitcnt vmcnt(25)
    v_mfma_f32_16x16x32_bf16 v[48:51], v[20:23], a[212:215], v[48:51]
    v_mfma_f32_16x16x32_bf16 v[48:51], v[16:19], a[196:199], v[48:51]
    buffer_load_dwordx4 v6, s[96:99], s21 offen lds
    v_mfma_f32_16x16x32_bf16 v[64:67], v[16:19], a[200:203], v[64:67]
    s_waitcnt vmcnt(25)
    s_add_u32 m0, s19, 20480
    s_add_u32 s21, s21, 294912
    v_mfma_f32_16x16x32_bf16 v[64:67], v[20:23], a[216:219], v[64:67]
    s_waitcnt vmcnt(24)
    v_mfma_f32_16x16x32_bf16 v[80:83], v[20:23], a[220:223], v[80:83]
    ds_read_b64_tr_b16 v[20:21], v1 offset:49152
    ds_read_b64_tr_b16 v[22:23], v1 offset:49664
    v_mfma_f32_16x16x32_bf16 v[80:83], v[16:19], a[204:207], v[80:83]
    s_waitcnt lgkmcnt(2)
    ds_read_b64_tr_b16 v[16:17], v1 offset:45056
    ds_read_b64_tr_b16 v[18:19], v1 offset:45568
    v_mfma_f32_16x16x32_bf16 v[84:87], v[24:27], a[204:207], v[84:87]
    v_mfma_f32_16x16x32_bf16 v[84:87], v[28:31], a[220:223], v[84:87]
    buffer_load_dwordx4 v6, s[96:99], s21 offen lds
    v_mfma_f32_16x16x32_bf16 v[68:71], v[28:31], a[216:219], v[68:71]
    v_mfma_f32_16x16x32_bf16 v[68:71], v[24:27], a[200:203], v[68:71]
    v_mfma_f32_16x16x32_bf16 v[52:55], v[24:27], a[196:199], v[52:55]
    v_mfma_f32_16x16x32_bf16 v[52:55], v[28:31], a[212:215], v[52:55]
    v_mfma_f32_16x16x32_bf16 v[36:39], v[28:31], a[208:211], v[36:39]
    ds_read_b64_tr_b16 v[28:29], v2 offset:49152
    ds_read_b64_tr_b16 v[30:31], v2 offset:49664
    v_mfma_f32_16x16x32_bf16 v[36:39], v[24:27], a[192:195], v[36:39]
    s_waitcnt lgkmcnt(2)
    ds_read_b64_tr_b16 v[24:25], v2 offset:45056
    ds_read_b64_tr_b16 v[26:27], v2 offset:45568
    v_mfma_f32_16x16x32_bf16 v[40:43], v[16:19], a[192:195], v[40:43]
    v_mfma_f32_16x16x32_bf16 v[40:43], v[20:23], a[208:211], v[40:43]
    v_mfma_f32_16x16x32_bf16 v[56:59], v[20:23], a[212:215], v[56:59]
    v_mfma_f32_16x16x32_bf16 v[56:59], v[16:19], a[196:199], v[56:59]
    v_mfma_f32_16x16x32_bf16 v[72:75], v[16:19], a[200:203], v[72:75]
    v_mfma_f32_16x16x32_bf16 v[72:75], v[20:23], a[216:219], v[72:75]
    v_mfma_f32_16x16x32_bf16 v[88:91], v[20:23], a[220:223], v[88:91]
    ds_read_b64_tr_b16 v[20:21], v3 offset:40960
    ds_read_b64_tr_b16 v[22:23], v3 offset:41472
    v_mfma_f32_16x16x32_bf16 v[88:91], v[16:19], a[204:207], v[88:91]
    s_waitcnt lgkmcnt(2)
    ds_read_b64_tr_b16 v[16:17], v3 offset:36864
    ds_read_b64_tr_b16 v[18:19], v3 offset:37376
    v_mfma_f32_16x16x32_bf16 v[92:95], v[24:27], a[204:207], v[92:95]
    v_mfma_f32_16x16x32_bf16 v[92:95], v[28:31], a[220:223], v[92:95]
    v_mfma_f32_16x16x32_bf16 v[76:79], v[28:31], a[216:219], v[76:79]
    v_mfma_f32_16x16x32_bf16 v[76:79], v[24:27], a[200:203], v[76:79]
    v_mfma_f32_16x16x32_bf16 v[60:63], v[24:27], a[196:199], v[60:63]
    v_mfma_f32_16x16x32_bf16 v[60:63], v[28:31], a[212:215], v[60:63]
    v_mfma_f32_16x16x32_bf16 v[44:47], v[28:31], a[208:211], v[44:47]
    ds_read_b64_tr_b16 v[28:29], v4 offset:40960
    ds_read_b64_tr_b16 v[30:31], v4 offset:41472
    v_mfma_f32_16x16x32_bf16 v[44:47], v[24:27], a[192:195], v[44:47]
    s_waitcnt lgkmcnt(2)
    ds_read_b64_tr_b16 v[24:25], v4 offset:36864
    ds_read_b64_tr_b16 v[26:27], v4 offset:37376
    v_mfma_f32_16x16x32_bf16 v[96:99], v[16:19], a[192:195], v[96:99]
    v_mfma_f32_16x16x32_bf16 v[96:99], v[20:23], a[208:211], v[96:99]
    v_mfma_f32_16x16x32_bf16 v[112:115], v[20:23], a[212:215], v[112:115]
    v_mfma_f32_16x16x32_bf16 v[112:115], v[16:19], a[196:199], v[112:115]
    v_mfma_f32_16x16x32_bf16 v[128:131], v[16:19], a[200:203], v[128:131]
    v_mfma_f32_16x16x32_bf16 v[128:131], v[20:23], a[216:219], v[128:131]
    v_mfma_f32_16x16x32_bf16 v[144:147], v[20:23], a[220:223], v[144:147]
    ds_read_b64_tr_b16 v[20:21], v3 offset:49152
    ds_read_b64_tr_b16 v[22:23], v3 offset:49664
    v_mfma_f32_16x16x32_bf16 v[144:147], v[16:19], a[204:207], v[144:147]
    s_waitcnt lgkmcnt(2)
    ds_read_b64_tr_b16 v[16:17], v3 offset:45056
    ds_read_b64_tr_b16 v[18:19], v3 offset:45568
    v_mfma_f32_16x16x32_bf16 v[148:151], v[24:27], a[204:207], v[148:151]
    v_mfma_f32_16x16x32_bf16 v[148:151], v[28:31], a[220:223], v[148:151]
    v_mfma_f32_16x16x32_bf16 v[132:135], v[28:31], a[216:219], v[132:135]
    v_mfma_f32_16x16x32_bf16 v[132:135], v[24:27], a[200:203], v[132:135]
    s_waitcnt vmcnt(8)
    v_cmp_ne_u64 vcc, s[44:45], v[210:211]
    s_nop 0
    s_cbranch_vccnz LS_q
LB_q:
    v_mfma_f32_16x16x32_bf16 v[116:119], v[24:27], a[196:199], v[116:119]
    v_lshl_add_u32 v8, v5, 2, s79
    v_mfma_f32_16x16x32_bf16 v[116:119], v[28:31], a[212:215], v[116:119]
    v_min_u32 v8, 720, v8
    v_mfma_f32_16x16x32_bf16 v[100:103], v[28:31], a[208:211], v[100:103]
    ds_read_b64_tr_b16 v[28:29], v4 offset:49152
    ds_read_b64_tr_b16 v[30:31], v4 offset:49664
    v_mfma_f32_16x16x32_bf16 v[100:103], v[24:27], a[192:195], v[100:103]
    s_waitcnt lgkmcnt(2)
    ds_read_b64_tr_b16 v[24:25], v4 offset:45056
    ds_read_b64_tr_b16 v[26:27], v4 offset:45568
    v_mfma_f32_16x16x32_bf16 v[104:107], v[16:19], a[192:195], v[104:107]
    s_mul_i32 s49, s32, 2688
    v_mfma_f32_16x16x32_bf16 v[104:107], v[20:23], a[208:211], v[104:107]
    s_sub_u32 s50, s93, 2688
    v_mfma_f32_16x16x32_bf16 v[120:123], v[20:23], a[212:215], v[120:123]
    v_cmp_gt_u32 vcc, 672, v8
    v_mfma_f32_16x16x32_bf16 v[120:123], v[16:19], a[196:199], v[120:123]
    v_lshlrev_b32 v8, 2, v8
    v_mfma_f32_16x16x32_bf16 v[136:139], v[16:19], a[200:203], v[136:139]
    v_add_u32 v9, s49, v8
    v_mfma_f32_16x16x32_bf16 v[136:139], v[20:23], a[216:219], v[136:139]
    v_add_u32 v8, s50, v8
    v_mfma_f32_16x16x32_bf16 v[152:155], v[20:23], a[220:223], v[152:155]
    s_barrier
    s_add_u32 m0, s19, 24576
    s_lshl_b32 s21, s56, 13
    s_add_u32 s21, s21, s27
    ds_read_b64_tr_b16 v[20:21], v1 offset:57344
    ds_read_b64_tr_b16 v[22:23], v1 offset:57856
    buffer_load_dwordx4 v5, s[8:11], s21 offen sc1 lds
    v_mfma_f32_16x16x32_bf16 v[152:155], v[16:19], a[204:207], v[152:155]
    s_waitcnt lgkmcnt(2)
    ds_read_b64_tr_b16 v[16:17], v1 offset:53248
    ds_read_b64_tr_b16 v[18:19], v1 offset:53760
    v_mfma_f32_16x16x32_bf16 v[156:159], v[24:27], a[204:207], v[156:159]
    s_add_u32 m0, s19, 28672
    v_cndmask_b32 v8, v8, v9, vcc
    s_add_u32 s21, s21, 4096
    v_mfma_f32_16x16x32_bf16 v[156:159], v[28:31], a[220:223], v[156:159]
    s_mov_b32 s49, 55623680
    v_mfma_f32_16x16x32_bf16 v[140:143], v[28:31], a[216:219], v[140:143]
    v_and_b32 v9, 0x70, v5
    v_mfma_f32_16x16x32_bf16 v[140:143], v[24:27], a[200:203], v[140:143]
    buffer_load_dwordx4 v5, s[8:11], s21 offen sc1 lds
    s_sub_u32 s50, s67, 55623680
    v_mfma_f32_16x16x32_bf16 v[124:127], v[24:27], a[196:199], v[124:127]
    s_add_u32 m0, s19, 32768
    v_cmp_gt_u32 vcc, 0x100, v5
    s_lshl_b32 s21, s57, 13
    v_mfma_f32_16x16x32_bf16 v[124:127], v[28:31], a[212:215], v[124:127]
    s_add_u32 s21, s21, s27
    v_lshl_add_u32 v9, v9, 2, s50
    v_mfma_f32_16x16x32_bf16 v[108:111], v[28:31], a[208:211], v[108:111]
    ds_read_b64_tr_b16 v[28:29], v2 offset:57344
    ds_read_b64_tr_b16 v[30:31], v2 offset:57856
    v_mfma_f32_16x16x32_bf16 v[108:111], v[24:27], a[192:195], v[108:111]
    s_waitcnt lgkmcnt(2)
    ds_read_b64_tr_b16 v[24:25], v2 offset:53248
    ds_read_b64_tr_b16 v[26:27], v2 offset:53760
    v_mfma_f32_16x16x32_bf16 v[32:35], v[16:19], a[224:227], v[32:35]
    v_cndmask_b32 v8, v9, v8, vcc
    v_mfma_f32_16x16x32_bf16 v[32:35], v[20:23], a[240:243], v[32:35]
    buffer_load_dwordx4 v5, s[8:11], s21 offen sc1 lds
    v_add_u32 v8, s49, v8
    v_mfma_f32_16x16x32_bf16 v[48:51], v[20:23], a[244:247], v[48:51]
    s_add_u32 m0, s19, 36864
    s_add_u32 s21, s21, 4096
    v_mfma_f32_16x16x32_bf16 v[48:51], v[16:19], a[228:231], v[48:51]
    v_mfma_f32_16x16x32_bf16 v[64:67], v[16:19], a[232:235], v[64:67]
    v_mfma_f32_16x16x32_bf16 v[64:67], v[20:23], a[248:251], v[64:67]
    v_mfma_f32_16x16x32_bf16 v[80:83], v[20:23], a[252:255], v[80:83]
    ds_read_b64_tr_b16 v[20:21], v1 offset:4096
    ds_read_b64_tr_b16 v[22:23], v1 offset:4608
    v_mfma_f32_16x16x32_bf16 v[80:83], v[16:19], a[236:239], v[80:83]
    s_waitcnt lgkmcnt(2)
    ds_read_b64_tr_b16 v[16:17], v1 offset:0
    ds_read_b64_tr_b16 v[18:19], v1 offset:512
    v_mfma_f32_16x16x32_bf16 v[84:87], v[24:27], a[236:239], v[84:87]
    buffer_load_dwordx4 v5, s[8:11], s21 offen sc1 lds
    v_mfma_f32_16x16x32_bf16 v[84:87], v[28:31], a[252:255], v[84:87]
    s_add_u32 m0, s19, 126976
    v_mfma_f32_16x16x32_bf16 v[68:71], v[28:31], a[248:251], v[68:71]
    v_mfma_f32_16x16x32_bf16 v[68:71], v[24:27], a[232:235], v[68:71]
    v_mfma_f32_16x16x32_bf16 v[52:55], v[24:27], a[228:231], v[52:55]
    v_mfma_f32_16x16x32_bf16 v[52:55], v[28:31], a[244:247], v[52:55]
    buffer_load_dwordx4 v5, s[8:11], s23 offen sc1 lds
    v_mfma_f32_16x16x32_bf16 v[36:39], v[28:31], a[240:243], v[36:39]
    s_add_u32 m0, s19, 131072
    ds_read_b64_tr_b16 v[28:29], v2 offset:4096
    ds_read_b64_tr_b16 v[30:31], v2 offset:4608
    v_mfma_f32_16x16x32_bf16 v[36:39], v[24:27], a[224:227], v[36:39]
    s_waitcnt lgkmcnt(2)
    ds_read_b64_tr_b16 v[24:25], v2 offset:0
    ds_read_b64_tr_b16 v[26:27], v2 offset:512
    v_mfma_f32_16x16x32_bf16 v[40:43], v[16:19], a[224:227], v[40:43]
    v_mfma_f32_16x16x32_bf16 v[40:43], v[20:23], a[240:243], v[40:43]
    v_mfma_f32_16x16x32_bf16 v[56:59], v[20:23], a[244:247], v[56:59]
    v_mfma_f32_16x16x32_bf16 v[56:59], v[16:19], a[228:231], v[56:59]
    buffer_load_dwordx4 v5, s[8:11], s24 offen sc1 lds
    v_mfma_f32_16x16x32_bf16 v[72:75], v[16:19], a[232:235], v[72:75]
    s_add_u32 m0, s19, 135168
    v_mfma_f32_16x16x32_bf16 v[72:75], v[20:23], a[248:251], v[72:75]
    v_mfma_f32_16x16x32_bf16 v[88:91], v[20:23], a[252:255], v[88:91]
    s_waitcnt vmcnt(6)
    s_barrier
    ds_read_b64_tr_b16 v[20:21], v1 offset:12288
    ds_read_b64_tr_b16 v[22:23], v1 offset:12800
    v_mfma_f32_16x16x32_bf16 v[88:91], v[16:19], a[236:239], v[88:91]
    s_waitcnt lgkmcnt(2)
    ds_read_b64_tr_b16 v[16:17], v1 offset:8192
    ds_read_b64_tr_b16 v[18:19], v1 offset:8704
    v_mfma_f32_16x16x32_bf16 v[92:95], v[24:27], a[236:239], v[92:95]
    v_mfma_f32_16x16x32_bf16 v[92:95], v[28:31], a[252:255], v[92:95]
    buffer_load_dwordx4 v5, s[8:11], s29 offen sc1 lds
    v_mfma_f32_16x16x32_bf16 v[76:79], v[28:31], a[248:251], v[76:79]
    s_add_u32 m0, s19, 139264
    v_mfma_f32_16x16x32_bf16 v[76:79], v[24:27], a[232:235], v[76:79]
    v_mfma_f32_16x16x32_bf16 v[60:63], v[24:27], a[228:231], v[60:63]
    v_mfma_f32_16x16x32_bf16 v[60:63], v[28:31], a[244:247], v[60:63]
    v_mfma_f32_16x16x32_bf16 v[44:47], v[28:31], a[240:243], v[44:47]
    ds_read_b64_tr_b16 v[28:29], v2 offset:12288
    ds_read_b64_tr_b16 v[30:31], v2 offset:12800
    v_mfma_f32_16x16x32_bf16 v[44:47], v[24:27], a[224:227], v[44:47]
    s_waitcnt lgkmcnt(2)
    ds_read_b64_tr_b16 v[24:25], v2 offset:8192
    ds_read_b64_tr_b16 v[26:27], v2 offset:8704
    v_mfma_f32_16x16x32_bf16 v[32:35], v[16:19], v[224:227], v[32:35]
    buffer_load_dwordx4 v5, s[8:11], s90 offen sc1 lds
    v_mfma_f32_16x16x32_bf16 v[32:35], v[20:23], v[240:243], v[32:35]
    s_add_u32 m0, s19, 143360
    v_mfma_f32_16x16x32_bf16 v[48:51], v[20:23], v[244:247], v[48:51]
    v_mfma_f32_16x16x32_bf16 v[48:51], v[16:19], v[228:231], v[48:51]
    v_mfma_f32_16x16x32_bf16 v[64:67], v[16:19], v[232:235], v[64:67]
    v_mfma_f32_16x16x32_bf16 v[64:67], v[20:23], v[248:251], v[64:67]
    buffer_load_dwordx4 v5, s[8:11], s91 offen sc1 lds
    v_mfma_f32_16x16x32_bf16 v[80:83], v[20:23], v[252:255], v[80:83]
    s_add_u32 m0, s19, 40960
    ds_read_b64_tr_b16 v[20:21], v1 offset:20480
    ds_read_b64_tr_b16 v[22:23], v1 offset:20992
    v_mfma_f32_16x16x32_bf16 v[80:83], v[16:19], v[236:239], v[80:83]
    s_waitcnt lgkmcnt(2)
    ds_read_b64_tr_b16 v[16:17], v1 offset:16384
    ds_read_b64_tr_b16 v[18:19], v1 offset:16896
    v_mfma_f32_16x16x32_bf16 v[84:87], v[24:27], v[236:239], v[84:87]
    s_lshl_b32 s21, s58, 13
    s_add_u32 s21, s21, s27
    v_mfma_f32_16x16x32_bf16 v[84:87], v[28:31], v[252:255], v[84:87]
    v_mfma_f32_16x16x32_bf16 v[68:71], v[28:31], v[248:251], v[68:71]
    v_mfma_f32_16x16x32_bf16 v[68:71], v[24:27], v[232:235], v[68:71]
    buffer_load_dwordx4 v5, s[8:11], s21 offen sc1 lds
    v_mfma_f32_16x16x32_bf16 v[52:55], v[24:27], v[228:231], v[52:55]
    s_add_u32 m0, s19, 45056
    s_add_u32 s21, s21, 4096
    v_mfma_f32_16x16x32_bf16 v[52:55], v[28:31], v[244:247], v[52:55]
    v_mfma_f32_16x16x32_bf16 v[36:39], v[28:31], v[240:243], v[36:39]
    ds_read_b64_tr_b16 v[28:29], v2 offset:20480
    ds_read_b64_tr_b16 v[30:31], v2 offset:20992
    v_mfma_f32_16x16x32_bf16 v[36:39], v[24:27], v[224:227], v[36:39]
    s_waitcnt lgkmcnt(2)
    ds_read_b64_tr_b16 v[24:25], v2 offset:16384
    ds_read_b64_tr_b16 v[26:27], v2 offset:16896
    v_mfma_f32_16x16x32_bf16 v[40:43], v[16:19], v[224:227], v[40:43]
    v_mfma_f32_16x16x32_bf16 v[40:43], v[20:23], v[240:243], v[40:43]
    buffer_load_dwordx4 v5, s[8:11], s21 offen sc1 lds
    v_mfma_f32_16x16x32_bf16 v[56:59], v[20:23], v[244:247], v[56:59]
    s_add_u32 m0, s19, 49152
    s_lshl_b32 s21, s59, 13
    s_add_u32 s21, s21, s27
    v_mfma_f32_16x16x32_bf16 v[56:59], v[16:19], v[228:231], v[56:59]
    v_mfma_f32_16x16x32_bf16 v[72:75], v[16:19], v[232:235], v[72:75]
    v_mfma_f32_16x16x32_bf16 v[72:75], v[20:23], v[248:251], v[72:75]
    v_mfma_f32_16x16x32_bf16 v[88:91], v[20:23], v[252:255], v[88:91]
    ds_read_b64_tr_b16 v[20:21], v3 offset:57344
    ds_read_b64_tr_b16 v[22:23], v3 offset:57856
    v_mfma_f32_16x16x32_bf16 v[88:91], v[16:19], v[236:239], v[88:91]
    s_waitcnt lgkmcnt(2)
    ds_read_b64_tr_b16 v[16:17], v3 offset:53248
    ds_read_b64_tr_b16 v[18:19], v3 offset:53760
    v_mfma_f32_16x16x32_bf16 v[92:95], v[24:27], v[236:239], v[92:95]
    buffer_load_dwordx4 v5, s[8:11], s21 offen sc1 lds
    v_mfma_f32_16x16x32_bf16 v[92:95], v[28:31], v[252:255], v[92:95]
    s_add_u32 m0, s19, 61440
    v_mfma_f32_16x16x32_bf16 v[76:79], v[28:31], v[248:251], v[76:79]
    v_mfma_f32_16x16x32_bf16 v[76:79], v[24:27], v[232:235], v[76:79]
    v_mfma_f32_16x16x32_bf16 v[60:63], v[24:27], v[228:231], v[60:63]
    v_mfma_f32_16x16x32_bf16 v[60:63], v[28:31], v[244:247], v[60:63]
    buffer_load_dwordx4 v13, s[4:7], s88 offen offset:0 lds
    v_mfma_f32_16x16x32_bf16 v[44:47], v[28:31], v[240:243], v[44:47]
    ds_read_b64_tr_b16 v[28:29], v4 offset:57344
    ds_read_b64_tr_b16 v[30:31], v4 offset:57856
    v_mfma_f32_16x16x32_bf16 v[44:47], v[24:27], v[224:227], v[44:47]
    s_waitcnt lgkmcnt(2)
    ds_read_b64_tr_b16 v[24:25], v4 offset:53248
    ds_read_b64_tr_b16 v[26:27], v4 offset:53760
    v_mfma_f32_16x16x32_bf16 v[96:99], v[16:19], a[224:227], v[96:99]
    s_add_u32 m0, s19, 65408
    v_mfma_f32_16x16x32_bf16 v[96:99], v[20:23], a[240:243], v[96:99]
    v_mfma_f32_16x16x32_bf16 v[112:115], v[20:23], a[244:247], v[112:115]
    v_mfma_f32_16x16x32_bf16 v[112:115], v[16:19], a[228:231], v[112:115]
    buffer_load_dwordx4 v13, s[4:7], s88 offen offset:128 lds
    v_mfma_f32_16x16x32_bf16 v[128:131], v[16:19], a[232:235], v[128:131]
    v_mul_f32 v40, v32, v40
    v_mul_f32 v32, s40, v32
    v_mul_f32 v41, v33, v41
    v_mfma_f32_16x16x32_bf16 v[128:131], v[20:23], a[248:251], v[128:131]
    v_exp_f32 v32, v32
    v_mfma_f32_16x16x32_bf16 v[144:147], v[20:23], a[252:255], v[144:147]
    ds_read_b64_tr_b16 v[20:21], v3 offset:4096
    ds_read_b64_tr_b16 v[22:23], v3 offset:4608
    v_mfma_f32_16x16x32_bf16 v[144:147], v[16:19], a[236:239], v[144:147]
    s_waitcnt lgkmcnt(2)
    ds_read_b64_tr_b16 v[16:17], v3 offset:0
    ds_read_b64_tr_b16 v[18:19], v3 offset:512
    v_mfma_f32_16x16x32_bf16 v[148:151], v[24:27], a[236:239], v[148:151]
    v_mul_f32 v33, s40, v33
    v_mul_f32 v42, v34, v42
    v_mul_f32 v34, s40, v34
    v_mfma_f32_16x16x32_bf16 v[148:151], v[28:31], a[252:255], v[148:151]
    v_exp_f32 v33, v33
    v_mfma_f32_16x16x32_bf16 v[132:135], v[28:31], a[248:251], v[132:135]
    v_add_f32 v32, 1.0, v32
    v_mul_f32 v43, v35, v43
    v_mfma_f32_16x16x32_bf16 v[132:135], v[24:27], a[232:235], v[132:135]
    v_exp_f32 v34, v34
    v_mfma_f32_16x16x32_bf16 v[116:119], v[24:27], a[228:231], v[116:119]
    s_add_u32 m0, s19, 69376
    s_nop 0
    buffer_load_dwordx4 v13, s[4:7], s88 offen offset:256 lds
    v_mul_f32 v35, s40, v35
    v_add_f32 v33, 1.0, v33
    v_mfma_f32_16x16x32_bf16 v[116:119], v[28:31], a[244:247], v[116:119]
    v_rcp_f32 v32, v32
    v_mfma_f32_16x16x32_bf16 v[100:103], v[28:31], a[240:243], v[100:103]
    ds_read_b64_tr_b16 v[28:29], v4 offset:4096
    ds_read_b64_tr_b16 v[30:31], v4 offset:4608
    v_mfma_f32_16x16x32_bf16 v[100:103], v[24:27], a[224:227], v[100:103]
    s_waitcnt lgkmcnt(2)
    ds_read_b64_tr_b16 v[24:25], v4 offset:0
    ds_read_b64_tr_b16 v[26:27], v4 offset:512
    v_mfma_f32_16x16x32_bf16 v[104:107], v[16:19], a[224:227], v[104:107]
    v_mul_f32 v44, v36, v44
    v_exp_f32 v35, v35
    v_mfma_f32_16x16x32_bf16 v[104:107], v[20:23], a[240:243], v[104:107]
    v_mul_f32 v36, s40, v36
    v_add_f32 v34, 1.0, v34
    v_mfma_f32_16x16x32_bf16 v[120:123], v[20:23], a[244:247], v[120:123]
    v_rcp_f32 v33, v33
    v_mfma_f32_16x16x32_bf16 v[120:123], v[16:19], a[228:231], v[120:123]
    v_mul_f32 v32, v32, v40
    v_mul_f32 v45, v37, v45
    v_mfma_f32_16x16x32_bf16 v[136:139], v[16:19], a[232:235], v[136:139]
    v_exp_f32 v36, v36
    v_mul_f32 v37, s40, v37
    v_mfma_f32_16x16x32_bf16 v[136:139], v[20:23], a[248:251], v[136:139]
    v_add_f32 v35, 1.0, v35
    v_mul_f32 v33, v33, v41
    v_mfma_f32_16x16x32_bf16 v[152:155], v[20:23], a[252:255], v[152:155]
    ds_read_b64_tr_b16 v[20:21], v3 offset:12288
    ds_read_b64_tr_b16 v[22:23], v3 offset:12800
    v_mfma_f32_16x16x32_bf16 v[152:155], v[16:19], a[236:239], v[152:155]
    s_waitcnt lgkmcnt(2)
    ds_read_b64_tr_b16 v[16:17], v3 offset:8192
    ds_read_b64_tr_b16 v[18:19], v3 offset:8704
    v_mfma_f32_16x16x32_bf16 v[156:159], v[24:27], a[236:239], v[156:159]
    s_add_u32 m0, s19, 73344
    s_nop 0
    buffer_load_dwordx4 v13, s[4:7], s88 offen offset:384 lds
    v_mul_f32 v46, v38, v46
    v_mul_f32 v38, s40, v38
    v_mfma_f32_16x16x32_bf16 v[156:159], v[28:31], a[252:255], v[156:159]
    v_rcp_f32 v34, v34
    v_mfma_f32_16x16x32_bf16 v[140:143], v[28:31], a[248:251], v[140:143]
    v_exp_f32 v37, v37
    v_mfma_f32_16x16x32_bf16 v[140:143], v[24:27], a[232:235], v[140:143]
    v_add_f32 v36, 1.0, v36
    v_mul_f32 v34, v34, v42
    v_mfma_f32_16x16x32_bf16 v[124:127], v[24:27], a[228:231], v[124:127]
    v_rcp_f32 v35, v35
    v_mul_f32 v47, v39, v47
    v_mfma_f32_16x16x32_bf16 v[124:127], v[28:31], a[244:247], v[124:127]
    v_exp_f32 v38, v38
    v_mfma_f32_16x16x32_bf16 v[108:111], v[28:31], a[240:243], v[108:111]
    ds_read_b64_tr_b16 v[28:29], v4 offset:12288
    ds_read_b64_tr_b16 v[30:31], v4 offset:12800
    v_mfma_f32_16x16x32_bf16 v[108:111], v[24:27], a[224:227], v[108:111]
    s_waitcnt lgkmcnt(2)
    ds_read_b64_tr_b16 v[24:25], v4 offset:8192
    ds_read_b64_tr_b16 v[26:27], v4 offset:8704
    v_mfma_f32_16x16x32_bf16 v[96:99], v[16:19], v[224:227], v[96:99]
    v_mul_f32 v39, s40, v39
    v_add_f32 v37, 1.0, v37
    v_mul_f32 v35, v35, v43
    v_mfma_f32_16x16x32_bf16 v[96:99], v[20:23], v[240:243], v[96:99]
    v_rcp_f32 v36, v36
    v_mfma_f32_16x16x32_bf16 v[112:115], v[20:23], v[244:247], v[112:115]
    v_exp_f32 v39, v39
    v_mfma_f32_16x16x32_bf16 v[112:115], v[16:19], v[228:231], v[112:115]
    v_add_f32 v38, 1.0, v38
    v_mul_f32 v36, v36, v44
    v_mfma_f32_16x16x32_bf16 v[128:131], v[16:19], v[232:235], v[128:131]
    s_add_u32 m0, s19, 77312
    s_nop 0
    buffer_load_dwordx4 v13, s[4:7], s88 offen offset:512 lds
    v_add_f32 v39, 1.0, v39
    v_cvt_pk_bf16_f32 v40, v32, v33
    v_mfma_f32_16x16x32_bf16 v[128:131], v[20:23], v[248:251], v[128:131]
    v_rcp_f32 v37, v37
    v_mfma_f32_16x16x32_bf16 v[144:147], v[20:23], v[252:255], v[144:147]
    ds_read_b64_tr_b16 v[20:21], v3 offset:20480
    ds_read_b64_tr_b16 v[22:23], v3 offset:20992
    v_mfma_f32_16x16x32_bf16 v[144:147], v[16:19], v[236:239], v[144:147]
    s_waitcnt lgkmcnt(2)
    ds_read_b64_tr_b16 v[16:17], v3 offset:16384
    ds_read_b64_tr_b16 v[18:19], v3 offset:16896
    v_mfma_f32_16x16x32_bf16 v[148:151], v[24:27], v[236:239], v[148:151]
    v_rcp_f32 v38, v38
    v_mul_f32 v37, v37, v45
    v_mfma_f32_16x16x32_bf16 v[148:151], v[28:31], v[252:255], v[148:151]
    v_rcp_f32 v39, v39
    v_mfma_f32_16x16x32_bf16 v[132:135], v[28:31], v[248:251], v[132:135]
    v_mul_f32 v38, v38, v46
    v_mul_f32 v39, v39, v47
    v_mfma_f32_16x16x32_bf16 v[132:135], v[24:27], v[232:235], v[132:135]
    v_cvt_pk_bf16_f32 v41, v34, v35
    v_cvt_pk_bf16_f32 v42, v36, v37
    v_mfma_f32_16x16x32_bf16 v[116:119], v[24:27], v[228:231], v[116:119]
    v_cvt_pk_bf16_f32 v43, v38, v39
    v_mul_f32 v56, v48, v56
    v_mul_f32 v48, s40, v48
    v_mfma_f32_16x16x32_bf16 v[116:119], v[28:31], v[244:247], v[116:119]
    v_mul_f32 v57, v49, v57
    v_mul_f32 v49, s40, v49
    v_mfma_f32_16x16x32_bf16 v[100:103], v[28:31], v[240:243], v[100:103]
    ds_read_b64_tr_b16 v[28:29], v4 offset:20480
    ds_read_b64_tr_b16 v[30:31], v4 offset:20992
    v_mfma_f32_16x16x32_bf16 v[100:103], v[24:27], v[224:227], v[100:103]
    s_waitcnt lgkmcnt(2)
    ds_read_b64_tr_b16 v[24:25], v4 offset:16384
    ds_read_b64_tr_b16 v[26:27], v4 offset:16896
    v_mfma_f32_16x16x32_bf16 v[104:107], v[16:19], v[224:227], v[104:107]
    s_add_u32 m0, s19, 81280
    s_nop 0
    buffer_load_dwordx4 v13, s[4:7], s88 offen offset:640 lds
    v_mul_f32 v58, v50, v58
    v_mul_f32 v50, s40, v50
    v_mfma_f32_16x16x32_bf16 v[104:107], v[20:23], v[240:243], v[104:107]
    v_exp_f32 v48, v48
    v_mfma_f32_16x16x32_bf16 v[120:123], v[20:23], v[244:247], v[120:123]
    v_exp_f32 v49, v49
    v_mfma_f32_16x16x32_bf16 v[120:123], v[16:19], v[228:231], v[120:123]
    v_add_f32 v48, 1.0, v48
    v_mul_f32 v59, v51, v59
    v_mfma_f32_16x16x32_bf16 v[136:139], v[16:19], v[232:235], v[136:139]
    v_exp_f32 v50, v50
    v_mul_f32 v51, s40, v51
    v_mfma_f32_16x16x32_bf16 v[136:139], v[20:23], v[248:251], v[136:139]
    v_add_f32 v49, 1.0, v49
    v_mul_f32 v60, v52, v60
    v_mfma_f32_16x16x32_bf16 v[152:155], v[20:23], v[252:255], v[152:155]
    s_waitcnt vmcnt(14)
    s_barrier
    ds_read_b128 v[20:23], v5 offset:28672
    v_mfma_f32_16x16x32_bf16 v[152:155], v[16:19], v[236:239], v[152:155]
    s_waitcnt lgkmcnt(1)
    ds_read_b128 v[16:19], v5 offset:24576
    v_mul_f32 v52, s40, v52
    v_mfma_f32_16x16x32_bf16 v[156:159], v[24:27], v[236:239], v[156:159]
    s_add_u32 m0, s19, 53248
    s_add_u32 s21, s21, 4096
    buffer_load_dwordx4 v5, s[8:11], s21 offen sc1 lds
    v_add_f32 v50, 1.0, v50
    v_mfma_f32_16x16x32_bf16 v[156:159], v[28:31], v[252:255], v[156:159]
    s_add_u32 m0, s19, 57344
    v_rcp_f32 v48, v48
    v_mfma_f32_16x16x32_bf16 v[140:143], v[28:31], v[248:251], v[140:143]
    s_lshl_b32 s21, s60, 13
    v_exp_f32 v51, v51
    v_mfma_f32_16x16x32_bf16 v[140:143], v[24:27], v[232:235], v[140:143]
    s_add_u32 s21, s21, s27
    v_rcp_f32 v49, v49
    v_mfma_f32_16x16x32_bf16 v[124:127], v[24:27], v[228:231], v[124:127]
    v_mul_f32 v48, v48, v56
    v_mul_f32 v61, v53, v61
    v_mul_f32 v53, s40, v53
    v_mfma_f32_16x16x32_bf16 v[124:127], v[28:31], v[244:247], v[124:127]
    buffer_load_dwordx4 v5, s[8:11], s21 offen sc1 lds
    v_add_f32 v51, 1.0, v51
    v_mfma_f32_16x16x32_bf16 v[108:111], v[28:31], v[240:243], v[108:111]
    s_add_u32 m0, s19, 85248
    ds_read_b128 v[28:31], v5 offset:29696
    v_mul_f32 v49, v49, v57
    v_mfma_f32_16x16x32_bf16 v[108:111], v[24:27], v[224:227], v[108:111]
    s_waitcnt lgkmcnt(1)
    ds_read_b128 v[24:27], v5 offset:25600
    v_mul_f32 v62, v54, v62
    v_mfma_f32_16x16x32_bf16 v[160:163], v[16:19], a[0:3], 0
    v_exp_f32 v52, v52
    v_mul_f32 v54, s40, v54
    v_mfma_f32_16x16x32_bf16 v[160:163], v[20:23], a[16:19], v[160:163]
    v_rcp_f32 v50, v50
    v_mfma_f32_16x16x32_bf16 v[164:167], v[20:23], a[20:23], 0
    v_exp_f32 v53, v53
    v_mfma_f32_16x16x32_bf16 v[164:167], v[16:19], a[4:7], v[164:167]
    buffer_load_dwordx4 v13, s[4:7], s88 offen offset:768 lds
    v_add_f32 v52, 1.0, v52
    v_mfma_f32_16x16x32_bf16 v[168:171], v[16:19], a[8:11], 0
    s_add_u32 m0, s19, 0
    v_rcp_f32 v51, v51
    v_mul_f32 v50, v50, v58
    v_mfma_f32_16x16x32_bf16 v[168:171], v[20:23], a[24:27], v[168:171]
    s_add_u32 s21, s21, 4096
    v_mul_f32 v63, v55, v63
    v_mul_f32 v55, s40, v55
    v_mfma_f32_16x16x32_bf16 v[172:175], v[20:23], a[28:31], 0
    ds_read_b128 v[20:23], v5 offset:30720
    v_add_f32 v53, 1.0, v53
    v_mfma_f32_16x16x32_bf16 v[172:175], v[16:19], a[12:15], v[172:175]
    s_waitcnt lgkmcnt(1)
    ds_read_b128 v[16:19], v5 offset:26624
    v_mul_f32 v51, v51, v59
    v_mfma_f32_16x16x32_bf16 v[188:191], v[24:27], a[12:15], 0
    v_exp_f32 v54, v54
    s_nop 0
    v_add_f32 v54, 1.0, v54
    v_mfma_f32_16x16x32_bf16 v[188:191], v[28:31], a[28:31], v[188:191]
    buffer_load_dwordx4 v5, s[8:11], s21 offen sc1 lds
    v_mfma_f32_16x16x32_bf16 v[184:187], v[28:31], a[24:27], 0
    s_add_u32 m0, s19, 89216
    v_rcp_f32 v52, v52
    v_mfma_f32_16x16x32_bf16 v[184:187], v[24:27], a[8:11], v[184:187]
    v_exp_f32 v55, v55
    v_mfma_f32_16x16x32_bf16 v[180:183], v[24:27], a[4:7], 0
    v_rcp_f32 v53, v53
    v_mul_f32 v52, v52, v60
    v_mfma_f32_16x16x32_bf16 v[180:183], v[28:31], a[20:23], v[180:183]
    v_add_f32 v55, 1.0, v55
    v_mul_f32 v53, v53, v61
    v_mfma_f32_16x16x32_bf16 v[176:179], v[28:31], a[16:19], 0
    ds_read_b128 v[28:31], v5 offset:31744
    v_cvt_pk_bf16_f32 v56, v48, v49
    v_mfma_f32_16x16x32_bf16 v[176:179], v[24:27], a[0:3], v[176:179]
    s_waitcnt lgkmcnt(1)
    ds_read_b128 v[24:27], v5 offset:27648
    buffer_load_dwordx4 v13, s[4:7], s88 offen offset:896 lds
    v_mfma_f32_16x16x32_bf16 v[192:195], v[16:19], a[0:3], 0
    s_add_u32 m0, s19, 4096
    v_rcp_f32 v54, v54
    s_nop 0
    v_mul_f32 v54, v54, v62
    v_mfma_f32_16x16x32_bf16 v[192:195], v[20:23], a[16:19], v[192:195]
    s_lshl_b32 s21, s61, 13
    v_rcp_f32 v55, v55
    v_mfma_f32_16x16x32_bf16 v[196:199], v[20:23], a[20:23], 0
    s_add_u32 s21, s21, s27
    v_mul_f32 v55, v55, v63
    v_cvt_pk_bf16_f32 v57, v50, v51
    v_mfma_f32_16x16x32_bf16 v[196:199], v[16:19], a[4:7], v[196:199]
    v_cvt_pk_bf16_f32 v58, v52, v53
    v_cvt_pk_bf16_f32 v59, v54, v55
    v_mfma_f32_16x16x32_bf16 v[200:203], v[16:19], a[8:11], 0
    s_add_u32 s39, s30, 0
    buffer_store_dwordx4 v[40:43], v5, s[8:11], s39 offen offset:0 sc1
    v_mfma_f32_16x16x32_bf16 v[200:203], v[20:23], a[24:27], v[200:203]
    buffer_load_dwordx4 v5, s[8:11], s21 offen sc1 lds
    v_mfma_f32_16x16x32_bf16 v[204:207], v[20:23], a[28:31], 0
    s_add_u32 m0, s19, 93184
    ds_read_b128 v[20:23], v5 offset:36864
    v_mfma_f32_16x16x32_bf16 v[204:207], v[16:19], a[12:15], v[204:207]
    s_waitcnt lgkmcnt(1)
    ds_read_b128 v[16:19], v5 offset:32768
    v_mfma_f32_16x16x32_bf16 v[220:223], v[24:27], a[12:15], 0
    s_add_u32 s39, s30, 0
    buffer_store_dwordx4 v[56:59], v5, s[8:11], s39 offen offset:1024 sc1
    v_add_u32 v52, s19, v5
    v_mul_f32 v72, v64, v72
    v_mfma_f32_16x16x32_bf16 v[220:223], v[28:31], a[28:31], v[220:223]
    v_mul_f32 v64, s40, v64
    v_mul_f32 v73, v65, v73
    v_mfma_f32_16x16x32_bf16 v[216:219], v[28:31], a[24:27], 0
    v_exp_f32 v64, v64
    v_mfma_f32_16x16x32_bf16 v[216:219], v[24:27], a[8:11], v[216:219]
    v_mul_f32 v65, s40, v65
    v_mul_f32 v74, v66, v74
    v_mfma_f32_16x16x32_bf16 v[212:215], v[24:27], a[4:7], 0
    v_exp_f32 v65, v65
    v_mul_f32 v66, s40, v66
    v_mfma_f32_16x16x32_bf16 v[212:215], v[28:31], a[20:23], v[212:215]
    buffer_load_dwordx4 v13, s[4:7], s88 offen offset:1024 lds
    v_add_f32 v64, 1.0, v64
    v_mfma_f32_16x16x32_bf16 v[208:211], v[28:31], a[16:19], 0
    s_add_u32 m0, s19, 8192
    ds_read_b128 v[28:31], v5 offset:37888
    v_mul_f32 v75, v67, v75
    v_mfma_f32_16x16x32_bf16 v[208:211], v[24:27], a[0:3], v[208:211]
    s_waitcnt lgkmcnt(1)
    ds_read_b128 v[24:27], v5 offset:33792
    v_mul_f32 v67, s40, v67
    v_mfma_f32_16x16x32_bf16 v[160:163], v[16:19], a[32:35], v[160:163]
    s_add_u32 s21, s21, 4096
    v_exp_f32 v66, v66
    v_add_f32 v65, 1.0, v65
    v_mfma_f32_16x16x32_bf16 v[160:163], v[20:23], a[48:51], v[160:163]
    v_rcp_f32 v64, v64
    v_mfma_f32_16x16x32_bf16 v[164:167], v[20:23], a[52:55], v[164:167]
    v_mul_f32 v76, v68, v76
    v_mul_f32 v68, s40, v68
    v_mfma_f32_16x16x32_bf16 v[164:167], v[16:19], a[36:39], v[164:167]
    v_exp_f32 v67, v67
    v_mfma_f32_16x16x32_bf16 v[168:171], v[16:19], a[40:43], v[168:171]
    v_add_f32 v66, 1.0, v66
    v_rcp_f32 v65, v65
    v_mfma_f32_16x16x32_bf16 v[168:171], v[20:23], a[56:59], v[168:171]
    buffer_load_dwordx4 v5, s[8:11], s21 offen sc1 lds
    v_mul_f32 v64, v64, v72
    v_mfma_f32_16x16x32_bf16 v[172:175], v[20:23], a[60:63], v[172:175]
    s_add_u32 m0, s19, 12288
    ds_read_b128 v[20:23], v5 offset:38912
    v_mul_f32 v77, v69, v77
    v_mfma_f32_16x16x32_bf16 v[172:175], v[16:19], a[44:47], v[172:175]
    s_waitcnt lgkmcnt(1)
    ds_read_b128 v[16:19], v5 offset:34816
    v_mul_f32 v69, s40, v69
    v_mfma_f32_16x16x32_bf16 v[188:191], v[24:27], a[44:47], v[188:191]
    s_lshl_b32 s21, s62, 13
    v_exp_f32 v68, v68
    v_add_f32 v67, 1.0, v67
    v_mfma_f32_16x16x32_bf16 v[188:191], v[28:31], a[60:63], v[188:191]
    s_add_u32 s21, s21, s27
    v_rcp_f32 v66, v66
    v_mfma_f32_16x16x32_bf16 v[184:187], v[28:31], a[56:59], v[184:187]
    v_mul_f32 v65, v65, v73
    v_mul_f32 v78, v70, v78
    v_mfma_f32_16x16x32_bf16 v[184:187], v[24:27], a[40:43], v[184:187]
    v_exp_f32 v69, v69
    v_mfma_f32_16x16x32_bf16 v[180:183], v[24:27], a[36:39], v[180:183]
    v_mul_f32 v70, s40, v70
    v_add_f32 v68, 1.0, v68
    v_mul_f32 v66, v66, v74
    v_mfma_f32_16x16x32_bf16 v[180:183], v[28:31], a[52:55], v[180:183]
    buffer_load_dwordx4 v5, s[8:11], s21 offen sc1 lds
    v_mul_f32 v79, v71, v79
    v_mfma_f32_16x16x32_bf16 v[176:179], v[28:31], a[48:51], v[176:179]
    ds_read_b128 v[28:31], v5 offset:39936
    v_mul_f32 v71, s40, v71
    v_mfma_f32_16x16x32_bf16 v[176:179], v[24:27], a[32:35], v[176:179]
    s_waitcnt lgkmcnt(1)
    ds_read_b128 v[24:27], v5 offset:35840
    v_add_f32 v69, 1.0, v69
    v_mfma_f32_16x16x32_bf16 v[192:195], v[16:19], a[32:35], v[192:195]
    v_rcp_f32 v67, v67
    s_nop 0
    v_mul_f32 v67, v67, v75
    v_mfma_f32_16x16x32_bf16 v[192:195], v[20:23], a[48:51], v[192:195]
    v_exp_f32 v70, v70
    v_mfma_f32_16x16x32_bf16 v[196:199], v[20:23], a[52:55], v[196:199]
    v_rcp_f32 v68, v68
    v_mfma_f32_16x16x32_bf16 v[196:199], v[16:19], a[36:39], v[196:199]
    v_exp_f32 v71, v71
    v_mfma_f32_16x16x32_bf16 v[200:203], v[16:19], a[40:43], v[200:203]
    v_add_f32 v70, 1.0, v70
    v_rcp_f32 v69, v69
    v_mfma_f32_16x16x32_bf16 v[200:203], v[20:23], a[56:59], v[200:203]
    v_mul_f32 v68, v68, v76
    v_add_f32 v71, 1.0, v71
    v_mfma_f32_16x16x32_bf16 v[204:207], v[20:23], a[60:63], v[204:207]
    s_waitcnt vmcnt(10)
    s_barrier
    ds_read_b128 v[20:23], v5 offset:45056
    v_mfma_f32_16x16x32_bf16 v[204:207], v[16:19], a[44:47], v[204:207]
    s_waitcnt lgkmcnt(1)
    ds_read_b128 v[16:19], v5 offset:40960
    v_mul_f32 v69, v69, v77
    v_mfma_f32_16x16x32_bf16 v[220:223], v[24:27], a[44:47], v[220:223]
    s_add_u32 m0, s19, 16384
    s_add_u32 s21, s21, 4096
    ds_read_b128 v[36:39], v52 offset:24576
    buffer_load_dwordx4 v5, s[8:11], s21 offen sc1 lds
    v_mfma_f32_16x16x32_bf16 v[220:223], v[28:31], a[60:63], v[220:223]
    s_add_u32 m0, s19, 20480
    ds_read_b128 v[40:43], v7 offset:61440
    v_cvt_pk_bf16_f32 v72, v64, v65
    v_mfma_f32_16x16x32_bf16 v[216:219], v[28:31], a[56:59], v[216:219]
    s_lshl_b32 s21, s63, 13
    v_rcp_f32 v70, v70
    v_mfma_f32_16x16x32_bf16 v[216:219], v[24:27], a[40:43], v[216:219]
    s_add_u32 s21, s21, s27
    v_rcp_f32 v71, v71
    v_mfma_f32_16x16x32_bf16 v[212:215], v[24:27], a[36:39], v[212:215]
    v_mul_f32 v70, v70, v78
    v_mul_f32 v71, v71, v79
    v_cvt_pk_bf16_f32 v73, v66, v67
    v_mfma_f32_16x16x32_bf16 v[212:215], v[28:31], a[52:55], v[212:215]
    v_cvt_pk_bf16_f32 v74, v68, v69
    v_cvt_pk_bf16_f32 v75, v70, v71
    v_mfma_f32_16x16x32_bf16 v[208:211], v[28:31], a[48:51], v[208:211]
    ds_read_b128 v[28:31], v5 offset:46080
    v_mul_f32 v88, v80, v88
    v_mfma_f32_16x16x32_bf16 v[208:211], v[24:27], a[32:35], v[208:211]
    s_waitcnt lgkmcnt(1)
    ds_read_b128 v[24:27], v5 offset:41984
    buffer_load_dwordx4 v5, s[8:11], s21 offen sc1 lds
    v_mfma_f32_16x16x32_bf16 v[32:35], v[36:39], v[40:43], 0
    v_mul_f32 v80, s40, v80
    v_mul_f32 v89, v81, v89
    v_mul_f32 v81, s40, v81
    v_mfma_f32_16x16x32_bf16 v[160:163], v[16:19], a[64:67], v[160:163]
    v_exp_f32 v80, v80
    v_mfma_f32_16x16x32_bf16 v[160:163], v[20:23], a[80:83], v[160:163]
    v_mul_f32 v90, v82, v90
    v_mul_f32 v82, s40, v82
    v_mfma_f32_16x16x32_bf16 v[164:167], v[20:23], a[84:87], v[164:167]
    v_exp_f32 v81, v81
    v_mfma_f32_16x16x32_bf16 v[164:167], v[16:19], a[68:71], v[164:167]
    v_add_f32 v80, 1.0, v80
    v_mul_f32 v91, v83, v91
    v_mul_f32 v83, s40, v83
    v_mfma_f32_16x16x32_bf16 v[168:171], v[16:19], a[72:75], v[168:171]
    v_exp_f32 v82, v82
    v_mfma_f32_16x16x32_bf16 v[168:171], v[20:23], a[88:91], v[168:171]
    v_add_f32 v81, 1.0, v81
    v_mul_f32 v92, v84, v92
    v_mfma_f32_16x16x32_bf16 v[172:175], v[20:23], a[92:95], v[172:175]
    ds_read_b128 v[20:23], v5 offset:47104
    v_mul_f32 v84, s40, v84
    v_mfma_f32_16x16x32_bf16 v[172:175], v[16:19], a[76:79], v[172:175]
    s_waitcnt lgkmcnt(1)
    ds_read_b128 v[16:19], v5 offset:43008
    v_rcp_f32 v80, v80
    v_mfma_f32_16x16x32_bf16 v[188:191], v[24:27], a[76:79], v[188:191]
    ds_read_b128 v[44:47], v52 offset:28672
    v_add_f32 v82, 1.0, v82
    v_mfma_f32_16x16x32_bf16 v[188:191], v[28:31], a[92:95], v[188:191]
    ds_read_b128 v[48:51], v7 offset:62464
    v_mul_f32 v80, v80, v88
    v_mfma_f32_16x16x32_bf16 v[184:187], v[28:31], a[88:91], v[184:187]
    v_exp_f32 v83, v83
    v_mfma_f32_16x16x32_bf16 v[184:187], v[24:27], a[72:75], v[184:187]
    v_rcp_f32 v81, v81
    v_mul_f32 v93, v85, v93
    v_mfma_f32_16x16x32_bf16 v[180:183], v[24:27], a[68:71], v[180:183]
    v_exp_f32 v84, v84
    v_mfma_f32_16x16x32_bf16 v[180:183], v[28:31], a[84:87], v[180:183]
    v_mul_f32 v85, s40, v85
    v_add_f32 v83, 1.0, v83
    v_mfma_f32_16x16x32_bf16 v[176:179], v[28:31], a[80:83], v[176:179]
    ds_read_b128 v[28:31], v5 offset:48128
    v_mul_f32 v81, v81, v89
    v_mfma_f32_16x16x32_bf16 v[176:179], v[24:27], a[64:67], v[176:179]
    s_waitcnt lgkmcnt(1)
    ds_read_b128 v[24:27], v5 offset:44032
    v_rcp_f32 v82, v82
    v_mfma_f32_16x16x32_bf16 v[32:35], v[44:47], v[48:51], v[32:35]
    ds_read_b128 v[36:39], v52 offset:32768
    v_mul_f32 v94, v86, v94
    v_mfma_f32_16x16x32_bf16 v[192:195], v[16:19], a[64:67], v[192:195]
    ds_read_b128 v[40:43], v7 offset:63488
    v_mul_f32 v86, s40, v86
    v_mfma_f32_16x16x32_bf16 v[192:195], v[20:23], a[80:83], v[192:195]
    v_exp_f32 v85, v85
    v_mfma_f32_16x16x32_bf16 v[196:199], v[20:23], a[84:87], v[196:199]
    v_add_f32 v84, 1.0, v84
    v_rcp_f32 v83, v83
    v_mfma_f32_16x16x32_bf16 v[196:199], v[16:19], a[68:71], v[196:199]
    v_mul_f32 v82, v82, v90
    v_mul_f32 v95, v87, v95
    v_mfma_f32_16x16x32_bf16 v[200:203], v[16:19], a[72:75], v[200:203]
    v_exp_f32 v86, v86
    v_mfma_f32_16x16x32_bf16 v[200:203], v[20:23], a[88:91], v[200:203]
    v_mul_f32 v87, s40, v87
    v_add_f32 v85, 1.0, v85
    v_mfma_f32_16x16x32_bf16 v[204:207], v[20:23], a[92:95], v[204:207]
    ds_read_b128 v[20:23], v5 offset:53248
    v_rcp_f32 v84, v84
    v_mfma_f32_16x16x32_bf16 v[204:207], v[16:19], a[76:79], v[204:207]
    s_waitcnt lgkmcnt(1)
    ds_read_b128 v[16:19], v5 offset:49152
    v_mul_f32 v83, v83, v91
    v_mfma_f32_16x16x32_bf16 v[32:35], v[36:39], v[40:43], v[32:35]
    v_exp_f32 v87, v87
    v_mfma_f32_16x16x32_bf16 v[220:223], v[24:27], a[76:79], v[220:223]
    v_add_f32 v86, 1.0, v86
    v_mul_f32 v84, v84, v92
    v_mfma_f32_16x16x32_bf16 v[220:223], v[28:31], a[92:95], v[220:223]
    v_rcp_f32 v85, v85
    v_add_f32 v87, 1.0, v87
    v_mfma_f32_16x16x32_bf16 v[216:219], v[28:31], a[88:91], v[216:219]
    v_rcp_f32 v86, v86
    v_mfma_f32_16x16x32_bf16 v[216:219], v[24:27], a[72:75], v[216:219]
    v_mul_f32 v85, v85, v93
    v_mul_f32 v86, v86, v94
    v_mfma_f32_16x16x32_bf16 v[212:215], v[24:27], a[68:71], v[212:215]
    v_rcp_f32 v87, v87
    v_mfma_f32_16x16x32_bf16 v[212:215], v[28:31], a[84:87], v[212:215]
    v_mul_f32 v87, v87, v95
    v_cvt_pk_bf16_f32 v88, v80, v81
    v_cvt_pk_bf16_f32 v89, v82, v83
    v_mfma_f32_16x16x32_bf16 v[208:211], v[28:31], a[80:83], v[208:211]
    ds_read_b128 v[28:31], v5 offset:54272
    v_cvt_pk_bf16_f32 v90, v84, v85
    v_mfma_f32_16x16x32_bf16 v[208:211], v[24:27], a[64:67], v[208:211]
    s_waitcnt lgkmcnt(1)
    ds_read_b128 v[24:27], v5 offset:50176
    v_cvt_pk_bf16_f32 v91, v86, v87
    v_mfma_f32_16x16x32_bf16 v[160:163], v[16:19], a[96:99], v[160:163]
    ds_read_b128 v[44:47], v52 offset:36864
    v_mfma_f32_16x16x32_bf16 v[160:163], v[20:23], a[112:115], v[160:163]
    ds_read_b128 v[48:51], v7 offset:64512
    s_add_u32 s39, s30, 86144
    buffer_store_dwordx4 v[72:75], v5, s[8:11], s39 offen offset:0 sc1
    v_mfma_f32_16x16x32_bf16 v[164:167], v[20:23], a[116:119], v[164:167]
    v_mfma_f32_16x16x32_bf16 v[164:167], v[16:19], a[100:103], v[164:167]
    v_mfma_f32_16x16x32_bf16 v[168:171], v[16:19], a[104:107], v[168:171]
    v_mfma_f32_16x16x32_bf16 v[168:171], v[20:23], a[120:123], v[168:171]
    v_mfma_f32_16x16x32_bf16 v[172:175], v[20:23], a[124:127], v[172:175]
    ds_read_b128 v[20:23], v5 offset:55296
    v_mfma_f32_16x16x32_bf16 v[172:175], v[16:19], a[108:111], v[172:175]
    s_waitcnt lgkmcnt(1)
    ds_read_b128 v[16:19], v5 offset:51200
    v_mfma_f32_16x16x32_bf16 v[32:35], v[44:47], v[48:51], v[32:35]
    s_add_u32 s39, s30, 86144
    buffer_store_dwordx4 v[88:91], v5, s[8:11], s39 offen offset:1024 sc1
    v_mul_f32 v104, v96, v104
    v_mfma_f32_16x16x32_bf16 v[188:191], v[24:27], a[108:111], v[188:191]
    v_mul_f32 v96, s40, v96
    v_mul_f32 v105, v97, v105
    v_mul_f32 v97, s40, v97
    v_mfma_f32_16x16x32_bf16 v[188:191], v[28:31], a[124:127], v[188:191]
    v_exp_f32 v96, v96
    v_mfma_f32_16x16x32_bf16 v[184:187], v[28:31], a[120:123], v[184:187]
    v_mul_f32 v106, v98, v106
    v_mul_f32 v98, s40, v98
    v_mfma_f32_16x16x32_bf16 v[184:187], v[24:27], a[104:107], v[184:187]
    v_exp_f32 v97, v97
    v_mfma_f32_16x16x32_bf16 v[180:183], v[24:27], a[100:103], v[180:183]
    v_add_f32 v96, 1.0, v96
    v_mul_f32 v107, v99, v107
    v_mul_f32 v99, s40, v99
    v_mfma_f32_16x16x32_bf16 v[180:183], v[28:31], a[116:119], v[180:183]
    v_exp_f32 v98, v98
    v_mfma_f32_16x16x32_bf16 v[176:179], v[28:31], a[112:115], v[176:179]
    ds_read_b128 v[28:31], v5 offset:56320
    v_add_f32 v97, 1.0, v97
    v_mfma_f32_16x16x32_bf16 v[176:179], v[24:27], a[96:99], v[176:179]
    s_waitcnt lgkmcnt(1)
    ds_read_b128 v[24:27], v5 offset:52224
    v_mul_f32 v108, v100, v108
    v_mfma_f32_16x16x32_bf16 v[192:195], v[16:19], a[96:99], v[192:195]
    ds_read_b128 v[36:39], v52 offset:40960
    v_rcp_f32 v96, v96
    v_mfma_f32_16x16x32_bf16 v[192:195], v[20:23], a[112:115], v[192:195]
    ds_read_b128 v[40:43], v12 offset:0
    v_mul_f32 v100, s40, v100
    v_mfma_f32_16x16x32_bf16 v[196:199], v[20:23], a[116:119], v[196:199]
    v_exp_f32 v99, v99
    v_mfma_f32_16x16x32_bf16 v[196:199], v[16:19], a[100:103], v[196:199]
    v_add_f32 v98, 1.0, v98
    v_mul_f32 v96, v96, v104
    v_mfma_f32_16x16x32_bf16 v[200:203], v[16:19], a[104:107], v[200:203]
    v_rcp_f32 v97, v97
    v_mul_f32 v109, v101, v109
    v_mfma_f32_16x16x32_bf16 v[200:203], v[20:23], a[120:123], v[200:203]
    v_exp_f32 v100, v100
    v_mfma_f32_16x16x32_bf16 v[204:207], v[20:23], a[124:127], v[204:207]
    s_waitcnt vmcnt(5)
    s_barrier
    s_add_u32 m0, s19, 24576
    s_add_u32 s21, s21, 4096
    ds_read_b128 v[20:23], v5 offset:0
    buffer_load_dwordx4 v5, s[8:11], s21 offen sc1 lds
    v_mfma_f32_16x16x32_bf16 v[204:207], v[16:19], a[108:111], v[204:207]
    s_waitcnt lgkmcnt(1)
    ds_read_b128 v[16:19], v5 offset:57344
    v_mul_f32 v101, s40, v101
    v_mfma_f32_16x16x32_bf16 v[32:35], v[36:39], v[40:43], v[32:35]
    s_add_u32 m0, s19, 28672
    ds_read_b128 v[44:47], v52 offset:45056
    v_add_f32 v99, 1.0, v99
    v_mul_f32 v97, v97, v105
    v_mfma_f32_16x16x32_bf16 v[220:223], v[24:27], a[108:111], v[220:223]
    s_lshl_b32 s21, s64, 13
    ds_read_b128 v[48:51], v12 offset:1024
    v_mul_f32 v110, v102, v110
    v_mfma_f32_16x16x32_bf16 v[220:223], v[28:31], a[124:127], v[220:223]
    s_add_u32 s21, s21, s27
    v_rcp_f32 v98, v98
    v_mfma_f32_16x16x32_bf16 v[216:219], v[28:31], a[120:123], v[216:219]
    v_exp_f32 v101, v101
    v_mfma_f32_16x16x32_bf16 v[216:219], v[24:27], a[104:107], v[216:219]
    v_mul_f32 v102, s40, v102
    v_add_f32 v100, 1.0, v100
    v_mul_f32 v98, v98, v106
    v_mfma_f32_16x16x32_bf16 v[212:215], v[24:27], a[100:103], v[212:215]
    buffer_load_dwordx4 v5, s[8:11], s21 offen sc1 lds
    v_mul_f32 v111, v103, v111
    v_mfma_f32_16x16x32_bf16 v[212:215], v[28:31], a[116:119], v[212:215]
    s_add_u32 m0, s19, 32768
    v_rcp_f32 v99, v99
    v_mfma_f32_16x16x32_bf16 v[208:211], v[28:31], a[112:115], v[208:211]
    s_add_u32 s21, s21, 4096
    ds_read_b128 v[28:31], v5 offset:1024
    v_mul_f32 v103, s40, v103
    v_mfma_f32_16x16x32_bf16 v[208:211], v[24:27], a[96:99], v[208:211]
    s_waitcnt lgkmcnt(1)
    ds_read_b128 v[24:27], v5 offset:58368
    v_exp_f32 v102, v102
    v_mfma_f32_16x16x32_bf16 v[32:35], v[44:47], v[48:51], v[32:35]
    v_add_f32 v101, 1.0, v101
    v_mul_f32 v99, v99, v107
    v_mfma_f32_16x16x32_bf16 v[160:163], v[16:19], a[128:131], v[160:163]
    v_rcp_f32 v100, v100
    v_mfma_f32_16x16x32_bf16 v[160:163], v[20:23], a[144:147], v[160:163]
    v_exp_f32 v103, v103
    v_mfma_f32_16x16x32_bf16 v[164:167], v[20:23], a[148:151], v[164:167]
    v_add_f32 v102, 1.0, v102
    v_rcp_f32 v101, v101
    v_mfma_f32_16x16x32_bf16 v[164:167], v[16:19], a[132:135], v[164:167]
    buffer_load_dwordx4 v5, s[8:11], s21 offen sc1 lds
    v_mul_f32 v100, v100, v108
    v_mfma_f32_16x16x32_bf16 v[168:171], v[16:19], a[136:139], v[168:171]
    s_add_u32 m0, s19, 36864
    v_add_f32 v103, 1.0, v103
    v_mul_f32 v101, v101, v109
    v_mfma_f32_16x16x32_bf16 v[168:171], v[20:23], a[152:155], v[168:171]
    s_lshl_b32 s21, s56, 12
    v_rcp_f32 v102, v102
    v_mfma_f32_16x16x32_bf16 v[172:175], v[20:23], a[156:159], v[172:175]
    s_add_u32 s21, s21, s69
    ds_read_b128 v[20:23], v5 offset:2048
    v_rcp_f32 v103, v103
    v_mfma_f32_16x16x32_bf16 v[172:175], v[16:19], a[140:143], v[172:175]
    s_waitcnt lgkmcnt(1)
    ds_read_b128 v[16:19], v5 offset:59392
    v_mul_f32 v102, v102, v110
    v_mfma_f32_16x16x32_bf16 v[188:191], v[24:27], a[140:143], v[188:191]
    ds_read_b128 v[36:39], v52 offset:49152
    v_mul_f32 v103, v103, v111
    v_mfma_f32_16x16x32_bf16 v[188:191], v[28:31], a[156:159], v[188:191]
    ds_read_b128 v[40:43], v12 offset:2048
    v_cvt_pk_bf16_f32 v104, v96, v97
    v_mfma_f32_16x16x32_bf16 v[184:187], v[28:31], a[152:155], v[184:187]
    v_cvt_pk_bf16_f32 v105, v98, v99
    v_cvt_pk_bf16_f32 v106, v100, v101
    v_cvt_pk_bf16_f32 v107, v102, v103
    v_mfma_f32_16x16x32_bf16 v[184:187], v[24:27], a[136:139], v[184:187]
    buffer_load_dwordx4 v5, s[8:11], s21 offen sc1 lds
    v_mul_f32 v120, v112, v120
    v_mfma_f32_16x16x32_bf16 v[180:183], v[24:27], a[132:135], v[180:183]
    v_mul_f32 v112, s40, v112
    v_mul_f32 v121, v113, v121
    v_mfma_f32_16x16x32_bf16 v[180:183], v[28:31], a[148:151], v[180:183]
    v_exp_f32 v112, v112
    v_mfma_f32_16x16x32_bf16 v[176:179], v[28:31], a[144:147], v[176:179]
    ds_read_b128 v[28:31], v5 offset:3072
    v_mul_f32 v113, s40, v113
    v_mul_f32 v122, v114, v122
    v_mfma_f32_16x16x32_bf16 v[176:179], v[24:27], a[128:131], v[176:179]
    s_waitcnt lgkmcnt(1)
    ds_read_b128 v[24:27], v5 offset:60416
    v_mul_f32 v114, s40, v114
    v_mfma_f32_16x16x32_bf16 v[32:35], v[36:39], v[40:43], v[32:35]
    v_exp_f32 v113, v113
    v_mfma_f32_16x16x32_bf16 v[192:195], v[16:19], a[128:131], v[192:195]
    v_add_f32 v112, 1.0, v112
    v_mul_f32 v123, v115, v123
    v_mfma_f32_16x16x32_bf16 v[192:195], v[20:23], a[144:147], v[192:195]
    v_exp_f32 v114, v114
    v_mul_f32 v115, s40, v115
    v_mfma_f32_16x16x32_bf16 v[196:199], v[20:23], a[148:151], v[196:199]
    v_add_f32 v113, 1.0, v113
    v_mul_f32 v124, v116, v124
    v_mfma_f32_16x16x32_bf16 v[196:199], v[16:19], a[132:135], v[196:199]
    v_rcp_f32 v112, v112
    v_mfma_f32_16x16x32_bf16 v[200:203], v[16:19], a[136:139], v[200:203]
    v_exp_f32 v115, v115
    v_mfma_f32_16x16x32_bf16 v[200:203], v[20:23], a[152:155], v[200:203]
    v_mul_f32 v116, s40, v116
    v_add_f32 v114, 1.0, v114
    v_mul_f32 v112, v112, v120
    v_mfma_f32_16x16x32_bf16 v[204:207], v[20:23], a[156:159], v[204:207]
    ds_read_b128 v[20:23], v5 offset:8192
    v_mul_f32 v125, v117, v125
    v_mfma_f32_16x16x32_bf16 v[204:207], v[16:19], a[140:143], v[204:207]
    s_waitcnt lgkmcnt(1)
    ds_read_b128 v[16:19], v5 offset:4096
    v_mul_f32 v117, s40, v117
    v_mfma_f32_16x16x32_bf16 v[220:223], v[24:27], a[140:143], v[220:223]
    s_barrier
    ds_read_b128 v[44:47], v52 offset:53248
    v_add_f32 v115, 1.0, v115
    v_mfma_f32_16x16x32_bf16 v[220:223], v[28:31], a[156:159], v[220:223]
    ds_read_b128 v[48:51], v12 offset:3072
    v_rcp_f32 v113, v113
    v_mfma_f32_16x16x32_bf16 v[216:219], v[28:31], a[152:155], v[216:219]
    v_exp_f32 v116, v116
    v_mfma_f32_16x16x32_bf16 v[216:219], v[24:27], a[136:139], v[216:219]
    v_rcp_f32 v114, v114
    v_mfma_f32_16x16x32_bf16 v[212:215], v[24:27], a[132:135], v[212:215]
    v_mul_f32 v113, v113, v121
    v_mul_f32 v126, v118, v126
    v_mfma_f32_16x16x32_bf16 v[212:215], v[28:31], a[148:151], v[212:215]
    v_exp_f32 v117, v117
    v_mul_f32 v118, s40, v118
    v_mfma_f32_16x16x32_bf16 v[208:211], v[28:31], a[144:147], v[208:211]
    ds_read_b128 v[28:31], v5 offset:9216
    v_add_f32 v116, 1.0, v116
    v_mfma_f32_16x16x32_bf16 v[208:211], v[24:27], a[128:131], v[208:211]
    s_waitcnt lgkmcnt(1)
    ds_read_b128 v[24:27], v5 offset:5120
    v_mul_f32 v114, v114, v122
    v_mfma_f32_16x16x32_bf16 v[32:35], v[44:47], v[48:51], v[32:35]
    ds_read_b128 v[36:39], v52 offset:57344
    v_mul_f32 v127, v119, v127
    v_mfma_f32_16x16x32_bf16 v[160:163], v[16:19], a[160:163], v[160:163]
    ds_read_b128 v[40:43], v12 offset:4096
    v_rcp_f32 v115, v115
    v_mfma_f32_16x16x32_bf16 v[160:163], v[20:23], a[176:179], v[160:163]
    v_exp_f32 v118, v118
    v_mfma_f32_16x16x32_bf16 v[164:167], v[20:23], a[180:183], v[164:167]
    v_mul_f32 v119, s40, v119
    v_add_f32 v117, 1.0, v117
    v_mfma_f32_16x16x32_bf16 v[164:167], v[16:19], a[164:167], v[164:167]
    v_rcp_f32 v116, v116
    v_mfma_f32_16x16x32_bf16 v[168:171], v[16:19], a[168:171], v[168:171]
    v_mul_f32 v115, v115, v123
    v_exp_f32 v119, v119
    v_mfma_f32_16x16x32_bf16 v[168:171], v[20:23], a[184:187], v[168:171]
    v_add_f32 v118, 1.0, v118
    v_mul_f32 v116, v116, v124
    v_mfma_f32_16x16x32_bf16 v[172:175], v[20:23], a[188:191], v[172:175]
    ds_read_b128 v[20:23], v5 offset:10240
    v_add_f32 v119, 1.0, v119
    v_mfma_f32_16x16x32_bf16 v[172:175], v[16:19], a[172:175], v[172:175]
    s_waitcnt lgkmcnt(1)
    ds_read_b128 v[16:19], v5 offset:6144
    v_cvt_pk_bf16_f32 v120, v112, v113
    v_mfma_f32_16x16x32_bf16 v[32:35], v[36:39], v[40:43], v[32:35]
    v_rcp_f32 v117, v117
    s_nop 0
    v_mul_f32 v117, v117, v125
    v_mfma_f32_16x16x32_bf16 v[188:191], v[24:27], a[172:175], v[188:191]
    v_rcp_f32 v118, v118
    v_mfma_f32_16x16x32_bf16 v[188:191], v[28:31], a[188:191], v[188:191]
    v_rcp_f32 v119, v119
    v_mfma_f32_16x16x32_bf16 v[184:187], v[28:31], a[184:187], v[184:187]
    v_mul_f32 v118, v118, v126
    v_mul_f32 v119, v119, v127
    v_mfma_f32_16x16x32_bf16 v[184:187], v[24:27], a[168:171], v[184:187]
    v_cvt_pk_bf16_f32 v121, v114, v115
    v_cvt_pk_bf16_f32 v122, v116, v117
    v_cvt_pk_bf16_f32 v123, v118, v119
    v_mfma_f32_16x16x32_bf16 v[180:183], v[24:27], a[164:167], v[180:183]
    s_add_u32 s39, s30, 16384
    buffer_store_dwordx4 v[104:107], v5, s[8:11], s39 offen offset:0 sc1
    v_mfma_f32_16x16x32_bf16 v[180:183], v[28:31], a[180:183], v[180:183]
    v_mfma_f32_16x16x32_bf16 v[176:179], v[28:31], a[176:179], v[176:179]
    ds_read_b128 v[28:31], v5 offset:11264
    v_mfma_f32_16x16x32_bf16 v[176:179], v[24:27], a[160:163], v[176:179]
    s_waitcnt lgkmcnt(1)
    ds_read_b128 v[24:27], v5 offset:7168
    v_mfma_f32_16x16x32_bf16 v[192:195], v[16:19], a[160:163], v[192:195]
    ds_read_b128 v[44:47], v52 offset:0
    v_mfma_f32_16x16x32_bf16 v[192:195], v[20:23], a[176:179], v[192:195]
    ds_read_b128 v[48:51], v12 offset:5120
    v_mfma_f32_16x16x32_bf16 v[196:199], v[20:23], a[180:183], v[196:199]
    s_add_u32 s39, s30, 16384
    buffer_store_dwordx4 v[120:123], v5, s[8:11], s39 offen offset:1024 sc1
    v_lshrrev_b32 v97, 8, v5
    v_mfma_f32_16x16x32_bf16 v[196:199], v[16:19], a[164:167], v[196:199]
    v_lshlrev_b32 v97, 10, v97
    v_and_b32 v98, 0xc0, v5
    v_lshl_add_u32 v97, v98, 1, v97
    v_mfma_f32_16x16x32_bf16 v[200:203], v[16:19], a[168:171], v[200:203]
    s_mul_i32 s89, s16, 144
    v_add_u32 v97, 61440, v97
    v_bfe_u32 v98, v5, 4, 2
    v_mfma_f32_16x16x32_bf16 v[200:203], v[20:23], a[184:187], v[200:203]
    s_add_u32 s92, s86, 0
    s_and_b32 s92, s92, 3
    s_lshl_b32 s92, s92, 5
    v_mfma_f32_16x16x32_bf16 v[204:207], v[20:23], a[188:191], v[204:207]
    s_waitcnt vmcnt(5)
    s_barrier
    s_add_u32 m0, s19, 40960
    s_lshl_b32 s21, s57, 12
    s_add_u32 s21, s21, s69
    ds_read_b128 v[20:23], v5 offset:16384
    buffer_load_dwordx4 v5, s[8:11], s21 offen sc1 lds
    v_mfma_f32_16x16x32_bf16 v[204:207], v[16:19], a[172:175], v[204:207]
    s_waitcnt lgkmcnt(1)
    ds_read_b128 v[16:19], v5 offset:12288
    s_add_u32 s92, s92, s89
    v_lshl_add_u32 v99, v98, 3, s92
    v_mfma_f32_16x16x32_bf16 v[32:35], v[44:47], v[48:51], v[32:35]
    s_add_u32 m0, s19, 45056
    ds_read_b128 v[36:39], v52 offset:4096
    v_lshrrev_b32 v104, 6, v99
    v_mfma_f32_16x16x32_bf16 v[220:223], v[24:27], a[172:175], v[220:223]
    s_lshl_b32 s21, s58, 12
    ds_read_b128 v[40:43], v12 offset:6144
    v_lshl_add_u32 v104, v104, 12, v97
    v_mfma_f32_16x16x32_bf16 v[220:223], v[28:31], a[188:191], v[220:223]
    s_add_u32 s21, s21, s69
    v_and_b32 v99, 63, v99
    v_lshl_add_u32 v104, v99, 1, v104
    v_mfma_f32_16x16x32_bf16 v[216:219], v[28:31], a[184:187], v[216:219]
    s_add_u32 s92, s86, 1
    s_and_b32 s92, s92, 3
    s_lshl_b32 s92, s92, 5
    s_add_u32 s92, s92, s89
    v_mfma_f32_16x16x32_bf16 v[216:219], v[24:27], a[168:171], v[216:219]
    v_lshl_add_u32 v99, v98, 3, s92
    v_lshrrev_b32 v105, 6, v99
    v_mfma_f32_16x16x32_bf16 v[212:215], v[24:27], a[164:167], v[212:215]
    buffer_load_dwordx4 v5, s[8:11], s21 offen sc1 lds
    v_lshl_add_u32 v105, v105, 12, v97
    v_mfma_f32_16x16x32_bf16 v[212:215], v[28:31], a[180:183], v[212:215]
    s_add_u32 m0, s19, 49152
    v_and_b32 v99, 63, v99
    v_lshl_add_u32 v105, v99, 1, v105
    v_mfma_f32_16x16x32_bf16 v[208:211], v[28:31], a[176:179], v[208:211]
    s_lshl_b32 s21, s59, 12
    ds_read_b128 v[28:31], v5 offset:17408
    s_add_u32 s92, s86, 2
    s_and_b32 s92, s92, 3
    v_mfma_f32_16x16x32_bf16 v[208:211], v[24:27], a[160:163], v[208:211]
    s_waitcnt lgkmcnt(1)
    ds_read_b128 v[24:27], v5 offset:13312
    s_lshl_b32 s92, s92, 5
    v_mfma_f32_16x16x32_bf16 v[32:35], v[36:39], v[40:43], v[32:35]
    s_add_u32 s92, s92, s89
    v_lshl_add_u32 v99, v98, 3, s92
    v_lshrrev_b32 v106, 6, v99
    v_mfma_f32_16x16x32_bf16 v[160:163], v[16:19], a[192:195], v[160:163]
    s_add_u32 s21, s21, s69
    v_lshl_add_u32 v106, v106, 12, v97
    v_and_b32 v99, 63, v99
    v_mfma_f32_16x16x32_bf16 v[160:163], v[20:23], a[208:211], v[160:163]
    v_lshl_add_u32 v106, v99, 1, v106
    s_add_u32 s92, s86, 3
    s_and_b32 s92, s92, 3
    v_mfma_f32_16x16x32_bf16 v[164:167], v[20:23], a[212:215], v[164:167]
    s_lshl_b32 s92, s92, 5
    s_add_u32 s92, s92, s89
    v_lshl_add_u32 v99, v98, 3, s92
    v_mfma_f32_16x16x32_bf16 v[164:167], v[16:19], a[196:199], v[164:167]
    buffer_load_dwordx4 v5, s[8:11], s21 offen sc1 lds
    v_lshrrev_b32 v107, 6, v99
    v_mfma_f32_16x16x32_bf16 v[168:171], v[16:19], a[200:203], v[168:171]
    s_add_u32 m0, s19, 53248
    v_lshl_add_u32 v107, v107, 12, v97
    v_and_b32 v99, 63, v99
    v_mfma_f32_16x16x32_bf16 v[168:171], v[20:23], a[216:219], v[168:171]
    s_lshl_b32 s21, s60, 12
    v_lshl_add_u32 v107, v99, 1, v107
    s_add_u32 s92, s89, 128
    v_lshl_add_u32 v99, v98, 2, s92
    v_mfma_f32_16x16x32_bf16 v[172:175], v[20:23], a[220:223], v[172:175]
    s_add_u32 s21, s21, s69
    ds_read_b128 v[20:23], v5 offset:18432
    v_lshrrev_b32 v108, 6, v99
    v_mfma_f32_16x16x32_bf16 v[172:175], v[16:19], a[204:207], v[172:175]
    s_waitcnt lgkmcnt(1)
    ds_read_b128 v[16:19], v5 offset:14336
    v_lshl_add_u32 v108, v108, 12, v97
    v_mfma_f32_16x16x32_bf16 v[188:191], v[24:27], a[204:207], v[188:191]
    ds_read_b128 v[44:47], v52 offset:8192
    v_and_b32 v99, 63, v99
    v_mfma_f32_16x16x32_bf16 v[188:191], v[28:31], a[220:223], v[188:191]
    ds_read_b128 v[48:51], v12 offset:7168
    v_lshl_add_u32 v108, v99, 1, v108
    v_mul_f32 v136, v128, v136
    v_mfma_f32_16x16x32_bf16 v[184:187], v[28:31], a[216:219], v[184:187]
    ds_read_b64_tr_b16 v[64:65], v104 offset:0
    v_mul_f32 v128, s40, v128
    v_mfma_f32_16x16x32_bf16 v[184:187], v[24:27], a[200:203], v[184:187]
    buffer_load_dwordx4 v5, s[8:11], s21 offen sc1 lds
    ds_read_b64_tr_b16 v[66:67], v104 offset:512
    v_mfma_f32_16x16x32_bf16 v[180:183], v[24:27], a[196:199], v[180:183]
    s_add_u32 m0, s19, 57344
    ds_read_b64_tr_b16 v[68:69], v104 offset:8
    v_mul_f32 v137, v129, v137
    v_mfma_f32_16x16x32_bf16 v[180:183], v[28:31], a[212:215], v[180:183]
    s_lshl_b32 s21, s61, 12
    ds_read_b64_tr_b16 v[70:71], v104 offset:520
    v_exp_f32 v128, v128
    v_mfma_f32_16x16x32_bf16 v[176:179], v[28:31], a[208:211], v[176:179]
    s_add_u32 s21, s21, s69
    ds_read_b128 v[28:31], v5 offset:19456
    v_mul_f32 v129, s40, v129
    v_mfma_f32_16x16x32_bf16 v[176:179], v[24:27], a[192:195], v[176:179]
    s_waitcnt lgkmcnt(5)
    ds_read_b128 v[24:27], v5 offset:15360
    v_mul_f32 v138, v130, v138
    v_mfma_f32_16x16x32_bf16 v[32:35], v[44:47], v[48:51], v[32:35]
    ds_read_b64_tr_b16 v[72:73], v105 offset:0
    v_mul_f32 v130, s40, v130
    v_mfma_f32_16x16x32_bf16 v[192:195], v[16:19], a[192:195], v[192:195]
    ds_read_b64_tr_b16 v[74:75], v105 offset:512
    v_exp_f32 v129, v129
    v_mfma_f32_16x16x32_bf16 v[192:195], v[20:23], a[208:211], v[192:195]
    ds_read_b64_tr_b16 v[76:77], v105 offset:8
    v_add_f32 v128, 1.0, v128
    v_mfma_f32_16x16x32_bf16 v[196:199], v[20:23], a[212:215], v[196:199]
    buffer_load_dwordx4 v5, s[8:11], s21 offen sc1 lds
    ds_read_b64_tr_b16 v[78:79], v105 offset:520
    v_mfma_f32_16x16x32_bf16 v[196:199], v[16:19], a[196:199], v[196:199]
    ds_read_b64_tr_b16 v[80:81], v106 offset:0
    v_mul_f32 v139, v131, v139
    v_mfma_f32_16x16x32_bf16 v[200:203], v[16:19], a[200:203], v[200:203]
    ds_read_b64_tr_b16 v[82:83], v106 offset:512
    v_exp_f32 v130, v130
    v_mfma_f32_16x16x32_bf16 v[200:203], v[20:23], a[216:219], v[200:203]
    ds_read_b64_tr_b16 v[84:85], v106 offset:8
    v_mul_f32 v131, s40, v131
    v_mfma_f32_16x16x32_bf16 v[204:207], v[20:23], a[220:223], v[204:207]
    ds_read_b128 v[20:23], v5 offset:24576
    v_add_f32 v129, 1.0, v129
    v_mfma_f32_16x16x32_bf16 v[204:207], v[16:19], a[204:207], v[204:207]
    s_waitcnt lgkmcnt(8)
    ds_read_b128 v[16:19], v5 offset:20480
    v_mul_f32 v140, v132, v140
    v_mfma_f32_16x16x32_bf16 v[220:223], v[24:27], a[204:207], v[220:223]
    ds_read_b128 v[36:39], v52 offset:12288
    v_rcp_f32 v128, v128
    v_mfma_f32_16x16x32_bf16 v[220:223], v[28:31], a[220:223], v[220:223]
    ds_read_b128 v[40:43], v12 offset:8192
    v_mul_f32 v132, s40, v132
    v_mfma_f32_16x16x32_bf16 v[216:219], v[28:31], a[216:219], v[216:219]
    ds_read_b64_tr_b16 v[86:87], v106 offset:520
    v_add_f32 v130, 1.0, v130
    v_mfma_f32_16x16x32_bf16 v[216:219], v[24:27], a[200:203], v[216:219]
    ds_read_b64_tr_b16 v[88:89], v107 offset:0
    v_mul_f32 v128, v128, v136
    v_mfma_f32_16x16x32_bf16 v[212:215], v[24:27], a[196:199], v[212:215]
    ds_read_b64_tr_b16 v[90:91], v107 offset:512
    v_exp_f32 v131, v131
    v_mfma_f32_16x16x32_bf16 v[212:215], v[28:31], a[212:215], v[212:215]
    ds_read_b64_tr_b16 v[92:93], v107 offset:8
    v_mul_f32 v141, v133, v141
    v_mfma_f32_16x16x32_bf16 v[208:211], v[28:31], a[208:211], v[208:211]
    ds_read_b128 v[28:31], v5 offset:25600
    v_mul_f32 v133, s40, v133
    v_mfma_f32_16x16x32_bf16 v[208:211], v[24:27], a[192:195], v[208:211]
    s_waitcnt lgkmcnt(5)
    ds_read_b128 v[24:27], v5 offset:21504
    v_add_f32 v131, 1.0, v131
    v_mfma_f32_16x16x32_bf16 v[32:35], v[36:39], v[40:43], v[32:35]
    ds_read_b128 v[44:47], v52 offset:16384
    v_rcp_f32 v129, v129
    v_mfma_f32_16x16x32_bf16 v[160:163], v[16:19], a[224:227], v[160:163]
    ds_read_b128 v[48:51], v12 offset:9216
    v_mul_f32 v129, v129, v137
    v_mfma_f32_16x16x32_bf16 v[160:163], v[20:23], a[240:243], v[160:163]
    ds_read_b64_tr_b16 v[94:95], v107 offset:520
    v_mul_f32 v142, v134, v142
    v_mfma_f32_16x16x32_bf16 v[164:167], v[20:23], a[244:247], v[164:167]
    ds_read_b64_tr_b16 v[100:101], v108 offset:0
    v_mul_f32 v134, s40, v134
    v_mfma_f32_16x16x32_bf16 v[164:167], v[16:19], a[228:231], v[164:167]
    ds_read_b64_tr_b16 v[102:103], v108 offset:512
    v_exp_f32 v132, v132
    v_mfma_f32_16x16x32_bf16 v[168:171], v[16:19], a[232:235], v[168:171]
    v_rcp_f32 v130, v130
    v_mfma_f32_16x16x32_bf16 v[168:171], v[20:23], a[248:251], v[168:171]
    v_exp_f32 v133, v133
    v_mfma_f32_16x16x32_bf16 v[172:175], v[20:23], a[252:255], v[172:175]
    ds_read_b128 v[20:23], v5 offset:26624
    v_add_f32 v132, 1.0, v132
    v_mfma_f32_16x16x32_bf16 v[172:175], v[16:19], a[236:239], v[172:175]
    s_waitcnt lgkmcnt(4)
    ds_read_b128 v[16:19], v5 offset:22528
    buffer_store_dwordx4 v[64:67], v5, s[8:11], s74 offen offset:0 sc1
    v_mul_f32 v130, v130, v138
    v_mfma_f32_16x16x32_bf16 v[32:35], v[44:47], v[48:51], v[32:35]
    v_rcp_f32 v131, v131
    v_mfma_f32_16x16x32_bf16 v[188:191], v[24:27], a[236:239], v[188:191]
    v_mul_f32 v143, v135, v143
    v_mul_f32 v135, s40, v135
    v_mfma_f32_16x16x32_bf16 v[188:191], v[28:31], a[252:255], v[188:191]
    v_exp_f32 v134, v134
    v_mfma_f32_16x16x32_bf16 v[184:187], v[28:31], a[248:251], v[184:187]
    v_add_f32 v133, 1.0, v133
    v_rcp_f32 v132, v132
    v_mfma_f32_16x16x32_bf16 v[184:187], v[24:27], a[232:235], v[184:187]
    v_mul_f32 v131, v131, v139
    v_add_f32 v134, 1.0, v134
    v_mfma_f32_16x16x32_bf16 v[180:183], v[24:27], a[228:231], v[180:183]
    buffer_store_dwordx4 v[68:71], v5, s[8:11], s74 offen offset:1024 sc1
    v_mul_f32 v132, v132, v140
    v_mfma_f32_16x16x32_bf16 v[180:183], v[28:31], a[244:247], v[180:183]
    v_exp_f32 v135, v135
    v_mfma_f32_16x16x32_bf16 v[176:179], v[28:31], a[240:243], v[176:179]
    ds_read_b128 v[28:31], v5 offset:27648
    v_rcp_f32 v133, v133
    v_mfma_f32_16x16x32_bf16 v[176:179], v[24:27], a[224:227], v[176:179]
    s_waitcnt lgkmcnt(1)
    ds_read_b128 v[24:27], v5 offset:23552
    v_add_f32 v135, 1.0, v135
    v_mfma_f32_16x16x32_bf16 v[192:195], v[16:19], a[224:227], v[192:195]
    ds_read_b128 v[36:39], v52 offset:20480
    v_mul_f32 v133, v133, v141
    v_mfma_f32_16x16x32_bf16 v[192:195], v[20:23], a[240:243], v[192:195]
    ds_read_b128 v[40:43], v12 offset:10240
    v_cvt_pk_bf16_f32 v136, v128, v129
    v_mfma_f32_16x16x32_bf16 v[196:199], v[20:23], a[244:247], v[196:199]
    buffer_store_dwordx4 v[72:75], v5, s[8:11], s75 offen offset:0 sc1
    v_rcp_f32 v134, v134
    v_mfma_f32_16x16x32_bf16 v[196:199], v[16:19], a[228:231], v[196:199]
    v_rcp_f32 v135, v135
    v_mfma_f32_16x16x32_bf16 v[200:203], v[16:19], a[232:235], v[200:203]
    v_mul_f32 v134, v134, v142
    v_mul_f32 v135, v135, v143
    v_mfma_f32_16x16x32_bf16 v[200:203], v[20:23], a[248:251], v[200:203]
    v_cvt_pk_bf16_f32 v137, v130, v131
    v_cvt_pk_bf16_f32 v138, v132, v133
    v_mfma_f32_16x16x32_bf16 v[204:207], v[20:23], a[252:255], v[204:207]
    s_waitcnt vmcnt(7)
    s_barrier
    s_add_u32 m0, s19, 0
    s_lshl_b32 s21, s62, 12
    s_add_u32 s21, s21, s69
    ds_read_b128 v[20:23], v5 offset:32768
    buffer_load_dwordx4 v5, s[8:11], s21 offen sc1 lds
    v_mfma_f32_16x16x32_bf16 v[204:207], v[16:19], a[236:239], v[204:207]
    s_waitcnt lgkmcnt(1)
    ds_read_b128 v[16:19], v5 offset:28672
    v_cvt_pk_bf16_f32 v139, v134, v135
    v_mfma_f32_16x16x32_bf16 v[32:35], v[36:39], v[40:43], v[32:35]
    s_add_u32 m0, s19, 4096
    buffer_store_dwordx4 v[76:79], v5, s[8:11], s75 offen offset:1024 sc1
    v_mul_f32 v152, v144, v152
    v_mfma_f32_16x16x32_bf16 v[220:223], v[24:27], a[236:239], v[220:223]
    s_lshl_b32 s21, s63, 12
    v_mul_f32 v144, s40, v144
    v_mul_f32 v153, v145, v153
    v_mfma_f32_16x16x32_bf16 v[220:223], v[28:31], a[252:255], v[220:223]
    s_add_u32 s21, s21, s69
    v_exp_f32 v144, v144
    v_mul_f32 v145, s40, v145
    v_mfma_f32_16x16x32_bf16 v[216:219], v[28:31], a[248:251], v[216:219]
    v_mul_f32 v154, v146, v154
    v_mul_f32 v146, s40, v146
    v_mfma_f32_16x16x32_bf16 v[216:219], v[24:27], a[232:235], v[216:219]
    v_exp_f32 v145, v145
    v_mfma_f32_16x16x32_bf16 v[212:215], v[24:27], a[228:231], v[212:215]
    buffer_load_dwordx4 v5, s[8:11], s21 offen sc1 lds
    v_add_f32 v144, 1.0, v144
    v_mfma_f32_16x16x32_bf16 v[212:215], v[28:31], a[244:247], v[212:215]
    s_add_u32 m0, s19, 8192
    buffer_store_dwordx4 v[80:83], v5, s[8:11], s76 offen offset:0 sc1
    v_mul_f32 v155, v147, v155
    v_mul_f32 v147, s40, v147
    v_mfma_f32_16x16x32_bf16 v[208:211], v[28:31], a[240:243], v[208:211]
    s_lshl_b32 s21, s64, 12
    ds_read_b128 v[28:31], v5 offset:33792
    v_add_f32 v145, 1.0, v145
    v_mfma_f32_16x16x32_bf16 v[208:211], v[24:27], a[224:227], v[208:211]
    s_waitcnt lgkmcnt(1)
    ds_read_b128 v[24:27], v5 offset:29696
    v_mul_f32 v156, v148, v156
    v_mfma_f32_16x16x32_bf16 v[160:163], v[16:19], v[224:227], v[160:163]
    s_add_u32 s21, s21, s69
    ds_read_b128 v[44:47], v52 offset:24576
    v_mul_f32 v148, s40, v148
    v_mfma_f32_16x16x32_bf16 v[160:163], v[20:23], v[240:243], v[160:163]
    ds_read_b128 v[48:51], v12 offset:11264
    v_exp_f32 v146, v146
    v_mfma_f32_16x16x32_bf16 v[164:167], v[20:23], v[244:247], v[164:167]
    v_rcp_f32 v144, v144
    v_mfma_f32_16x16x32_bf16 v[164:167], v[16:19], v[228:231], v[164:167]
    buffer_store_dwordx4 v[84:87], v5, s[8:11], s76 offen offset:1024 sc1
    v_add_f32 v146, 1.0, v146
    v_mfma_f32_16x16x32_bf16 v[168:171], v[16:19], v[232:235], v[168:171]
    buffer_load_dwordx4 v5, s[8:11], s21 offen sc1 lds
    v_mul_f32 v144, v144, v152
    v_mfma_f32_16x16x32_bf16 v[168:171], v[20:23], v[248:251], v[168:171]
    s_add_u32 m0, s19, 12288
    v_exp_f32 v147, v147
    v_mul_f32 v157, v149, v157
    v_mfma_f32_16x16x32_bf16 v[172:175], v[20:23], v[252:255], v[172:175]
    s_add_u32 s26, s26, 128
    ds_read_b128 v[20:23], v5 offset:34816
    v_mul_f32 v149, s40, v149
    v_mfma_f32_16x16x32_bf16 v[172:175], v[16:19], v[236:239], v[172:175]
    s_waitcnt lgkmcnt(1)
    ds_read_b128 v[16:19], v5 offset:30720
    v_add_f32 v147, 1.0, v147
    v_mfma_f32_16x16x32_bf16 v[32:35], v[44:47], v[48:51], v[32:35]
    s_mul_i32 s20, s56, 589824
    ds_read_b128 v[36:39], v52 offset:28672
    v_mul_f32 v158, v150, v158
    v_mfma_f32_16x16x32_bf16 v[188:191], v[24:27], v[236:239], v[188:191]
    s_add_u32 s20, s20, s26
    ds_read_b128 v[40:43], v12 offset:12288
    buffer_store_dwordx4 v[88:91], v5, s[8:11], s77 offen offset:0 sc1
    v_mul_f32 v150, s40, v150
    v_mfma_f32_16x16x32_bf16 v[188:191], v[28:31], v[252:255], v[188:191]
    v_rcp_f32 v145, v145
    v_mfma_f32_16x16x32_bf16 v[184:187], v[28:31], v[248:251], v[184:187]
    v_exp_f32 v148, v148
    v_mfma_f32_16x16x32_bf16 v[184:187], v[24:27], v[232:235], v[184:187]
    buffer_load_dwordx4 v6, s[12:15], s20 offen lds
    v_mul_f32 v145, v145, v153
    v_mfma_f32_16x16x32_bf16 v[180:183], v[24:27], v[228:231], v[180:183]
    s_add_u32 m0, s19, 16384
    v_rcp_f32 v146, v146
    v_add_f32 v148, 1.0, v148
    v_mfma_f32_16x16x32_bf16 v[180:183], v[28:31], v[244:247], v[180:183]
    s_add_u32 s20, s20, 294912
    v_exp_f32 v149, v149
    v_mfma_f32_16x16x32_bf16 v[176:179], v[28:31], v[240:243], v[176:179]
    ds_read_b128 v[28:31], v5 offset:35840
    buffer_store_dwordx4 v[92:95], v5, s[8:11], s77 offen offset:1024 sc1
    v_mfma_f32_16x16x32_bf16 v[176:179], v[24:27], v[224:227], v[176:179]
    s_waitcnt lgkmcnt(1)
    ds_read_b128 v[24:27], v5 offset:31744
    v_mul_f32 v146, v146, v154
    v_mfma_f32_16x16x32_bf16 v[32:35], v[36:39], v[40:43], v[32:35]
    v_rcp_f32 v147, v147
    v_mul_f32 v159, v151, v159
    v_mfma_f32_16x16x32_bf16 v[192:195], v[16:19], v[224:227], v[192:195]
    v_exp_f32 v150, v150
    v_mfma_f32_16x16x32_bf16 v[192:195], v[20:23], v[240:243], v[192:195]
    v_mul_f32 v151, s40, v151
    v_add_f32 v149, 1.0, v149
    v_mfma_f32_16x16x32_bf16 v[196:199], v[20:23], v[244:247], v[196:199]
    buffer_load_dwordx4 v6, s[12:15], s20 offen lds
    v_mul_f32 v147, v147, v155
    v_mfma_f32_16x16x32_bf16 v[196:199], v[16:19], v[228:231], v[196:199]
    buffer_store_dwordx4 v[100:103], v5, s[8:11], s78 offen offset:0 sc1
    v_rcp_f32 v148, v148
    v_mfma_f32_16x16x32_bf16 v[200:203], v[16:19], v[232:235], v[200:203]
    v_exp_f32 v151, v151
    v_mfma_f32_16x16x32_bf16 v[200:203], v[20:23], v[248:251], v[200:203]
    v_add_f32 v150, 1.0, v150
    v_mul_f32 v148, v148, v156
    v_mfma_f32_16x16x32_bf16 v[204:207], v[20:23], v[252:255], v[204:207]
    ds_read_b128 v[20:23], v5 offset:38912
    v_add_f32 v151, 1.0, v151
    v_mfma_f32_16x16x32_bf16 v[204:207], v[16:19], v[236:239], v[204:207]
    s_waitcnt lgkmcnt(1)
    ds_read_b128 v[16:19], v5 offset:36864
    v_rcp_f32 v149, v149
    v_mfma_f32_16x16x32_bf16 v[220:223], v[24:27], v[236:239], v[220:223]
    ds_read_b128 v[44:47], v52 offset:32768
    v_mul_f32 v149, v149, v157
    v_mfma_f32_16x16x32_bf16 v[220:223], v[28:31], v[252:255], v[220:223]
    ds_read_b128 v[48:51], v12 offset:13312
    v_cvt_pk_bf16_f32 v152, v144, v145
    v_mfma_f32_16x16x32_bf16 v[216:219], v[28:31], v[248:251], v[216:219]
    v_rcp_f32 v150, v150
    v_mfma_f32_16x16x32_bf16 v[216:219], v[24:27], v[232:235], v[216:219]
    v_rcp_f32 v151, v151
    v_mul_f32 v150, v150, v158
    v_mfma_f32_16x16x32_bf16 v[212:215], v[24:27], v[228:231], v[212:215]
    v_mul_f32 v151, v151, v159
    v_cvt_pk_bf16_f32 v153, v146, v147
    v_mfma_f32_16x16x32_bf16 v[212:215], v[28:31], v[244:247], v[212:215]
    v_cvt_pk_bf16_f32 v154, v148, v149
    v_cvt_pk_bf16_f32 v155, v150, v151
    v_mfma_f32_16x16x32_bf16 v[208:211], v[28:31], v[240:243], v[208:211]
    ds_read_b128 v[28:31], v5 offset:39936
    v_mfma_f32_16x16x32_bf16 v[208:211], v[24:27], v[224:227], v[208:211]
    s_waitcnt lgkmcnt(1)
    ds_read_b128 v[24:27], v5 offset:37888
    s_add_u32 s39, s30, 102528
    buffer_store_dwordx4 v[136:139], v5, s[8:11], s39 offen offset:0 sc1
    v_mfma_f32_16x16x32_bf16 v[32:35], v[44:47], v[48:51], v[32:35]
    s_add_u32 s39, s30, 102528
    buffer_store_dwordx4 v[152:155], v5, s[8:11], s39 offen offset:1024 sc1
    v_bfe_u32 v62, v5, 4, 4
    v_mul_u32_u24 v57, 72, v62
    v_lshrrev_b32 v54, 8, v5
    v_lshl_add_u32 v57, v54, 3, v57
    v_lshlrev_b32 v54, 2, v54
    v_sub_u32 v62, v62, v54
    v_and_b32 v61, 16, v5
    s_mul_i32 s89, s16, 4608
    s_add_u32 s89, s89, 61440
    s_add_u32 s92, s89, 1152
    v_add_u32 v53, s92, v57
    s_and_b32 s92, s16, 1
    s_lshl_b32 s92, s92, 5
    s_add_u32 s92, s92, 61440
    s_cmp_lt_u32 s16, 2
    s_cselect_b32 s92, 86208, s92
    v_add_u32 v59, s92, v57
    s_mov_b32 s92, 86208
    s_cmp_eq_u32 s16, 0
    s_cselect_b32 s92, 81088, s92
    s_cmp_eq_u32 s16, 3
    s_cselect_b32 s92, 81096, s92
    v_add_u32 v54, s92, v5
    v_lshrrev_b32 v57, 6, v5
    v_mul_u32_u24 v57, 72, v57
    v_add_u32 v58, s89, v57
    v_bfe_u32 v57, v5, 4, 2
    v_lshl_add_u32 v55, v57, 3, v58
    s_sub_u32 s92, s37, s36
    s_sub_u32 s92, s92, 256
    v_bfe_u32 v60, v5, 8, 1
    v_mul_lo_u32 v60, v60, s92
    v_lshrrev_b32 v57, 9, v5
    v_mul_u32_u24 v56, 86144, v57
    v_lshlrev_b32 v13, 9, v57
    v_add_u32 v13, v13, v5
    v_bfe_u32 v57, v5, 8, 1
    v_lshl_add_u32 v56, v57, 10, v56
    v_and_b32 v57, 0xf0, v5
    v_add_u32 v56, v56, v57
    v_add_u32 v60, v60, v13
    s_mov_b64 s[42:43], 0xffff
    s_or_b32 s100, s18, s16
    s_cmp_eq_u32 s100, 0
    s_cselect_b32 s100, 0xf149f2ca, 0
    v_mfma_f32_16x16x32_bf16 v[128:131], v[16:19], a[0:3], 0
    v_mfma_f32_16x16x32_bf16 v[128:131], v[20:23], a[16:19], v[128:131]
    v_mfma_f32_16x16x32_bf16 v[132:135], v[20:23], a[20:23], 0
    v_mfma_f32_16x16x32_bf16 v[132:135], v[16:19], a[4:7], v[132:135]
    v_mfma_f32_16x16x32_bf16 v[144:147], v[16:19], a[8:11], 0
    v_cvt_pk_bf16_f32 v32, v32, v33
    v_cvt_pk_bf16_f32 v33, v34, v35
    v_mfma_f32_16x16x32_bf16 v[144:147], v[20:23], a[24:27], v[144:147]
    ds_write_b64 v54, v[32:33]
    ds_write_b64 v59, v[32:33]
    v_mfma_f32_16x16x32_bf16 v[148:151], v[20:23], a[28:31], 0
    ds_read_b128 v[20:23], v5 offset:43008
    v_cvt_pk_bf16_f32 v160, v160, v161
    v_mfma_f32_16x16x32_bf16 v[148:151], v[16:19], a[12:15], v[148:151]
    s_waitcnt lgkmcnt(3)
    ds_read_b128 v[16:19], v5 offset:40960
    v_cvt_pk_bf16_f32 v161, v162, v163
    v_mfma_f32_16x16x32_bf16 v[156:159], v[24:27], a[12:15], 0
    v_cvt_pk_bf16_f32 v192, v192, v193
    v_cvt_pk_bf16_f32 v193, v194, v195
    v_mfma_f32_16x16x32_bf16 v[156:159], v[28:31], a[28:31], v[156:159]
    ds_write_b64 v53, v[192:193] offset:0
    v_cvt_pk_bf16_f32 v164, v164, v165
    v_mfma_f32_16x16x32_bf16 v[152:155], v[28:31], a[24:27], 0
    v_cvt_pk_bf16_f32 v165, v166, v167
    v_cvt_pk_bf16_f32 v196, v196, v197
    v_mfma_f32_16x16x32_bf16 v[152:155], v[24:27], a[8:11], v[152:155]
    v_cvt_pk_bf16_f32 v197, v198, v199
    v_cvt_pk_bf16_f32 v168, v168, v169
    v_mfma_f32_16x16x32_bf16 v[140:143], v[24:27], a[4:7], 0
    ds_write_b64 v53, v[196:197] offset:1152
    v_cvt_pk_bf16_f32 v169, v170, v171
    v_mfma_f32_16x16x32_bf16 v[140:143], v[28:31], a[20:23], v[140:143]
    v_cvt_pk_bf16_f32 v200, v200, v201
    v_cvt_pk_bf16_f32 v201, v202, v203
    v_mfma_f32_16x16x32_bf16 v[136:139], v[28:31], a[16:19], 0
    ds_read_b128 v[28:31], v5 offset:44032
    ds_write_b64 v53, v[200:201] offset:2304
    v_mfma_f32_16x16x32_bf16 v[136:139], v[24:27], a[0:3], v[136:139]
    s_waitcnt lgkmcnt(4)
    ds_read_b128 v[24:27], v5 offset:41984
    v_cvt_pk_bf16_f32 v172, v172, v173
    v_mfma_f32_16x16x32_bf16 v[128:131], v[16:19], a[32:35], v[128:131]
    v_cvt_pk_bf16_f32 v173, v174, v175
    v_cvt_pk_bf16_f32 v204, v204, v205
    v_mfma_f32_16x16x32_bf16 v[128:131], v[20:23], a[48:51], v[128:131]
    v_cvt_pk_bf16_f32 v205, v206, v207
    v_cvt_pk_bf16_f32 v220, v220, v221
    v_mfma_f32_16x16x32_bf16 v[132:135], v[20:23], a[52:55], v[132:135]
    ds_write_b64 v53, v[204:205] offset:3456
    v_cvt_pk_bf16_f32 v221, v222, v223
    v_mfma_f32_16x16x32_bf16 v[132:135], v[16:19], a[36:39], v[132:135]
    v_mov_b32 v174, v220
    v_mov_b32 v175, 0
    v_mfma_f32_16x16x32_bf16 v[144:147], v[16:19], a[40:43], v[144:147]
    ds_write_b64 v53, v[220:221] offset:3488
    v_add_u32 v52, 81088, v52
    v_mfma_f32_16x16x32_bf16 v[144:147], v[20:23], a[56:59], v[144:147]
    ds_write_b128 v52, v[172:175] offset:1024
    v_cvt_pk_bf16_f32 v208, v208, v209
    v_mfma_f32_16x16x32_bf16 v[148:151], v[20:23], a[60:63], v[148:151]
    s_waitcnt vmcnt(16)
    s_barrier
    s_add_u32 m0, s19, 20480
    s_mul_i32 s20, s57, 589824
    s_add_u32 s20, s20, s26
    ds_read_b128 v[20:23], v5 offset:47104
    buffer_load_dwordx4 v6, s[12:15], s20 offen lds
    v_mfma_f32_16x16x32_bf16 v[148:151], v[16:19], a[44:47], v[148:151]
    s_waitcnt lgkmcnt(4)
    ds_read_b128 v[16:19], v5 offset:45056
    v_cvt_pk_bf16_f32 v209, v210, v211
    v_mfma_f32_16x16x32_bf16 v[156:159], v[24:27], a[44:47], v[156:159]
    s_add_u32 m0, s19, 24576
    v_mov_b32 v162, v208
    v_mov_b32 v163, 0
    v_mfma_f32_16x16x32_bf16 v[156:159], v[28:31], a[60:63], v[156:159]
    s_add_u32 s20, s20, 294912
    ds_write_b64 v53, v[208:209] offset:32
    v_cvt_pk_bf16_f32 v212, v212, v213
    v_mfma_f32_16x16x32_bf16 v[152:155], v[28:31], a[56:59], v[152:155]
    v_cvt_pk_bf16_f32 v213, v214, v215
    v_mov_b32 v166, v212
    v_mfma_f32_16x16x32_bf16 v[152:155], v[24:27], a[40:43], v[152:155]
    v_mov_b32 v167, 0
    v_cvt_pk_bf16_f32 v216, v216, v217
    v_mfma_f32_16x16x32_bf16 v[140:143], v[24:27], a[36:39], v[140:143]
    ds_write_b64 v53, v[212:213] offset:1184
    v_cvt_pk_bf16_f32 v217, v218, v219
    v_mfma_f32_16x16x32_bf16 v[140:143], v[28:31], a[52:55], v[140:143]
    buffer_load_dwordx4 v6, s[12:15], s20 offen lds
    v_mov_b32 v170, v216
    v_mfma_f32_16x16x32_bf16 v[136:139], v[28:31], a[48:51], v[136:139]
    s_add_u32 m0, s19, 28672
    ds_read_b128 v[28:31], v5 offset:48128
    v_mov_b32 v171, 0
    v_mfma_f32_16x16x32_bf16 v[136:139], v[24:27], a[32:35], v[136:139]
    s_waitcnt lgkmcnt(3)
    ds_read_b128 v[24:27], v5 offset:46080
    ds_write_b64 v53, v[216:217] offset:2336
    v_mfma_f32_16x16x32_bf16 v[128:131], v[16:19], a[64:67], v[128:131]
    s_mul_i32 s20, s58, 589824
    v_cvt_pk_bf16_f32 v176, v176, v177
    v_cvt_pk_bf16_f32 v177, v178, v179
    v_mfma_f32_16x16x32_bf16 v[128:131], v[20:23], a[80:83], v[128:131]
    s_add_u32 s20, s20, s26
    v_mov_b32 v210, v208
    v_mov_b32 v211, v208
    v_mfma_f32_16x16x32_bf16 v[132:135], v[20:23], a[84:87], v[132:135]
    v_cvt_pk_bf16_f32 v180, v180, v181
    v_cvt_pk_bf16_f32 v181, v182, v183
    v_mfma_f32_16x16x32_bf16 v[132:135], v[16:19], a[68:71], v[132:135]
    v_mov_b32 v214, v212
    v_mov_b32 v215, v212
    v_mfma_f32_16x16x32_bf16 v[144:147], v[16:19], a[72:75], v[144:147]
    v_cvt_pk_bf16_f32 v184, v184, v185
    v_cvt_pk_bf16_f32 v185, v186, v187
    v_mfma_f32_16x16x32_bf16 v[144:147], v[20:23], a[88:91], v[144:147]
    s_waitcnt lgkmcnt(0)
    s_barrier
    buffer_load_dwordx4 v6, s[12:15], s20 offen lds
    v_mfma_f32_16x16x32_bf16 v[148:151], v[20:23], a[92:95], v[148:151]
    s_add_u32 m0, s19, 32768
    ds_read_b128 v[20:23], v5 offset:51200
    v_mov_b32 v218, v216
    v_mfma_f32_16x16x32_bf16 v[148:151], v[16:19], a[76:79], v[148:151]
    s_add_u32 s20, s20, 294912
    ds_read_b128 v[16:19], v5 offset:49152
    v_mov_b32 v219, v216
    v_mfma_f32_16x16x32_bf16 v[156:159], v[24:27], a[76:79], v[156:159]
    v_cvt_pk_bf16_f32 v188, v188, v189
    v_cvt_pk_bf16_f32 v189, v190, v191
    v_mfma_f32_16x16x32_bf16 v[156:159], v[28:31], a[92:95], v[156:159]
    v_mov_b32 v222, v220
    v_mov_b32 v223, v220
    v_mfma_f32_16x16x32_bf16 v[152:155], v[28:31], a[88:91], v[152:155]
    v_permlane16_swap_b32 v210, v211
    v_mov_b32 v179, 0
    v_mfma_f32_16x16x32_bf16 v[152:155], v[24:27], a[72:75], v[152:155]
    v_permlane16_swap_b32 v214, v215
    v_mov_b32 v183, 0
    v_mfma_f32_16x16x32_bf16 v[140:143], v[24:27], a[68:71], v[140:143]
    v_permlane16_swap_b32 v218, v219
    v_mov_b32 v187, 0
    v_mfma_f32_16x16x32_bf16 v[140:143], v[28:31], a[84:87], v[140:143]
    buffer_load_dwordx4 v6, s[12:15], s20 offen lds
    v_permlane16_swap_b32 v222, v223
    v_mfma_f32_16x16x32_bf16 v[136:139], v[28:31], a[80:83], v[136:139]
    s_add_u32 m0, s19, 36864
    ds_read_b128 v[28:31], v5 offset:52224
    v_mov_b32 v191, 0
    v_mfma_f32_16x16x32_bf16 v[136:139], v[24:27], a[64:67], v[136:139]
    s_waitcnt lgkmcnt(1)
    ds_read_b128 v[24:27], v5 offset:50176
    v_cndmask_b32 v178, 0, v211, s[42:43]
    v_mfma_f32_16x16x32_bf16 v[128:131], v[16:19], a[96:99], v[128:131]
    s_mul_i32 s20, s59, 589824
    v_cndmask_b32 v182, 0, v215, s[42:43]
    v_cndmask_b32 v186, 0, v219, s[42:43]
    v_mfma_f32_16x16x32_bf16 v[128:131], v[20:23], a[112:115], v[128:131]
    s_add_u32 s20, s20, s26
    v_cndmask_b32 v190, 0, v223, s[42:43]
    v_mov_b32 v63, 0xf149f2ca
    v_mfma_f32_16x16x32_bf16 v[132:135], v[20:23], a[116:119], v[132:135]
    v_add_u32 v40, 80, v62
    v_and_b32 v40, 0x71, v40
    v_mfma_f32_16x16x32_bf16 v[132:135], v[16:19], a[100:103], v[132:135]
    v_add_u32 v41, 79, v62
    v_and_b32 v41, 0x71, v41
    v_mfma_f32_16x16x32_bf16 v[144:147], v[16:19], a[104:107], v[144:147]
    v_add_u32 v42, 78, v62
    v_and_b32 v42, 0x71, v42
    v_mfma_f32_16x16x32_bf16 v[144:147], v[20:23], a[120:123], v[144:147]
    buffer_load_dwordx4 v6, s[12:15], s20 offen lds
    v_add_u32 v43, 77, v62
    v_mfma_f32_16x16x32_bf16 v[148:151], v[20:23], a[124:127], v[148:151]
    ds_read_b128 v[20:23], v5 offset:55296
    v_and_b32 v43, 0x71, v43
    v_mfma_f32_16x16x32_bf16 v[148:151], v[16:19], a[108:111], v[148:151]
    s_waitcnt lgkmcnt(1)
    ds_read_b128 v[16:19], v5 offset:53248
    v_add_u32 v44, 64, v62
    v_mfma_f32_16x16x32_bf16 v[156:159], v[24:27], a[108:111], v[156:159]
    v_and_b32 v44, 0x71, v44
    v_add_u32 v45, 63, v62
    v_mfma_f32_16x16x32_bf16 v[156:159], v[28:31], a[124:127], v[156:159]
    v_and_b32 v45, 0x71, v45
    v_add_u32 v46, 62, v62
    v_mfma_f32_16x16x32_bf16 v[152:155], v[28:31], a[120:123], v[152:155]
    v_and_b32 v46, 0x71, v46
    v_add_u32 v47, 61, v62
    v_mfma_f32_16x16x32_bf16 v[152:155], v[24:27], a[104:107], v[152:155]
    v_and_b32 v47, 0x71, v47
    v_cmp_eq_u32 s[94:95], 64, v40
    v_mfma_f32_16x16x32_bf16 v[140:143], v[24:27], a[100:103], v[140:143]
    s_nop 0
    v_cndmask_b32 v40, v63, 0, s[94:95]
    v_cmp_eq_u32 s[94:95], 64, v41
    v_mfma_f32_16x16x32_bf16 v[140:143], v[28:31], a[116:119], v[140:143]
    s_nop 0
    v_cndmask_b32 v41, v63, 0, s[94:95]
    v_cmp_eq_u32 s[94:95], 64, v42
    v_mfma_f32_16x16x32_bf16 v[136:139], v[28:31], a[112:115], v[136:139]
    ds_read_b128 v[28:31], v5 offset:56320
    v_cndmask_b32 v42, v63, 0, s[94:95]
    v_mfma_f32_16x16x32_bf16 v[136:139], v[24:27], a[96:99], v[136:139]
    s_waitcnt lgkmcnt(1)
    ds_read_b128 v[24:27], v5 offset:54272
    v_cmp_eq_u32 s[94:95], 64, v43
    v_mfma_f32_16x16x32_bf16 v[128:131], v[16:19], a[128:131], v[128:131]
    s_nop 0
    v_cndmask_b32 v43, v63, 0, s[94:95]
    v_cmp_eq_u32 s[94:95], 64, v44
    v_mfma_f32_16x16x32_bf16 v[128:131], v[20:23], a[144:147], v[128:131]
    s_nop 0
    v_cndmask_b32 v44, v63, 0, s[94:95]
    v_cmp_eq_u32 s[94:95], 64, v45
    v_mfma_f32_16x16x32_bf16 v[132:135], v[20:23], a[148:151], v[132:135]
    s_waitcnt vmcnt(7)
    s_barrier
    v_cndmask_b32 v45, v63, 0, s[94:95]
    v_mfma_f32_16x16x32_bf16 v[132:135], v[16:19], a[132:135], v[132:135]
    v_cmp_eq_u32 s[94:95], 64, v46
    s_nop 1
    v_cndmask_b32 v46, v63, 0, s[94:95]
    v_mfma_f32_16x16x32_bf16 v[144:147], v[16:19], a[136:139], v[144:147]
    v_cmp_eq_u32 s[94:95], 64, v47
    s_nop 1
    v_cndmask_b32 v47, v63, 0, s[94:95]
    v_mfma_f32_16x16x32_bf16 v[144:147], v[20:23], a[152:155], v[144:147]
    v_min_f32 v48, s100, v40
    v_min_f32 v49, s100, v41
    v_mfma_f32_16x16x32_bf16 v[148:151], v[20:23], a[156:159], v[148:151]
    ds_read_b128 v[20:23], v5 offset:59392
    v_min_f32 v50, s100, v42
    v_mfma_f32_16x16x32_bf16 v[148:151], v[16:19], a[140:143], v[148:151]
    s_waitcnt lgkmcnt(1)
    ds_read_b128 v[16:19], v5 offset:57344
    v_min_f32 v51, s100, v43
    v_mfma_f32_16x16x32_bf16 v[156:159], v[24:27], a[140:143], v[156:159]
    ds_read_b128 v[36:39], v52
    v_mfma_f32_16x16x32_bf16 v[156:159], v[28:31], a[156:159], v[156:159]
    ds_read_b64_tr_b16 v[192:193], v55 offset:0
    ds_read_b64_tr_b16 v[202:203], v58 offset:48
    v_mfma_f32_16x16x32_bf16 v[152:155], v[28:31], a[152:155], v[152:155]
    ds_read_b64_tr_b16 v[194:195], v55 offset:1152
    ds_read_b64_tr_b16 v[204:205], v58 offset:1200
    v_mfma_f32_16x16x32_bf16 v[152:155], v[24:27], a[136:139], v[152:155]
    ds_read_b64_tr_b16 v[196:197], v55 offset:2304
    ds_read_b64_tr_b16 v[206:207], v58 offset:2352
    v_mfma_f32_16x16x32_bf16 v[140:143], v[24:27], a[132:135], v[140:143]
    ds_read_b64_tr_b16 v[198:199], v55 offset:3456
    ds_read_b64_tr_b16 v[208:209], v58 offset:3504
    v_mfma_f32_16x16x32_bf16 v[140:143], v[28:31], a[148:151], v[140:143]
    ds_read_b64_tr_b16 v[200:201], v55 offset:4608
    ds_read_b64_tr_b16 v[210:211], v58 offset:4656
    v_mfma_f32_16x16x32_bf16 v[136:139], v[28:31], a[144:147], v[136:139]
    ds_read_b128 v[28:31], v5 offset:60416
    v_mfma_f32_16x16x32_bf16 v[136:139], v[24:27], a[128:131], v[136:139]
    s_waitcnt lgkmcnt(12)
    ds_read_b128 v[24:27], v5 offset:58368
    v_mfma_f32_16x16x32_bf16 v[128:131], v[16:19], a[160:163], v[128:131]
    v_mfma_f32_16x16x32_bf16 v[216:219], v[160:163], v[176:179], v[44:47]
    v_mfma_f32_16x16x32_bf16 v[128:131], v[20:23], a[176:179], v[128:131]
    s_waitcnt vmcnt(5)
    buffer_store_dword v15, off, s[8:11], s46 sc1
    buffer_store_dword v15, off, s[8:11], s80 sc1
    v_mfma_f32_16x16x32_bf16 v[132:135], v[20:23], a[180:183], v[132:135]
    s_waitcnt lgkmcnt(12)
    v_mfma_f32_16x16x32_bf16 v[212:215], v[36:39], v[176:179], v[48:51]
    v_mfma_f32_16x16x32_bf16 v[132:135], v[16:19], a[164:167], v[132:135]
    v_mfma_f32_16x16x32_bf16 v[176:179], v[164:167], v[180:183], v[44:47]
    v_mfma_f32_16x16x32_bf16 v[144:147], v[16:19], a[168:171], v[144:147]
    v_mfma_f32_16x16x32_bf16 v[220:223], v[160:163], v[180:183], v[40:43]
    v_mfma_f32_16x16x32_bf16 v[144:147], v[20:23], a[184:187], v[144:147]
    v_mfma_f32_16x16x32_bf16 v[180:183], v[168:171], v[184:187], v[44:47]
    v_mfma_f32_16x16x32_bf16 v[148:151], v[20:23], a[188:191], v[148:151]
    s_waitcnt lgkmcnt(2)
    s_barrier
    s_add_u32 m0, s19, 40960
    s_add_u32 s20, s20, 294912
    ds_read_b128 v[20:23], v5 offset:2048
    buffer_load_dwordx4 v6, s[12:15], s20 offen lds
    v_mfma_f32_16x16x32_bf16 v[148:151], v[16:19], a[172:175], v[148:151]
    s_waitcnt lgkmcnt(1)
    ds_read_b128 v[16:19], v5 offset:0
    v_max_f32 v212, v212, v213
    v_mfma_f32_16x16x32_bf16 v[156:159], v[24:27], a[172:175], v[156:159]
    s_add_u32 m0, s19, 45056
    v_mfma_f32_16x16x32_bf16 v[160:163], v[164:167], v[184:187], v[40:43]
    v_mfma_f32_16x16x32_bf16 v[156:159], v[28:31], a[188:191], v[156:159]
    s_mul_i32 s20, s60, 589824
    v_mfma_f32_16x16x32_bf16 v[184:187], v[172:175], v[188:191], v[44:47]
    v_mfma_f32_16x16x32_bf16 v[152:155], v[28:31], a[184:187], v[152:155]
    s_add_u32 s20, s20, s26
    v_mfma_f32_16x16x32_bf16 v[164:167], v[168:171], v[188:191], v[40:43]
    v_mfma_f32_16x16x32_bf16 v[152:155], v[24:27], a[168:171], v[152:155]
    v_max_f32 v213, v214, v215
    v_max_f32 v214, v216, v217
    v_mfma_f32_16x16x32_bf16 v[140:143], v[24:27], a[164:167], v[140:143]
    v_max_f32 v215, v218, v219
    v_max_f32 v220, v220, v221
    v_mfma_f32_16x16x32_bf16 v[140:143], v[28:31], a[180:183], v[140:143]
    buffer_load_dwordx4 v6, s[12:15], s20 offen lds
    v_max_f32 v221, v222, v223
    v_mfma_f32_16x16x32_bf16 v[136:139], v[28:31], a[176:179], v[136:139]
    s_add_u32 m0, s19, 49152
    ds_read_b128 v[28:31], v5 offset:3072
    v_max_f32 v222, v176, v177
    v_mfma_f32_16x16x32_bf16 v[136:139], v[24:27], a[160:163], v[136:139]
    s_waitcnt lgkmcnt(1)
    ds_read_b128 v[24:27], v5 offset:1024
    v_max_f32 v223, v178, v179
    v_mfma_f32_16x16x32_bf16 v[128:131], v[16:19], a[192:195], v[128:131]
    s_add_u32 s20, s20, 294912
    v_max_f32 v160, v160, v161
    v_max_f32 v161, v162, v163
    v_mfma_f32_16x16x32_bf16 v[128:131], v[20:23], a[208:211], v[128:131]
    v_max_f32 v162, v180, v181
    v_max_f32 v163, v182, v183
    v_mfma_f32_16x16x32_bf16 v[132:135], v[20:23], a[212:215], v[132:135]
    v_max_f32 v164, v164, v165
    v_max_f32 v165, v166, v167
    v_mfma_f32_16x16x32_bf16 v[132:135], v[16:19], a[196:199], v[132:135]
    v_max_f32 v166, v184, v185
    v_max_f32 v167, v186, v187
    v_mfma_f32_16x16x32_bf16 v[144:147], v[16:19], a[200:203], v[144:147]
    v_max3_f32 v216, v212, v213, v214
    v_max3_f32 v176, v220, v221, v222
    v_mfma_f32_16x16x32_bf16 v[144:147], v[20:23], a[216:219], v[144:147]
    buffer_load_dwordx4 v6, s[12:15], s20 offen lds
    v_max3_f32 v180, v160, v161, v162
    v_mfma_f32_16x16x32_bf16 v[148:151], v[20:23], a[220:223], v[148:151]
    s_add_u32 m0, s19, 53248
    ds_read_b128 v[20:23], v5 offset:6144
    v_max3_f32 v184, v164, v165, v166
    v_mfma_f32_16x16x32_bf16 v[148:151], v[16:19], a[204:207], v[148:151]
    s_waitcnt lgkmcnt(1)
    ds_read_b128 v[16:19], v5 offset:4096
    v_max_f32 v216, v216, v215
    v_mfma_f32_16x16x32_bf16 v[156:159], v[24:27], a[204:207], v[156:159]
    s_mul_i32 s20, s61, 589824
    v_max_f32 v176, v176, v223
    v_max_f32 v180, v180, v163
    v_mfma_f32_16x16x32_bf16 v[156:159], v[28:31], a[220:223], v[156:159]
    s_add_u32 s20, s20, s26
    v_max_f32 v184, v184, v167
    v_mov_b32 v217, v216
    v_mfma_f32_16x16x32_bf16 v[152:155], v[28:31], a[216:219], v[152:155]
    v_mov_b32 v177, v176
    v_mov_b32 v181, v180
    v_mfma_f32_16x16x32_bf16 v[152:155], v[24:27], a[200:203], v[152:155]
    v_mov_b32 v185, v184
    v_permlane16_swap_b32 v216, v217
    v_mfma_f32_16x16x32_bf16 v[140:143], v[24:27], a[196:199], v[140:143]
    v_permlane16_swap_b32 v176, v177
    v_permlane16_swap_b32 v180, v181
    v_mfma_f32_16x16x32_bf16 v[140:143], v[28:31], a[212:215], v[140:143]
    buffer_load_dwordx4 v6, s[12:15], s20 offen lds
    v_permlane16_swap_b32 v184, v185
    v_mfma_f32_16x16x32_bf16 v[136:139], v[28:31], a[208:211], v[136:139]
    ds_read_b128 v[28:31], v5 offset:7168
    v_max_f32 v216, v216, v217
    v_mfma_f32_16x16x32_bf16 v[136:139], v[24:27], a[192:195], v[136:139]
    s_waitcnt lgkmcnt(1)
    ds_read_b128 v[24:27], v5 offset:5120
    v_max_f32 v176, v176, v177
    v_mfma_f32_16x16x32_bf16 v[128:131], v[16:19], a[224:227], v[128:131]
    v_max_f32 v180, v180, v181
    v_max_f32 v184, v184, v185
    v_mfma_f32_16x16x32_bf16 v[128:131], v[20:23], a[240:243], v[128:131]
    v_mov_b32 v217, v216
    v_mov_b32 v177, v176
    v_mfma_f32_16x16x32_bf16 v[132:135], v[20:23], a[244:247], v[132:135]
    v_mov_b32 v181, v180
    v_mov_b32 v185, v184
    v_mfma_f32_16x16x32_bf16 v[132:135], v[16:19], a[228:231], v[132:135]
    v_permlane32_swap_b32 v216, v217
    v_permlane32_swap_b32 v176, v177
    v_mfma_f32_16x16x32_bf16 v[144:147], v[16:19], a[232:235], v[144:147]
    v_permlane32_swap_b32 v180, v181
    v_permlane32_swap_b32 v184, v185
    v_mfma_f32_16x16x32_bf16 v[144:147], v[20:23], a[248:251], v[144:147]
    v_max_f32 v216, v216, v217
    v_max_f32 v176, v176, v177
    v_mfma_f32_16x16x32_bf16 v[148:151], v[20:23], a[252:255], v[148:151]
    ds_read_b128 v[20:23], v5 offset:10240
    v_max_f32 v180, v180, v181
    v_mfma_f32_16x16x32_bf16 v[148:151], v[16:19], a[236:239], v[148:151]
    s_waitcnt lgkmcnt(1)
    ds_read_b128 v[16:19], v5 offset:8192
    v_max_f32 v184, v184, v185
    v_mfma_f32_16x16x32_bf16 v[156:159], v[24:27], a[236:239], v[156:159]
    v_mul_f32 v216, s41, v216
    v_mul_f32 v176, s41, v176
    v_mfma_f32_16x16x32_bf16 v[156:159], v[28:31], a[252:255], v[156:159]
    v_mul_f32 v180, s41, v180
    v_mul_f32 v184, s41, v184
    v_mfma_f32_16x16x32_bf16 v[152:155], v[28:31], a[248:251], v[152:155]
    v_fma_f32 v212, v212, s41, -v216
    v_fma_f32 v213, v213, s41, -v216
    v_mfma_f32_16x16x32_bf16 v[152:155], v[24:27], a[232:235], v[152:155]
    v_fma_f32 v214, v214, s41, -v216
    v_fma_f32 v215, v215, s41, -v216
    v_mfma_f32_16x16x32_bf16 v[140:143], v[24:27], a[228:231], v[140:143]
    v_fma_f32 v220, v220, s41, -v176
    v_fma_f32 v221, v221, s41, -v176
    v_mfma_f32_16x16x32_bf16 v[140:143], v[28:31], a[244:247], v[140:143]
    v_fma_f32 v222, v222, s41, -v176
    v_fma_f32 v223, v223, s41, -v176
    v_mfma_f32_16x16x32_bf16 v[136:139], v[28:31], a[240:243], v[136:139]
    ds_read_b128 v[28:31], v5 offset:11264
    v_fma_f32 v160, v160, s41, -v180
    v_mfma_f32_16x16x32_bf16 v[136:139], v[24:27], a[224:227], v[136:139]
    s_waitcnt lgkmcnt(1)
    ds_read_b128 v[24:27], v5 offset:9216
    v_fma_f32 v161, v161, s41, -v180
    v_mfma_f32_16x16x32_bf16 v[128:131], v[16:19], v[224:227], v[128:131]
    v_fma_f32 v162, v162, s41, -v180
    v_fma_f32 v163, v163, s41, -v180
    v_mfma_f32_16x16x32_bf16 v[128:131], v[20:23], v[240:243], v[128:131]
    v_fma_f32 v164, v164, s41, -v184
    v_fma_f32 v165, v165, s41, -v184
    v_mfma_f32_16x16x32_bf16 v[132:135], v[20:23], v[244:247], v[132:135]
    v_fma_f32 v166, v166, s41, -v184
    v_fma_f32 v167, v167, s41, -v184
    v_mfma_f32_16x16x32_bf16 v[132:135], v[16:19], v[228:231], v[132:135]
    v_exp_f32 v212, v212
    v_mfma_f32_16x16x32_bf16 v[144:147], v[16:19], v[232:235], v[144:147]
    v_exp_f32 v213, v213
    v_mfma_f32_16x16x32_bf16 v[144:147], v[20:23], v[248:251], v[144:147]
    v_exp_f32 v214, v214
    v_mfma_f32_16x16x32_bf16 v[148:151], v[20:23], v[252:255], v[148:151]
    s_waitcnt vmcnt(9)
    s_barrier
    s_add_u32 m0, s19, 57344
    s_add_u32 s20, s20, 294912
    ds_read_b64_tr_b16 v[20:21], v1 offset:16384
    ds_read_b64_tr_b16 v[22:23], v1 offset:16896
    buffer_load_dwordx4 v6, s[12:15], s20 offen lds
    v_mfma_f32_16x16x32_bf16 v[148:151], v[16:19], v[236:239], v[148:151]
    s_waitcnt lgkmcnt(2)
    ds_read_b64_tr_b16 v[16:17], v1 offset:12288
    ds_read_b64_tr_b16 v[18:19], v1 offset:12800
    v_mfma_f32_16x16x32_bf16 v[156:159], v[24:27], v[236:239], v[156:159]
    s_add_u32 m0, s19, 0
    v_exp_f32 v215, v215
    v_mfma_f32_16x16x32_bf16 v[156:159], v[28:31], v[252:255], v[156:159]
    s_mul_i32 s20, s62, 589824
    v_exp_f32 v220, v220
    v_mfma_f32_16x16x32_bf16 v[152:155], v[28:31], v[248:251], v[152:155]
    s_add_u32 s20, s20, s26
    v_exp_f32 v221, v221
    v_mfma_f32_16x16x32_bf16 v[152:155], v[24:27], v[232:235], v[152:155]
    v_exp_f32 v222, v222
    v_mfma_f32_16x16x32_bf16 v[140:143], v[24:27], v[228:231], v[140:143]
    v_exp_f32 v223, v223
    v_mfma_f32_16x16x32_bf16 v[140:143], v[28:31], v[244:247], v[140:143]
    buffer_load_dwordx4 v6, s[12:15], s20 offen lds
    v_mfma_f32_16x16x32_bf16 v[136:139], v[28:31], v[240:243], v[136:139]
    s_add_u32 m0, s19, 4096
    ds_read_b64_tr_b16 v[28:29], v2 offset:16384
    ds_read_b64_tr_b16 v[30:31], v2 offset:16896
    v_mfma_f32_16x16x32_bf16 v[136:139], v[24:27], v[224:227], v[136:139]
    s_waitcnt lgkmcnt(2)
    ds_read_b64_tr_b16 v[24:25], v2 offset:12288
    ds_read_b64_tr_b16 v[26:27], v2 offset:12800
    v_mfma_f32_16x16x32_bf16 v[64:67], v[16:19], a[0:3], 0
    s_add_u32 s20, s20, 294912
    v_exp_f32 v160, v160
    v_mfma_f32_16x16x32_bf16 v[64:67], v[20:23], a[16:19], v[64:67]
    v_exp_f32 v161, v161
    v_mfma_f32_16x16x32_bf16 v[72:75], v[20:23], a[20:23], 0
    v_exp_f32 v162, v162
    v_mfma_f32_16x16x32_bf16 v[72:75], v[16:19], a[4:7], v[72:75]
    v_exp_f32 v163, v163
    v_mfma_f32_16x16x32_bf16 v[80:83], v[16:19], a[8:11], 0
    v_exp_f32 v164, v164
    v_mfma_f32_16x16x32_bf16 v[80:83], v[20:23], a[24:27], v[80:83]
    buffer_load_dwordx4 v6, s[12:15], s20 offen lds
    v_add_f32 v216, v212, v213
    v_mfma_f32_16x16x32_bf16 v[88:91], v[20:23], a[28:31], 0
    ds_read_b64_tr_b16 v[20:21], v3 offset:16384
    ds_read_b64_tr_b16 v[22:23], v3 offset:16896
    v_mfma_f32_16x16x32_bf16 v[88:91], v[16:19], a[12:15], v[88:91]
    s_waitcnt lgkmcnt(2)
    ds_read_b64_tr_b16 v[16:17], v3 offset:12288
    ds_read_b64_tr_b16 v[18:19], v3 offset:12800
    v_mfma_f32_16x16x32_bf16 v[92:95], v[24:27], a[12:15], 0
    v_exp_f32 v165, v165
    v_mfma_f32_16x16x32_bf16 v[92:95], v[28:31], a[28:31], v[92:95]
    v_exp_f32 v166, v166
    v_mfma_f32_16x16x32_bf16 v[84:87], v[28:31], a[24:27], 0
    v_exp_f32 v167, v167
    v_mfma_f32_16x16x32_bf16 v[84:87], v[24:27], a[8:11], v[84:87]
    v_add_f32 v217, v214, v215
    v_add_f32 v176, v220, v221
    v_mfma_f32_16x16x32_bf16 v[76:79], v[24:27], a[4:7], 0
    v_add_f32 v177, v222, v223
    v_add_f32 v180, v160, v161
    v_mfma_f32_16x16x32_bf16 v[76:79], v[28:31], a[20:23], v[76:79]
    v_add_f32 v181, v162, v163
    v_add_f32 v184, v164, v165
    v_mfma_f32_16x16x32_bf16 v[68:71], v[28:31], a[16:19], 0
    ds_read_b64_tr_b16 v[28:29], v4 offset:16384
    ds_read_b64_tr_b16 v[30:31], v4 offset:16896
    v_mfma_f32_16x16x32_bf16 v[68:71], v[24:27], a[0:3], v[68:71]
    s_waitcnt lgkmcnt(2)
    ds_read_b64_tr_b16 v[24:25], v4 offset:12288
    ds_read_b64_tr_b16 v[26:27], v4 offset:12800
    v_mfma_f32_16x16x32_bf16 v[96:99], v[16:19], a[0:3], 0
    v_add_f32 v185, v166, v167
    v_add_f32 v216, v216, v217
    v_mfma_f32_16x16x32_bf16 v[96:99], v[20:23], a[16:19], v[96:99]
    v_add_f32 v176, v176, v177
    v_add_f32 v180, v180, v181
    v_mfma_f32_16x16x32_bf16 v[104:107], v[20:23], a[20:23], 0
    v_add_f32 v184, v184, v185
    v_mov_b32 v217, v216
    v_mfma_f32_16x16x32_bf16 v[104:107], v[16:19], a[4:7], v[104:107]
    v_mov_b32 v177, v176
    v_mov_b32 v181, v180
    v_mfma_f32_16x16x32_bf16 v[112:115], v[16:19], a[8:11], 0
    v_mov_b32 v185, v184
    v_permlane16_swap_b32 v216, v217
    v_mfma_f32_16x16x32_bf16 v[112:115], v[20:23], a[24:27], v[112:115]
    v_permlane16_swap_b32 v176, v177
    v_permlane16_swap_b32 v180, v181
    v_mfma_f32_16x16x32_bf16 v[120:123], v[20:23], a[28:31], 0
    ds_read_b64_tr_b16 v[20:21], v1 offset:24576
    ds_read_b64_tr_b16 v[22:23], v1 offset:25088
    v_mfma_f32_16x16x32_bf16 v[120:123], v[16:19], a[12:15], v[120:123]
    s_waitcnt lgkmcnt(2)
    ds_read_b64_tr_b16 v[16:17], v1 offset:20480
    ds_read_b64_tr_b16 v[18:19], v1 offset:20992
    v_mfma_f32_16x16x32_bf16 v[124:127], v[24:27], a[12:15], 0
    v_permlane16_swap_b32 v184, v185
    v_add_f32 v216, v216, v217
    v_mfma_f32_16x16x32_bf16 v[124:127], v[28:31], a[28:31], v[124:127]
    v_add_f32 v176, v176, v177
    v_add_f32 v180, v180, v181
    v_mfma_f32_16x16x32_bf16 v[116:119], v[28:31], a[24:27], 0
    v_add_f32 v184, v184, v185
    v_mov_b32 v217, v216
    v_mfma_f32_16x16x32_bf16 v[116:119], v[24:27], a[8:11], v[116:119]
    v_mov_b32 v177, v176
    v_mov_b32 v181, v180
    v_mfma_f32_16x16x32_bf16 v[108:111], v[24:27], a[4:7], 0
    v_mov_b32 v185, v184
    v_permlane32_swap_b32 v216, v217
    v_mfma_f32_16x16x32_bf16 v[108:111], v[28:31], a[20:23], v[108:111]
    v_permlane32_swap_b32 v176, v177
    v_permlane32_swap_b32 v180, v181
    v_mfma_f32_16x16x32_bf16 v[100:103], v[28:31], a[16:19], 0
    ds_read_b64_tr_b16 v[28:29], v2 offset:24576
    ds_read_b64_tr_b16 v[30:31], v2 offset:25088
    v_mfma_f32_16x16x32_bf16 v[100:103], v[24:27], a[0:3], v[100:103]
    s_waitcnt lgkmcnt(2)
    ds_read_b64_tr_b16 v[24:25], v2 offset:20480
    ds_read_b64_tr_b16 v[26:27], v2 offset:20992
    v_mfma_f32_16x16x32_bf16 v[64:67], v[16:19], a[32:35], v[64:67]
    v_permlane32_swap_b32 v184, v185
    v_add_f32 v216, v216, v217
    v_mfma_f32_16x16x32_bf16 v[64:67], v[20:23], a[48:51], v[64:67]
    v_add_f32 v176, v176, v177
    v_add_f32 v180, v180, v181
    v_mfma_f32_16x16x32_bf16 v[72:75], v[20:23], a[52:55], v[72:75]
    v_add_f32 v184, v184, v185
    v_mfma_f32_16x16x32_bf16 v[72:75], v[16:19], a[36:39], v[72:75]
    v_rcp_f32 v216, v216
    v_mfma_f32_16x16x32_bf16 v[80:83], v[16:19], a[40:43], v[80:83]
    v_rcp_f32 v176, v176
    v_mfma_f32_16x16x32_bf16 v[80:83], v[20:23], a[56:59], v[80:83]
    s_add_u32 s51, s44, 1
    buffer_load_dword v9, v8, s[8:11], 0 offen sc1
    v_mul_f32 v212, v212, v216
    v_mfma_f32_16x16x32_bf16 v[88:91], v[20:23], a[60:63], v[88:91]
    ds_read_b64_tr_b16 v[20:21], v3 offset:24576
    ds_read_b64_tr_b16 v[22:23], v3 offset:25088
    v_mfma_f32_16x16x32_bf16 v[88:91], v[16:19], a[44:47], v[88:91]
    s_waitcnt lgkmcnt(2)
    ds_read_b64_tr_b16 v[16:17], v3 offset:20480
    ds_read_b64_tr_b16 v[18:19], v3 offset:20992
    v_mfma_f32_16x16x32_bf16 v[92:95], v[24:27], a[44:47], v[92:95]
    v_rcp_f32 v180, v180
    v_mfma_f32_16x16x32_bf16 v[92:95], v[28:31], a[60:63], v[92:95]
    v_rcp_f32 v184, v184
    v_mfma_f32_16x16x32_bf16 v[84:87], v[28:31], a[56:59], v[84:87]
    v_mul_f32 v213, v213, v216
    v_mul_f32 v214, v214, v216
    v_mfma_f32_16x16x32_bf16 v[84:87], v[24:27], a[40:43], v[84:87]
    v_mul_f32 v215, v215, v216
    v_mul_f32 v220, v220, v176
    v_mfma_f32_16x16x32_bf16 v[76:79], v[24:27], a[36:39], v[76:79]
    v_mul_f32 v221, v221, v176
    v_mul_f32 v222, v222, v176
    v_mfma_f32_16x16x32_bf16 v[76:79], v[28:31], a[52:55], v[76:79]
    v_mul_f32 v223, v223, v176
    v_mul_f32 v160, v160, v180
    v_mfma_f32_16x16x32_bf16 v[68:71], v[28:31], a[48:51], v[68:71]
    ds_read_b64_tr_b16 v[28:29], v4 offset:24576
    ds_read_b64_tr_b16 v[30:31], v4 offset:25088
    v_mfma_f32_16x16x32_bf16 v[68:71], v[24:27], a[32:35], v[68:71]
    s_waitcnt lgkmcnt(2)
    ds_read_b64_tr_b16 v[24:25], v4 offset:20480
    ds_read_b64_tr_b16 v[26:27], v4 offset:20992
    v_mfma_f32_16x16x32_bf16 v[96:99], v[16:19], a[32:35], v[96:99]
    v_mul_f32 v161, v161, v180
    v_mul_f32 v162, v162, v180
    v_mfma_f32_16x16x32_bf16 v[96:99], v[20:23], a[48:51], v[96:99]
    v_mul_f32 v163, v163, v180
    v_mul_f32 v164, v164, v184
    v_mfma_f32_16x16x32_bf16 v[104:107], v[20:23], a[52:55], v[104:107]
    v_mul_f32 v165, v165, v184
    v_mul_f32 v166, v166, v184
    v_mfma_f32_16x16x32_bf16 v[104:107], v[16:19], a[36:39], v[104:107]
    v_mul_f32 v167, v167, v184
    v_cvt_pk_bf16_f32 v212, v212, 0
    v_mfma_f32_16x16x32_bf16 v[112:115], v[16:19], a[40:43], v[112:115]
    v_cvt_pk_bf16_f32 v213, v213, 0
    v_cvt_pk_bf16_f32 v214, v214, 0
    v_mfma_f32_16x16x32_bf16 v[112:115], v[20:23], a[56:59], v[112:115]
    v_cvt_pk_bf16_f32 v215, v215, 0
    v_cvt_pk_bf16_f32 v220, v220, 0
    v_mfma_f32_16x16x32_bf16 v[120:123], v[20:23], a[60:63], v[120:123]
    s_waitcnt vmcnt(7)
    s_barrier
    s_add_u32 m0, s19, 8192
    s_mul_i32 s20, s63, 589824
    s_add_u32 s20, s20, s26
    ds_read_b64_tr_b16 v[20:21], v1 offset:32768
    ds_read_b64_tr_b16 v[22:23], v1 offset:33280
    buffer_load_dwordx4 v6, s[12:15], s20 offen lds
    v_mfma_f32_16x16x32_bf16 v[120:123], v[16:19], a[44:47], v[120:123]
    s_waitcnt lgkmcnt(2)
    ds_read_b64_tr_b16 v[16:17], v1 offset:28672
    ds_read_b64_tr_b16 v[18:19], v1 offset:29184
    v_mfma_f32_16x16x32_bf16 v[124:127], v[24:27], a[44:47], v[124:127]
    s_add_u32 m0, s19, 12288
    v_cvt_pk_bf16_f32 v221, v221, 0
    v_cvt_pk_bf16_f32 v222, v222, 0
    v_mfma_f32_16x16x32_bf16 v[124:127], v[28:31], a[60:63], v[124:127]
    s_add_u32 s20, s20, 294912
    v_cvt_pk_bf16_f32 v223, v223, 0
    v_cvt_pk_bf16_f32 v160, v160, 0
    v_mfma_f32_16x16x32_bf16 v[116:119], v[28:31], a[56:59], v[116:119]
    v_cvt_pk_bf16_f32 v161, v161, 0
    v_cvt_pk_bf16_f32 v162, v162, 0
    v_mfma_f32_16x16x32_bf16 v[116:119], v[24:27], a[40:43], v[116:119]
    v_cvt_pk_bf16_f32 v163, v163, 0
    v_cvt_pk_bf16_f32 v164, v164, 0
    v_mfma_f32_16x16x32_bf16 v[108:111], v[24:27], a[36:39], v[108:111]
    v_cvt_pk_bf16_f32 v165, v165, 0
    v_cvt_pk_bf16_f32 v166, v166, 0
    v_mfma_f32_16x16x32_bf16 v[108:111], v[28:31], a[52:55], v[108:111]
    buffer_load_dwordx4 v6, s[12:15], s20 offen lds
    v_cvt_pk_bf16_f32 v167, v167, 0
    v_mfma_f32_16x16x32_bf16 v[100:103], v[28:31], a[48:51], v[100:103]
    s_add_u32 m0, s19, 16384
    ds_read_b64_tr_b16 v[28:29], v2 offset:32768
    ds_read_b64_tr_b16 v[30:31], v2 offset:33280
    v_mfma_f32_16x16x32_bf16 v[100:103], v[24:27], a[32:35], v[100:103]
    s_waitcnt lgkmcnt(2)
    ds_read_b64_tr_b16 v[24:25], v2 offset:28672
    ds_read_b64_tr_b16 v[26:27], v2 offset:29184
    v_mfma_f32_16x16x32_bf16 v[64:67], v[16:19], a[64:67], v[64:67]
    s_mul_i32 s20, s64, 589824
    v_lshlrev_b32 v212, v61, v212
    v_lshlrev_b32 v213, v61, v213
    v_mfma_f32_16x16x32_bf16 v[64:67], v[20:23], a[80:83], v[64:67]
    s_add_u32 s20, s20, s26
    v_lshlrev_b32 v214, v61, v214
    v_lshlrev_b32 v215, v61, v215
    v_mfma_f32_16x16x32_bf16 v[72:75], v[20:23], a[84:87], v[72:75]
    v_lshlrev_b32 v220, v61, v220
    v_lshlrev_b32 v221, v61, v221
    v_mfma_f32_16x16x32_bf16 v[72:75], v[16:19], a[68:71], v[72:75]
    v_lshlrev_b32 v222, v61, v222
    v_lshlrev_b32 v223, v61, v223
    v_mfma_f32_16x16x32_bf16 v[80:83], v[16:19], a[72:75], v[80:83]
    v_lshlrev_b32 v160, v61, v160
    v_lshlrev_b32 v161, v61, v161
    v_mfma_f32_16x16x32_bf16 v[80:83], v[20:23], a[88:91], v[80:83]
    buffer_load_dwordx4 v6, s[12:15], s20 offen lds
    v_lshlrev_b32 v162, v61, v162
    v_mfma_f32_16x16x32_bf16 v[88:91], v[20:23], a[92:95], v[88:91]
    ds_read_b64_tr_b16 v[20:21], v3 offset:32768
    ds_read_b64_tr_b16 v[22:23], v3 offset:33280
    v_mfma_f32_16x16x32_bf16 v[88:91], v[16:19], a[76:79], v[88:91]
    s_waitcnt lgkmcnt(2)
    ds_read_b64_tr_b16 v[16:17], v3 offset:28672
    ds_read_b64_tr_b16 v[18:19], v3 offset:29184
    v_mfma_f32_16x16x32_bf16 v[92:95], v[24:27], a[76:79], v[92:95]
    v_lshlrev_b32 v163, v61, v163
    v_lshlrev_b32 v164, v61, v164
    v_mfma_f32_16x16x32_bf16 v[92:95], v[28:31], a[92:95], v[92:95]
    v_lshlrev_b32 v165, v61, v165
    v_lshlrev_b32 v166, v61, v166
    v_mfma_f32_16x16x32_bf16 v[84:87], v[28:31], a[88:91], v[84:87]
    v_lshlrev_b32 v167, v61, v167
    v_mfma_f32_16x16x32_bf16 v[84:87], v[24:27], a[72:75], v[84:87]
    v_mfma_f32_16x16x32_bf16 v[216:219], v[192:195], v[212:215], 0
    v_mfma_f32_16x16x32_bf16 v[76:79], v[24:27], a[68:71], v[76:79]
    v_mfma_f32_16x16x32_bf16 v[168:171], v[202:205], v[212:215], 0
    v_mfma_f32_16x16x32_bf16 v[76:79], v[28:31], a[84:87], v[76:79]
    v_mfma_f32_16x16x32_bf16 v[176:179], v[194:197], v[220:223], 0
    v_mfma_f32_16x16x32_bf16 v[68:71], v[28:31], a[80:83], v[68:71]
    ds_read_b64_tr_b16 v[28:29], v4 offset:32768
    ds_read_b64_tr_b16 v[30:31], v4 offset:33280
    v_mfma_f32_16x16x32_bf16 v[68:71], v[24:27], a[64:67], v[68:71]
    s_waitcnt lgkmcnt(2)
    ds_read_b64_tr_b16 v[24:25], v4 offset:28672
    ds_read_b64_tr_b16 v[26:27], v4 offset:29184
    v_mfma_f32_16x16x32_bf16 v[96:99], v[16:19], a[64:67], v[96:99]
    v_mfma_f32_16x16x32_bf16 v[172:175], v[204:207], v[220:223], 0
    v_mfma_f32_16x16x32_bf16 v[96:99], v[20:23], a[80:83], v[96:99]
    v_mfma_f32_16x16x32_bf16 v[180:183], v[196:199], v[160:163], 0
    v_mfma_f32_16x16x32_bf16 v[104:107], v[20:23], a[84:87], v[104:107]
    v_mfma_f32_16x16x32_bf16 v[188:191], v[206:209], v[160:163], 0
    v_mfma_f32_16x16x32_bf16 v[104:107], v[16:19], a[68:71], v[104:107]
    v_mfma_f32_16x16x32_bf16 v[184:187], v[198:201], v[164:167], 0
    v_mfma_f32_16x16x32_bf16 v[112:115], v[16:19], a[72:75], v[112:115]
    v_mfma_f32_16x16x32_bf16 v[36:39], v[208:211], v[164:167], 0
    v_mfma_f32_16x16x32_bf16 v[112:115], v[20:23], a[88:91], v[112:115]
    v_mov_b32 v41, 0
    v_mov_b32 v42, 0
    v_mfma_f32_16x16x32_bf16 v[120:123], v[20:23], a[92:95], v[120:123]
    ds_read_b64_tr_b16 v[20:21], v1 offset:40960
    ds_read_b64_tr_b16 v[22:23], v1 offset:41472
    v_mfma_f32_16x16x32_bf16 v[120:123], v[16:19], a[76:79], v[120:123]
    s_waitcnt lgkmcnt(2)
    ds_read_b64_tr_b16 v[16:17], v1 offset:36864
    ds_read_b64_tr_b16 v[18:19], v1 offset:37376
    v_mfma_f32_16x16x32_bf16 v[124:127], v[24:27], a[76:79], v[124:127]
    v_mov_b32 v43, 0
    v_cvt_pk_bf16_f32 v44, v216, v217
    v_mfma_f32_16x16x32_bf16 v[124:127], v[28:31], a[92:95], v[124:127]
    v_cvt_pk_bf16_f32 v45, v218, v219
    v_cvt_pk_bf16_f32 v40, v168, v169
    v_mfma_f32_16x16x32_bf16 v[116:119], v[28:31], a[88:91], v[116:119]
    v_cvt_pk_bf16_f32 v46, v176, v177
    v_cvt_pk_bf16_f32 v47, v178, v179
    v_mfma_f32_16x16x32_bf16 v[116:119], v[24:27], a[72:75], v[116:119]
    v_cvt_pk_bf16_f32 v172, v172, v173
    s_lshl_b64 s[42:43], s[42:43], 16
    v_mfma_f32_16x16x32_bf16 v[108:111], v[24:27], a[68:71], v[108:111]
    v_cndmask_b32 v40, v40, v172, s[42:43]
    v_cvt_pk_bf16_f32 v48, v180, v181
    v_mfma_f32_16x16x32_bf16 v[108:111], v[28:31], a[84:87], v[108:111]
    s_lshl_b64 s[42:43], s[42:43], 16
    v_cvt_pk_bf16_f32 v49, v182, v183
    v_cvt_pk_bf16_f32 v188, v188, v189
    v_mfma_f32_16x16x32_bf16 v[100:103], v[28:31], a[80:83], v[100:103]
    ds_read_b64_tr_b16 v[28:29], v2 offset:40960
    ds_read_b64_tr_b16 v[30:31], v2 offset:41472
    v_mfma_f32_16x16x32_bf16 v[100:103], v[24:27], a[64:67], v[100:103]
    s_waitcnt lgkmcnt(2)
    ds_read_b64_tr_b16 v[24:25], v2 offset:36864
    ds_read_b64_tr_b16 v[26:27], v2 offset:37376
    v_mfma_f32_16x16x32_bf16 v[64:67], v[16:19], a[96:99], v[64:67]
    v_cndmask_b32 v40, v40, v188, s[42:43]
    v_cvt_pk_bf16_f32 v50, v184, v185
    v_mfma_f32_16x16x32_bf16 v[64:67], v[20:23], a[112:115], v[64:67]
    s_lshl_b64 s[42:43], s[42:43], 16
    v_cvt_pk_bf16_f32 v51, v186, v187
    v_cvt_pk_bf16_f32 v36, v36, v37
    v_mfma_f32_16x16x32_bf16 v[72:75], v[20:23], a[116:119], v[72:75]
    v_cndmask_b32 v40, v40, v36, s[42:43]
    v_permlane32_swap_b32 v44, v46
    v_mfma_f32_16x16x32_bf16 v[72:75], v[16:19], a[100:103], v[72:75]
    v_permlane32_swap_b32 v45, v47
    v_permlane32_swap_b32 v48, v50
    v_mfma_f32_16x16x32_bf16 v[80:83], v[16:19], a[104:107], v[80:83]
    v_permlane32_swap_b32 v49, v51
    v_mul_f32 v136, v128, v136
    v_mfma_f32_16x16x32_bf16 v[80:83], v[20:23], a[120:123], v[80:83]
    buffer_store_dwordx4 v[44:47], v60, s[8:11], s36 offen sc1
    s_add_u32 s36, s36, 86144
    v_mfma_f32_16x16x32_bf16 v[88:91], v[20:23], a[124:127], v[88:91]
    ds_read_b64_tr_b16 v[20:21], v3 offset:40960
    ds_read_b64_tr_b16 v[22:23], v3 offset:41472
    v_mfma_f32_16x16x32_bf16 v[88:91], v[16:19], a[108:111], v[88:91]
    s_waitcnt lgkmcnt(2)
    ds_read_b64_tr_b16 v[16:17], v3 offset:36864
    ds_read_b64_tr_b16 v[18:19], v3 offset:37376
    v_mfma_f32_16x16x32_bf16 v[92:95], v[24:27], a[108:111], v[92:95]
    v_mul_f32 v128, s40, v128
    v_mul_f32 v137, v129, v137
    v_mfma_f32_16x16x32_bf16 v[92:95], v[28:31], a[124:127], v[92:95]
    v_exp_f32 v128, v128
    v_mfma_f32_16x16x32_bf16 v[84:87], v[28:31], a[120:123], v[84:87]
    v_mul_f32 v129, s40, v129
    v_mul_f32 v138, v130, v138
    v_mfma_f32_16x16x32_bf16 v[84:87], v[24:27], a[104:107], v[84:87]
    buffer_store_dwordx4 v[48:51], v60, s[8:11], s36 offen sc1
    v_mul_f32 v130, s40, v130
    v_mfma_f32_16x16x32_bf16 v[76:79], v[24:27], a[100:103], v[76:79]
    v_exp_f32 v129, v129
    v_mfma_f32_16x16x32_bf16 v[76:79], v[28:31], a[116:119], v[76:79]
    v_add_f32 v128, 1.0, v128
    v_mul_f32 v139, v131, v139
    v_mfma_f32_16x16x32_bf16 v[68:71], v[28:31], a[112:115], v[68:71]
    ds_read_b64_tr_b16 v[28:29], v4 offset:40960
    ds_read_b64_tr_b16 v[30:31], v4 offset:41472
    v_mfma_f32_16x16x32_bf16 v[68:71], v[24:27], a[96:99], v[68:71]
    s_waitcnt lgkmcnt(2)
    ds_read_b64_tr_b16 v[24:25], v4 offset:36864
    ds_read_b64_tr_b16 v[26:27], v4 offset:37376
    v_mfma_f32_16x16x32_bf16 v[96:99], v[16:19], a[96:99], v[96:99]
    s_waitcnt vmcnt(5)
    v_subrev_u32 v9, s51, v9
    v_cmp_le_u32 vcc, 7, v9
    s_nop 0
    s_cbranch_vccnz LS_w
LB_w:
    v_mfma_f32_16x16x32_bf16 v[96:99], v[20:23], a[112:115], v[96:99]
    buffer_store_dwordx4 v[40:43], v56, s[8:11], s38 offen sc1
    v_lshlrev_b32 v8, 2, v5
    v_mfma_f32_16x16x32_bf16 v[104:107], v[20:23], a[116:119], v[104:107]
    s_add_u32 s51, s44, 1
    buffer_load_dword v9, v8, s[8:11], s82 offen sc1
    v_mul_f32 v131, s40, v131
    v_mfma_f32_16x16x32_bf16 v[104:107], v[16:19], a[100:103], v[104:107]
    v_exp_f32 v130, v130
    v_mfma_f32_16x16x32_bf16 v[112:115], v[16:19], a[104:107], v[112:115]
    v_add_f32 v129, 1.0, v129
    v_mul_f32 v140, v132, v140
    v_mfma_f32_16x16x32_bf16 v[112:115], v[20:23], a[120:123], v[112:115]
    v_rcp_f32 v128, v128
    v_mfma_f32_16x16x32_bf16 v[120:123], v[20:23], a[124:127], v[120:123]
    s_barrier
    s_add_u32 m0, s19, 20480
    s_add_u32 s20, s20, 294912
    ds_read_b64_tr_b16 v[20:21], v1 offset:49152
    ds_read_b64_tr_b16 v[22:23], v1 offset:49664
    buffer_load_dwordx4 v6, s[12:15], s20 offen lds
    v_mfma_f32_16x16x32_bf16 v[120:123], v[16:19], a[108:111], v[120:123]
    s_waitcnt lgkmcnt(2)
    ds_read_b64_tr_b16 v[16:17], v1 offset:45056
    ds_read_b64_tr_b16 v[18:19], v1 offset:45568
    v_mfma_f32_16x16x32_bf16 v[124:127], v[24:27], a[108:111], v[124:127]
    s_add_u32 m0, s19, 24576
    v_exp_f32 v131, v131
    v_mfma_f32_16x16x32_bf16 v[124:127], v[28:31], a[124:127], v[124:127]
    s_mul_i32 s20, s56, 589824
    v_mul_f32 v132, s40, v132
    v_add_f32 v130, 1.0, v130
    v_mfma_f32_16x16x32_bf16 v[116:119], v[28:31], a[120:123], v[116:119]
    s_add_u32 s20, s20, s26
    v_rcp_f32 v129, v129
    v_mfma_f32_16x16x32_bf16 v[116:119], v[24:27], a[104:107], v[116:119]
    buffer_load_dwordx4 v6, s[96:99], s20 offen lds
    v_mul_f32 v128, v128, v136
    v_mfma_f32_16x16x32_bf16 v[108:111], v[24:27], a[100:103], v[108:111]
    s_add_u32 m0, s19, 28672
    v_mul_f32 v141, v133, v141
    v_mul_f32 v133, s40, v133
    v_mfma_f32_16x16x32_bf16 v[108:111], v[28:31], a[116:119], v[108:111]
    s_add_u32 s20, s20, 294912
    v_exp_f32 v132, v132
    v_mfma_f32_16x16x32_bf16 v[100:103], v[28:31], a[112:115], v[100:103]
    ds_read_b64_tr_b16 v[28:29], v2 offset:49152
    ds_read_b64_tr_b16 v[30:31], v2 offset:49664
    v_mfma_f32_16x16x32_bf16 v[100:103], v[24:27], a[96:99], v[100:103]
    s_waitcnt lgkmcnt(2)
    ds_read_b64_tr_b16 v[24:25], v2 offset:45056
    ds_read_b64_tr_b16 v[26:27], v2 offset:45568
    v_mfma_f32_16x16x32_bf16 v[64:67], v[16:19], a[128:131], v[64:67]
    v_add_f32 v131, 1.0, v131
    v_mul_f32 v129, v129, v137
    v_mfma_f32_16x16x32_bf16 v[64:67], v[20:23], a[144:147], v[64:67]
    buffer_load_dwordx4 v6, s[96:99], s20 offen lds
    v_mul_f32 v142, v134, v142
    v_mfma_f32_16x16x32_bf16 v[72:75], v[20:23], a[148:151], v[72:75]
    s_add_u32 m0, s19, 32768
    v_rcp_f32 v130, v130
    v_mfma_f32_16x16x32_bf16 v[72:75], v[16:19], a[132:135], v[72:75]
    s_mul_i32 s20, s57, 589824
    v_exp_f32 v133, v133
    v_mfma_f32_16x16x32_bf16 v[80:83], v[16:19], a[136:139], v[80:83]
    s_add_u32 s20, s20, s26
    v_mul_f32 v134, s40, v134
    v_add_f32 v132, 1.0, v132
    v_mfma_f32_16x16x32_bf16 v[80:83], v[20:23], a[152:155], v[80:83]
    v_rcp_f32 v131, v131
    v_mfma_f32_16x16x32_bf16 v[88:91], v[20:23], a[156:159], v[88:91]
    ds_read_b64_tr_b16 v[20:21], v1 offset:57344
    ds_read_b64_tr_b16 v[22:23], v1 offset:57856
    v_mfma_f32_16x16x32_bf16 v[88:91], v[16:19], a[140:143], v[88:91]
    s_waitcnt lgkmcnt(2)
    ds_read_b64_tr_b16 v[16:17], v1 offset:53248
    ds_read_b64_tr_b16 v[18:19], v1 offset:53760
    v_mfma_f32_16x16x32_bf16 v[92:95], v[24:27], a[140:143], v[92:95]
    buffer_load_dwordx4 v6, s[96:99], s20 offen lds
    v_mul_f32 v130, v130, v138
    v_mfma_f32_16x16x32_bf16 v[92:95], v[28:31], a[156:159], v[92:95]
    s_add_u32 m0, s19, 90112
    v_mul_f32 v143, v135, v143
    v_mul_f32 v135, s40, v135
    v_mfma_f32_16x16x32_bf16 v[84:87], v[28:31], a[152:155], v[84:87]
    s_add_u32 s66, s66, 4096
    v_exp_f32 v134, v134
    v_mfma_f32_16x16x32_bf16 v[84:87], v[24:27], a[136:139], v[84:87]
    v_add_f32 v133, 1.0, v133
    v_mul_f32 v131, v131, v139
    v_mfma_f32_16x16x32_bf16 v[76:79], v[24:27], a[132:135], v[76:79]
    v_rcp_f32 v132, v132
    v_mfma_f32_16x16x32_bf16 v[76:79], v[28:31], a[148:151], v[76:79]
    buffer_load_dwordx4 v5, s[8:11], s66 offen sc1 lds
    v_add_f32 v134, 1.0, v134
    v_mfma_f32_16x16x32_bf16 v[68:71], v[28:31], a[144:147], v[68:71]
    s_add_u32 m0, s19, 94208
    ds_read_b64_tr_b16 v[28:29], v2 offset:57344
    ds_read_b64_tr_b16 v[30:31], v2 offset:57856
    v_mfma_f32_16x16x32_bf16 v[68:71], v[24:27], a[128:131], v[68:71]
    s_waitcnt lgkmcnt(2)
    ds_read_b64_tr_b16 v[24:25], v2 offset:53248
    ds_read_b64_tr_b16 v[26:27], v2 offset:53760
    v_mfma_f32_16x16x32_bf16 v[64:67], v[16:19], a[160:163], v[64:67]
    s_add_u32 s66, s66, 4096
    v_exp_f32 v135, v135
    v_mfma_f32_16x16x32_bf16 v[64:67], v[20:23], a[176:179], v[64:67]
    v_rcp_f32 v133, v133
    v_mfma_f32_16x16x32_bf16 v[72:75], v[20:23], a[180:183], v[72:75]
    v_mul_f32 v132, v132, v140
    v_add_f32 v135, 1.0, v135
    v_mfma_f32_16x16x32_bf16 v[72:75], v[16:19], a[164:167], v[72:75]
    buffer_load_dwordx4 v5, s[8:11], s66 offen sc1 lds
    v_mul_f32 v133, v133, v141
    v_mfma_f32_16x16x32_bf16 v[80:83], v[16:19], a[168:171], v[80:83]
    s_add_u32 m0, s19, 98304
    v_rcp_f32 v134, v134
    v_mfma_f32_16x16x32_bf16 v[80:83], v[20:23], a[184:187], v[80:83]
    s_add_u32 s66, s66, 4096
    v_rcp_f32 v135, v135
    v_mfma_f32_16x16x32_bf16 v[88:91], v[20:23], a[188:191], v[88:91]
    s_waitcnt vmcnt(11)
    s_barrier
    ds_read_b64_tr_b16 v[20:21], v1 offset:4096
    ds_read_b64_tr_b16 v[22:23], v1 offset:4608
    v_mfma_f32_16x16x32_bf16 v[88:91], v[16:19], a[172:175], v[88:91]
    s_waitcnt lgkmcnt(2)
    ds_read_b64_tr_b16 v[16:17], v1 offset:0
    ds_read_b64_tr_b16 v[18:19], v1 offset:512
    v_mfma_f32_16x16x32_bf16 v[92:95], v[24:27], a[172:175], v[92:95]
    v_mul_f32 v134, v134, v142
    v_mul_f32 v135, v135, v143
    v_mfma_f32_16x16x32_bf16 v[92:95], v[28:31], a[188:191], v[92:95]
    buffer_load_dwordx4 v5, s[8:11], s66 offen sc1 lds
    v_cvt_pk_bf16_f32 v136, v128, v129
    v_mfma_f32_16x16x32_bf16 v[84:87], v[28:31], a[184:187], v[84:87]
    s_add_u32 m0, s19, 36864
    v_cvt_pk_bf16_f32 v137, v130, v131
    v_cvt_pk_bf16_f32 v138, v132, v133
    v_mfma_f32_16x16x32_bf16 v[84:87], v[24:27], a[168:171], v[84:87]
    s_add_u32 s20, s20, 294912
    v_cvt_pk_bf16_f32 v139, v134, v135
    v_permlane32_swap_b32 v136, v138
    v_mfma_f32_16x16x32_bf16 v[76:79], v[24:27], a[164:167], v[76:79]
    v_permlane32_swap_b32 v137, v139
    v_mul_f32 v152, v144, v152
    v_mfma_f32_16x16x32_bf16 v[76:79], v[28:31], a[180:183], v[76:79]
    v_mul_f32 v144, s40, v144
    v_mul_f32 v153, v145, v153
    v_mfma_f32_16x16x32_bf16 v[68:71], v[28:31], a[176:179], v[68:71]
    ds_read_b64_tr_b16 v[28:29], v2 offset:4096
    ds_read_b64_tr_b16 v[30:31], v2 offset:4608
    v_mfma_f32_16x16x32_bf16 v[68:71], v[24:27], a[160:163], v[68:71]
    s_waitcnt lgkmcnt(2)
    ds_read_b64_tr_b16 v[24:25], v2 offset:0
    ds_read_b64_tr_b16 v[26:27], v2 offset:512
    v_mfma_f32_16x16x32_bf16 v[64:67], v[16:19], a[192:195], v[64:67]
    buffer_load_dwordx4 v6, s[96:99], s20 offen lds
    v_mul_f32 v145, s40, v145
    v_mfma_f32_16x16x32_bf16 v[64:67], v[20:23], a[208:211], v[64:67]
    s_add_u32 m0, s19, 40960
    v_exp_f32 v144, v144
    v_mfma_f32_16x16x32_bf16 v[72:75], v[20:23], a[212:215], v[72:75]
    s_mul_i32 s20, s58, 589824
    v_mul_f32 v154, v146, v154
    v_mul_f32 v146, s40, v146
    v_mfma_f32_16x16x32_bf16 v[72:75], v[16:19], a[196:199], v[72:75]
    s_add_u32 s20, s20, s26
    v_exp_f32 v145, v145
    v_mfma_f32_16x16x32_bf16 v[80:83], v[16:19], a[200:203], v[80:83]
    v_add_f32 v144, 1.0, v144
    v_mul_f32 v155, v147, v155
    v_mfma_f32_16x16x32_bf16 v[80:83], v[20:23], a[216:219], v[80:83]
    buffer_load_dwordx4 v6, s[96:99], s20 offen lds
    v_mul_f32 v147, s40, v147
    v_mfma_f32_16x16x32_bf16 v[88:91], v[20:23], a[220:223], v[88:91]
    s_add_u32 m0, s19, 102400
    ds_read_b64_tr_b16 v[20:21], v1 offset:12288
    ds_read_b64_tr_b16 v[22:23], v1 offset:12800
    v_mfma_f32_16x16x32_bf16 v[88:91], v[16:19], a[204:207], v[88:91]
    s_waitcnt lgkmcnt(2)
    ds_read_b64_tr_b16 v[16:17], v1 offset:8192
    ds_read_b64_tr_b16 v[18:19], v1 offset:8704
    v_mfma_f32_16x16x32_bf16 v[92:95], v[24:27], a[204:207], v[92:95]
    s_add_u32 s66, s66, 4096
    v_exp_f32 v146, v146
    v_mfma_f32_16x16x32_bf16 v[92:95], v[28:31], a[220:223], v[92:95]
    v_add_f32 v145, 1.0, v145
    v_mul_f32 v156, v148, v156
    v_mfma_f32_16x16x32_bf16 v[84:87], v[28:31], a[216:219], v[84:87]
    v_rcp_f32 v144, v144
    v_mfma_f32_16x16x32_bf16 v[84:87], v[24:27], a[200:203], v[84:87]
    buffer_load_dwordx4 v5, s[8:11], s66 offen sc1 lds
    v_mul_f32 v148, s40, v148
    v_mfma_f32_16x16x32_bf16 v[76:79], v[24:27], a[196:199], v[76:79]
    s_add_u32 m0, s19, 106496
    v_exp_f32 v147, v147
    v_mfma_f32_16x16x32_bf16 v[76:79], v[28:31], a[212:215], v[76:79]
    s_add_u32 s66, s66, 4096
    v_add_f32 v146, 1.0, v146
    v_mul_f32 v144, v144, v152
    v_mfma_f32_16x16x32_bf16 v[68:71], v[28:31], a[208:211], v[68:71]
    ds_read_b64_tr_b16 v[28:29], v2 offset:12288
    ds_read_b64_tr_b16 v[30:31], v2 offset:12800
    v_mfma_f32_16x16x32_bf16 v[68:71], v[24:27], a[192:195], v[68:71]
    s_waitcnt lgkmcnt(2)
    ds_read_b64_tr_b16 v[24:25], v2 offset:8192
    ds_read_b64_tr_b16 v[26:27], v2 offset:8704
    v_mfma_f32_16x16x32_bf16 v[64:67], v[16:19], a[224:227], v[64:67]
    v_rcp_f32 v145, v145
    v_mfma_f32_16x16x32_bf16 v[64:67], v[20:23], a[240:243], v[64:67]
    buffer_load_dwordx4 v5, s[8:11], s66 offen sc1 lds
    v_mul_f32 v157, v149, v157
    v_mfma_f32_16x16x32_bf16 v[72:75], v[20:23], a[244:247], v[72:75]
    s_add_u32 m0, s19, 110592
    v_exp_f32 v148, v148
    v_mfma_f32_16x16x32_bf16 v[72:75], v[16:19], a[228:231], v[72:75]
    s_add_u32 s66, s66, 4096
    v_mul_f32 v149, s40, v149
    v_add_f32 v147, 1.0, v147
    v_mfma_f32_16x16x32_bf16 v[80:83], v[16:19], a[232:235], v[80:83]
    v_rcp_f32 v146, v146
    v_mfma_f32_16x16x32_bf16 v[80:83], v[20:23], a[248:251], v[80:83]
    v_mul_f32 v145, v145, v153
    v_mul_f32 v158, v150, v158
    v_mfma_f32_16x16x32_bf16 v[88:91], v[20:23], a[252:255], v[88:91]
    s_waitcnt vmcnt(10)
    s_barrier
    ds_read_b64_tr_b16 v[20:21], v1 offset:20480
    ds_read_b64_tr_b16 v[22:23], v1 offset:20992
    v_mfma_f32_16x16x32_bf16 v[88:91], v[16:19], a[236:239], v[88:91]
    s_waitcnt lgkmcnt(2)
    ds_read_b64_tr_b16 v[16:17], v1 offset:16384
    ds_read_b64_tr_b16 v[18:19], v1 offset:16896
    v_mfma_f32_16x16x32_bf16 v[92:95], v[24:27], a[236:239], v[92:95]
    buffer_load_dwordx4 v5, s[8:11], s66 offen sc1 lds
    v_mul_f32 v150, s40, v150
    v_mfma_f32_16x16x32_bf16 v[92:95], v[28:31], a[252:255], v[92:95]
    s_add_u32 m0, s19, 114688
    v_exp_f32 v149, v149
    v_mfma_f32_16x16x32_bf16 v[84:87], v[28:31], a[248:251], v[84:87]
    s_add_u32 s66, s66, 4096
    v_add_f32 v148, 1.0, v148
    v_mul_f32 v146, v146, v154
    v_mfma_f32_16x16x32_bf16 v[84:87], v[24:27], a[232:235], v[84:87]
    v_rcp_f32 v147, v147
    v_mfma_f32_16x16x32_bf16 v[76:79], v[24:27], a[228:231], v[76:79]
    v_mul_f32 v159, v151, v159
    v_mul_f32 v151, s40, v151
    v_mfma_f32_16x16x32_bf16 v[76:79], v[28:31], a[244:247], v[76:79]
    buffer_load_dwordx4 v5, s[8:11], s66 offen sc1 lds
    v_add_f32 v149, 1.0, v149
    v_mfma_f32_16x16x32_bf16 v[68:71], v[28:31], a[240:243], v[68:71]
    s_add_u32 m0, s19, 118784
    ds_read_b64_tr_b16 v[28:29], v2 offset:20480
    ds_read_b64_tr_b16 v[30:31], v2 offset:20992
    v_mfma_f32_16x16x32_bf16 v[68:71], v[24:27], a[224:227], v[68:71]
    s_waitcnt lgkmcnt(2)
    ds_read_b64_tr_b16 v[24:25], v2 offset:16384
    ds_read_b64_tr_b16 v[26:27], v2 offset:16896
    v_mfma_f32_16x16x32_bf16 v[64:67], v[16:19], v[224:227], v[64:67]
    s_add_u32 s66, s66, 4096
    v_subrev_u32 v9, s51, v9
    v_cmp_le_u32 vcc, 7, v9
    s_nop 0
    s_and_b64 vcc, vcc, s[84:85]
    s_cbranch_vccnz LS_e
LB_e:
    v_mfma_f32_16x16x32_bf16 v[64:67], v[20:23], v[240:243], v[64:67]
    s_barrier
    v_mul_f32 v147, v147, v155
    v_mfma_f32_16x16x32_bf16 v[72:75], v[20:23], v[244:247], v[72:75]
    v_mov_b32 v10, s44
    v_mov_b32 v11, s45
    v_mfma_f32_16x16x32_bf16 v[72:75], v[16:19], v[228:231], v[72:75]
    buffer_load_dwordx4 v5, s[8:11], s66 offen sc1 lds
    buffer_store_dwordx2 v[10:11], off, s[8:11], s83 sc1
    v_mfma_f32_16x16x32_bf16 v[80:83], v[16:19], v[232:235], v[80:83]
    s_add_u32 m0, s19, 122880
    v_bfe_u32 v9, v5, 8, 1
    v_and_b32 v8, 0xf0, v5
    v_mfma_f32_16x16x32_bf16 v[80:83], v[20:23], v[248:251], v[80:83]
    s_add_u32 s66, s66, 4096
    v_lshl_add_u32 v9, v9, 3, v8
    v_mfma_f32_16x16x32_bf16 v[88:91], v[20:23], v[252:255], v[88:91]
    ds_read_b64_tr_b16 v[20:21], v3 offset:49152
    ds_read_b64_tr_b16 v[22:23], v3 offset:49664
    v_mfma_f32_16x16x32_bf16 v[88:91], v[16:19], v[236:239], v[88:91]
    s_waitcnt lgkmcnt(2)
    ds_read_b64_tr_b16 v[16:17], v3 offset:45056
    ds_read_b64_tr_b16 v[18:19], v3 offset:45568
    v_mfma_f32_16x16x32_bf16 v[92:95], v[24:27], v[236:239], v[92:95]
    buffer_load_dwordx2 v[10:11], v9, s[8:11], s48 offen offset:2048 sc1
    v_mfma_f32_16x16x32_bf16 v[92:95], v[28:31], v[252:255], v[92:95]
    buffer_load_dwordx4 v5, s[8:11], s66 offen sc1 lds
    buffer_load_dwordx4 v[200:203], v5, s[8:11], s48 offen sc1
    v_mfma_f32_16x16x32_bf16 v[84:87], v[28:31], v[248:251], v[84:87]
    s_add_u32 m0, s19, 126976
    buffer_load_dwordx4 v[204:207], v5, s[8:11], s48 offen offset:1024 sc1
    s_add_u32 s66, s66, 4096
    v_mfma_f32_16x16x32_bf16 v[84:87], v[24:27], v[232:235], v[84:87]
    v_and_b32 v8, 0x70, v5
    v_lshlrev_b32 v8, 2, v8
    v_mfma_f32_16x16x32_bf16 v[76:79], v[24:27], v[228:231], v[76:79]
    v_exp_f32 v150, v150
    v_mfma_f32_16x16x32_bf16 v[76:79], v[28:31], v[244:247], v[76:79]
    v_rcp_f32 v148, v148
    v_mfma_f32_16x16x32_bf16 v[68:71], v[28:31], v[240:243], v[68:71]
    ds_read_b64_tr_b16 v[28:29], v4 offset:49152
    ds_read_b64_tr_b16 v[30:31], v4 offset:49664
    v_mfma_f32_16x16x32_bf16 v[68:71], v[24:27], v[224:227], v[68:71]
    s_waitcnt lgkmcnt(2)
    ds_read_b64_tr_b16 v[24:25], v4 offset:45056
    ds_read_b64_tr_b16 v[26:27], v4 offset:45568
    v_mfma_f32_16x16x32_bf16 v[96:99], v[16:19], a[128:131], v[96:99]
    buffer_load_dwordx4 v5, s[8:11], s66 offen sc1 lds
    v_add_f32 v150, 1.0, v150
    v_mfma_f32_16x16x32_bf16 v[96:99], v[20:23], a[144:147], v[96:99]
    s_add_u32 m0, s19, 131072
    v_exp_f32 v151, v151
    v_mfma_f32_16x16x32_bf16 v[104:107], v[20:23], a[148:151], v[104:107]
    s_add_u32 s66, s66, 4096
    v_rcp_f32 v149, v149
    v_mfma_f32_16x16x32_bf16 v[104:107], v[16:19], a[132:135], v[104:107]
    v_mul_f32 v148, v148, v156
    v_add_f32 v151, 1.0, v151
    v_mfma_f32_16x16x32_bf16 v[112:115], v[16:19], a[136:139], v[112:115]
    v_rcp_f32 v150, v150
    v_mfma_f32_16x16x32_bf16 v[112:115], v[20:23], a[152:155], v[112:115]
    buffer_load_dwordx4 v5, s[8:11], s66 offen sc1 lds
    v_mul_f32 v149, v149, v157
    v_mfma_f32_16x16x32_bf16 v[120:123], v[20:23], a[156:159], v[120:123]
    s_add_u32 m0, s19, 135168
    ds_read_b64_tr_b16 v[20:21], v3 offset:57344
    ds_read_b64_tr_b16 v[22:23], v3 offset:57856
    v_mfma_f32_16x16x32_bf16 v[120:123], v[16:19], a[140:143], v[120:123]
    s_waitcnt lgkmcnt(2)
    ds_read_b64_tr_b16 v[16:17], v3 offset:53248
    ds_read_b64_tr_b16 v[18:19], v3 offset:53760
    v_mfma_f32_16x16x32_bf16 v[124:127], v[24:27], a[140:143], v[124:127]
    s_add_u32 s66, s66, 4096
    v_rcp_f32 v151, v151
    v_mfma_f32_16x16x32_bf16 v[124:127], v[28:31], a[156:159], v[124:127]
    v_mul_f32 v150, v150, v158
    v_mul_f32 v151, v151, v159
    v_mfma_f32_16x16x32_bf16 v[116:119], v[28:31], a[152:155], v[116:119]
    v_cvt_pk_bf16_f32 v152, v144, v145
    v_cvt_pk_bf16_f32 v153, v146, v147
    v_mfma_f32_16x16x32_bf16 v[116:119], v[24:27], a[136:139], v[116:119]
    buffer_load_dwordx4 v5, s[8:11], s66 offen sc1 lds
    v_cvt_pk_bf16_f32 v154, v148, v149
    v_mfma_f32_16x16x32_bf16 v[108:111], v[24:27], a[132:135], v[108:111]
    s_add_u32 m0, s19, 139264
    v_cvt_pk_bf16_f32 v155, v150, v151
    v_permlane32_swap_b32 v152, v154
    v_mfma_f32_16x16x32_bf16 v[108:111], v[28:31], a[148:151], v[108:111]
    s_add_u32 s66, s66, 4096
    v_permlane32_swap_b32 v153, v155
    v_mfma_f32_16x16x32_bf16 v[100:103], v[28:31], a[144:147], v[100:103]
    ds_read_b64_tr_b16 v[28:29], v4 offset:57344
    ds_read_b64_tr_b16 v[30:31], v4 offset:57856
    v_mfma_f32_16x16x32_bf16 v[100:103], v[24:27], a[128:131], v[100:103]
    s_waitcnt lgkmcnt(2)
    ds_read_b64_tr_b16 v[24:25], v4 offset:53248
    ds_read_b64_tr_b16 v[26:27], v4 offset:53760
    v_mfma_f32_16x16x32_bf16 v[96:99], v[16:19], a[160:163], v[96:99]
    s_add_u32 s39, s31, 45056
    buffer_store_dwordx4 v[136:139], v13, s[8:11], s39 offen sc1
    v_mfma_f32_16x16x32_bf16 v[96:99], v[20:23], a[176:179], v[96:99]
    buffer_load_dwordx4 v5, s[8:11], s66 offen sc1 lds
    v_mfma_f32_16x16x32_bf16 v[104:107], v[20:23], a[180:183], v[104:107]
    s_add_u32 m0, s19, 143360
    s_add_u32 s66, s66, 4096
    v_mfma_f32_16x16x32_bf16 v[104:107], v[16:19], a[164:167], v[104:107]
    v_mfma_f32_16x16x32_bf16 v[112:115], v[16:19], a[168:171], v[112:115]
    v_mfma_f32_16x16x32_bf16 v[112:115], v[20:23], a[184:187], v[112:115]
    v_mfma_f32_16x16x32_bf16 v[120:123], v[20:23], a[188:191], v[120:123]
    ds_read_b64_tr_b16 v[20:21], v3 offset:4096
    ds_read_b64_tr_b16 v[22:23], v3 offset:4608
    v_mfma_f32_16x16x32_bf16 v[120:123], v[16:19], a[172:175], v[120:123]
    s_waitcnt lgkmcnt(2)
    ds_read_b64_tr_b16 v[16:17], v3 offset:0
    ds_read_b64_tr_b16 v[18:19], v3 offset:512
    v_mfma_f32_16x16x32_bf16 v[124:127], v[24:27], a[172:175], v[124:127]
    buffer_load_dwordx4 v5, s[8:11], s66 offen sc1 lds
    v_mfma_f32_16x16x32_bf16 v[124:127], v[28:31], a[188:191], v[124:127]
    s_add_u32 s39, s31, 131200
    buffer_store_dwordx4 v[152:155], v13, s[8:11], s39 offen sc1
    v_mul_f32 v208, s40, v64
    v_mfma_f32_16x16x32_bf16 v[116:119], v[28:31], a[184:187], v[116:119]
    s_add_u32 s28, s44, 2
    v_mov_b32 v15, s28
    v_mul_f32 v209, s40, v65
    v_mfma_f32_16x16x32_bf16 v[116:119], v[24:27], a[168:171], v[116:119]
    s_add_u32 m0, s19, 147456
    v_exp_f32 v208, v208
    v_mfma_f32_16x16x32_bf16 v[108:111], v[24:27], a[164:167], v[108:111]
    s_add_u32 s66, s66, 4096
    v_exp_f32 v209, v209
    v_mfma_f32_16x16x32_bf16 v[108:111], v[28:31], a[180:183], v[108:111]
    buffer_load_dwordx4 v5, s[8:11], s66 offen sc1 lds
    v_mul_f32 v210, s40, v66
    v_mfma_f32_16x16x32_bf16 v[100:103], v[28:31], a[176:179], v[100:103]
    s_add_u32 m0, s19, 151552
    ds_read_b64_tr_b16 v[28:29], v4 offset:4096
    ds_read_b64_tr_b16 v[30:31], v4 offset:4608
    v_mfma_f32_16x16x32_bf16 v[100:103], v[24:27], a[160:163], v[100:103]
    s_waitcnt lgkmcnt(2)
    ds_read_b64_tr_b16 v[24:25], v4 offset:0
    ds_read_b64_tr_b16 v[26:27], v4 offset:512
    v_mfma_f32_16x16x32_bf16 v[96:99], v[16:19], a[192:195], v[96:99]
    s_add_u32 s66, s66, 4096
    v_add_f32 v208, 1.0, v208
    v_mul_f32 v211, s40, v67
    v_mfma_f32_16x16x32_bf16 v[96:99], v[20:23], a[208:211], v[96:99]
    v_exp_f32 v210, v210
    v_mfma_f32_16x16x32_bf16 v[104:107], v[20:23], a[212:215], v[104:107]
    v_rcp_f32 v208, v208
    v_mfma_f32_16x16x32_bf16 v[104:107], v[16:19], a[196:199], v[104:107]
    buffer_load_dwordx4 v5, s[8:11], s66 offen sc1 lds
    v_add_f32 v209, 1.0, v209
    v_mfma_f32_16x16x32_bf16 v[112:115], v[16:19], a[200:203], v[112:115]
    s_add_u32 m0, s19, 155648
    v_mul_f32 v64, v64, v208
    v_mul_f32 v212, s40, v68
    v_mfma_f32_16x16x32_bf16 v[112:115], v[20:23], a[216:219], v[112:115]
    s_add_u32 s66, s66, 4096
    v_exp_f32 v211, v211
    v_mfma_f32_16x16x32_bf16 v[120:123], v[20:23], a[220:223], v[120:123]
    ds_read_b64_tr_b16 v[20:21], v3 offset:12288
    ds_read_b64_tr_b16 v[22:23], v3 offset:12800
    v_mfma_f32_16x16x32_bf16 v[120:123], v[16:19], a[204:207], v[120:123]
    s_waitcnt lgkmcnt(2)
    ds_read_b64_tr_b16 v[16:17], v3 offset:8192
    ds_read_b64_tr_b16 v[18:19], v3 offset:8704
    v_mfma_f32_16x16x32_bf16 v[124:127], v[24:27], a[204:207], v[124:127]
    v_rcp_f32 v209, v209
    v_mfma_f32_16x16x32_bf16 v[124:127], v[28:31], a[220:223], v[124:127]
    buffer_load_dwordx4 v5, s[8:11], s66 offen sc1 lds
    v_add_f32 v210, 1.0, v210
    v_mfma_f32_16x16x32_bf16 v[116:119], v[28:31], a[216:219], v[116:119]
    s_add_u32 m0, s19, 159744
    v_mul_f32 v65, v65, v209
    v_mul_f32 v213, s40, v69
    v_mfma_f32_16x16x32_bf16 v[116:119], v[24:27], a[200:203], v[116:119]
    s_add_u32 s66, s66, 4096
    v_exp_f32 v212, v212
    v_mfma_f32_16x16x32_bf16 v[108:111], v[24:27], a[196:199], v[108:111]
    v_rcp_f32 v210, v210
    v_mfma_f32_16x16x32_bf16 v[108:111], v[28:31], a[212:215], v[108:111]
    v_add_f32 v211, 1.0, v211
    v_mul_f32 v66, v66, v210
    v_mfma_f32_16x16x32_bf16 v[100:103], v[28:31], a[208:211], v[100:103]
    ds_read_b64_tr_b16 v[28:29], v4 offset:12288
    ds_read_b64_tr_b16 v[30:31], v4 offset:12800
    v_mfma_f32_16x16x32_bf16 v[100:103], v[24:27], a[192:195], v[100:103]
    s_waitcnt lgkmcnt(2)
    ds_read_b64_tr_b16 v[24:25], v4 offset:8192
    ds_read_b64_tr_b16 v[26:27], v4 offset:8704
    v_mfma_f32_16x16x32_bf16 v[96:99], v[16:19], a[224:227], v[96:99]
    buffer_load_dwordx4 v5, s[8:11], s66 offen sc1 lds
    v_mul_f32 v214, s40, v70
    v_mfma_f32_16x16x32_bf16 v[96:99], v[20:23], a[240:243], v[96:99]
    s_add_u32 m0, s19, 61440
    v_exp_f32 v213, v213
    v_mfma_f32_16x16x32_bf16 v[104:107], v[20:23], a[244:247], v[104:107]
    s_add_u32 s66, s66, 4096
    v_rcp_f32 v211, v211
    v_mfma_f32_16x16x32_bf16 v[104:107], v[16:19], a[228:231], v[104:107]
    v_add_f32 v212, 1.0, v212
    v_mul_f32 v67, v67, v211
    v_mfma_f32_16x16x32_bf16 v[112:115], v[16:19], a[232:235], v[112:115]
    v_exp_f32 v214, v214
    v_mfma_f32_16x16x32_bf16 v[112:115], v[20:23], a[248:251], v[112:115]
    buffer_load_dwordx4 v5, s[8:11], s66 offen sc1 lds
    v_mul_f32 v215, s40, v71
    v_mfma_f32_16x16x32_bf16 v[120:123], v[20:23], a[252:255], v[120:123]
    s_add_u32 m0, s19, 65536
    ds_read_b64_tr_b16 v[20:21], v3 offset:20480
    ds_read_b64_tr_b16 v[22:23], v3 offset:20992
    v_mfma_f32_16x16x32_bf16 v[120:123], v[16:19], a[236:239], v[120:123]
    s_waitcnt lgkmcnt(2)
    ds_read_b64_tr_b16 v[16:17], v3 offset:16384
    ds_read_b64_tr_b16 v[18:19], v3 offset:16896
    v_mfma_f32_16x16x32_bf16 v[124:127], v[24:27], a[236:239], v[124:127]
    s_add_u32 s66, s66, 4096
    v_rcp_f32 v212, v212
    v_mfma_f32_16x16x32_bf16 v[124:127], v[28:31], a[252:255], v[124:127]
    v_add_f32 v213, 1.0, v213
    v_mul_f32 v68, v68, v212
    v_mfma_f32_16x16x32_bf16 v[116:119], v[28:31], a[248:251], v[116:119]
    v_exp_f32 v215, v215
    v_mfma_f32_16x16x32_bf16 v[116:119], v[24:27], a[232:235], v[116:119]
    buffer_load_dwordx4 v5, s[8:11], s66 offen sc1 lds
    v_mul_f32 v208, s40, v72
    v_mfma_f32_16x16x32_bf16 v[108:111], v[24:27], a[228:231], v[108:111]
    s_add_u32 m0, s19, 69632
    v_rcp_f32 v213, v213
    v_mfma_f32_16x16x32_bf16 v[108:111], v[28:31], a[244:247], v[108:111]
    s_add_u32 s66, s66, 4096
    v_add_f32 v214, 1.0, v214
    v_mul_f32 v69, v69, v213
    v_mfma_f32_16x16x32_bf16 v[100:103], v[28:31], a[240:243], v[100:103]
    ds_read_b64_tr_b16 v[28:29], v4 offset:20480
    ds_read_b64_tr_b16 v[30:31], v4 offset:20992
    v_mfma_f32_16x16x32_bf16 v[100:103], v[24:27], a[224:227], v[100:103]
    s_waitcnt lgkmcnt(2)
    ds_read_b64_tr_b16 v[24:25], v4 offset:16384
    ds_read_b64_tr_b16 v[26:27], v4 offset:16896
    v_mfma_f32_16x16x32_bf16 v[96:99], v[16:19], v[224:227], v[96:99]
    v_exp_f32 v208, v208
    v_mfma_f32_16x16x32_bf16 v[96:99], v[20:23], v[240:243], v[96:99]
    buffer_load_dwordx4 v5, s[8:11], s66 offen sc1 lds
    v_mul_f32 v209, s40, v73
    v_mfma_f32_16x16x32_bf16 v[104:107], v[20:23], v[244:247], v[104:107]
    s_add_u32 m0, s19, 73728
    v_rcp_f32 v214, v214
    v_mfma_f32_16x16x32_bf16 v[104:107], v[16:19], v[228:231], v[104:107]
    s_add_u32 s66, s66, 4096
    v_add_f32 v215, 1.0, v215
    v_mul_f32 v70, v70, v214
    v_mfma_f32_16x16x32_bf16 v[112:115], v[16:19], v[232:235], v[112:115]
    v_exp_f32 v209, v209
    v_mfma_f32_16x16x32_bf16 v[112:115], v[20:23], v[248:251], v[112:115]
    v_mul_f32 v210, s40, v74
    v_add_f32 v208, 1.0, v208
    v_mfma_f32_16x16x32_bf16 v[120:123], v[20:23], v[252:255], v[120:123]
    s_waitcnt vmcnt(25)
    s_barrier
    ds_read_b64_tr_b16 v[20:21], v1 offset:28672
    ds_read_b64_tr_b16 v[22:23], v1 offset:29184
    v_mfma_f32_16x16x32_bf16 v[120:123], v[16:19], v[236:239], v[120:123]
    s_waitcnt lgkmcnt(2)
    ds_read_b64_tr_b16 v[16:17], v1 offset:24576
    ds_read_b64_tr_b16 v[18:19], v1 offset:25088
    v_mfma_f32_16x16x32_bf16 v[124:127], v[24:27], v[236:239], v[124:127]
    buffer_load_dwordx4 v5, s[8:11], s66 offen sc1 lds
    v_mul_f32 v211, s40, v75
    v_mfma_f32_16x16x32_bf16 v[124:127], v[28:31], v[252:255], v[124:127]
    s_add_u32 m0, s19, 45056
    v_rcp_f32 v215, v215
    v_mfma_f32_16x16x32_bf16 v[116:119], v[28:31], v[248:251], v[116:119]
    s_add_u32 s20, s20, 294912
    v_mul_f32 v71, v71, v215
    v_add_f32 v209, 1.0, v209
    v_mfma_f32_16x16x32_bf16 v[116:119], v[24:27], v[232:235], v[116:119]
    v_exp_f32 v210, v210
    v_mfma_f32_16x16x32_bf16 v[108:111], v[24:27], v[228:231], v[108:111]
    v_rcp_f32 v208, v208
    v_mfma_f32_16x16x32_bf16 v[108:111], v[28:31], v[244:247], v[108:111]
    buffer_load_dwordx4 v6, s[96:99], s20 offen lds
    v_mul_f32 v72, v72, v208
    v_mfma_f32_16x16x32_bf16 v[100:103], v[28:31], v[240:243], v[100:103]
    s_add_u32 m0, s19, 49152
    ds_read_b64_tr_b16 v[28:29], v2 offset:28672
    ds_read_b64_tr_b16 v[30:31], v2 offset:29184
    v_mfma_f32_16x16x32_bf16 v[100:103], v[24:27], v[224:227], v[100:103]
    s_waitcnt lgkmcnt(2)
    ds_read_b64_tr_b16 v[24:25], v2 offset:24576
    ds_read_b64_tr_b16 v[26:27], v2 offset:25088
    v_mfma_f32_16x16x32_bf16 v[32:35], v[16:19], a[0:3], 0
    s_mul_i32 s20, s59, 589824
    v_exp_f32 v211, v211
    v_mul_f32 v212, s40, v76
    v_mfma_f32_16x16x32_bf16 v[32:35], v[20:23], a[16:19], v[32:35]
    s_add_u32 s20, s20, s26
    v_rcp_f32 v209, v209
    v_mfma_f32_16x16x32_bf16 v[40:43], v[20:23], a[20:23], 0
    buffer_load_dwordx4 v6, s[96:99], s20 offen lds
    v_add_f32 v210, 1.0, v210
    v_mfma_f32_16x16x32_bf16 v[40:43], v[16:19], a[4:7], v[40:43]
    s_add_u32 m0, s19, 53248
    v_mul_f32 v73, v73, v209
    v_exp_f32 v212, v212
    v_mfma_f32_16x16x32_bf16 v[48:51], v[16:19], a[8:11], 0
    s_add_u32 s20, s20, 294912
    v_mul_f32 v213, s40, v77
    v_add_f32 v211, 1.0, v211
    v_mfma_f32_16x16x32_bf16 v[48:51], v[20:23], a[24:27], v[48:51]
    buffer_load_dwordx4 v6, s[96:99], s20 offen lds
    v_mul_f32 v214, s40, v78
    v_mfma_f32_16x16x32_bf16 v[56:59], v[20:23], a[28:31], 0
    s_add_u32 m0, s19, 57344
    ds_read_b64_tr_b16 v[20:21], v3 offset:28672
    ds_read_b64_tr_b16 v[22:23], v3 offset:29184
    v_add_f32 v212, 1.0, v212
    v_mfma_f32_16x16x32_bf16 v[56:59], v[16:19], a[12:15], v[56:59]
    s_waitcnt lgkmcnt(2)
    ds_read_b64_tr_b16 v[16:17], v3 offset:24576
    ds_read_b64_tr_b16 v[18:19], v3 offset:25088
    v_mfma_f32_16x16x32_bf16 v[60:63], v[24:27], a[12:15], 0
    s_mul_i32 s20, s60, 589824
    v_rcp_f32 v210, v210
    v_mfma_f32_16x16x32_bf16 v[60:63], v[28:31], a[28:31], v[60:63]
    s_add_u32 s20, s20, s26
    v_mul_f32 v74, v74, v210
    v_exp_f32 v213, v213
    v_mfma_f32_16x16x32_bf16 v[52:55], v[28:31], a[24:27], 0
    v_rcp_f32 v211, v211
    v_mfma_f32_16x16x32_bf16 v[52:55], v[24:27], a[8:11], v[52:55]
    buffer_load_dwordx4 v6, s[96:99], s20 offen lds
    v_mul_f32 v75, v75, v211
    v_mfma_f32_16x16x32_bf16 v[44:47], v[24:27], a[4:7], 0
    s_add_u32 m0, s19, 0
    v_exp_f32 v214, v214
    v_mul_f32 v215, s40, v79
    v_mfma_f32_16x16x32_bf16 v[44:47], v[28:31], a[20:23], v[44:47]
    s_add_u32 s20, s20, 294912
    v_rcp_f32 v212, v212
    v_mfma_f32_16x16x32_bf16 v[36:39], v[28:31], a[16:19], 0
    ds_read_b64_tr_b16 v[28:29], v4 offset:28672
    ds_read_b64_tr_b16 v[30:31], v4 offset:29184
    v_mfma_f32_16x16x32_bf16 v[36:39], v[24:27], a[0:3], v[36:39]
    s_waitcnt lgkmcnt(2)
    ds_read_b64_tr_b16 v[24:25], v4 offset:24576
    ds_read_b64_tr_b16 v[26:27], v4 offset:25088
    v_add_f32 v213, 1.0, v213
    v_mfma_f32_16x16x32_bf16 v[160:163], v[16:19], a[0:3], 0
    buffer_load_dwordx4 v6, s[96:99], s20 offen lds
    v_mul_f32 v76, v76, v212
    v_mfma_f32_16x16x32_bf16 v[160:163], v[20:23], a[16:19], v[160:163]
    s_add_u32 m0, s19, 4096
    v_exp_f32 v215, v215
    v_mfma_f32_16x16x32_bf16 v[168:171], v[20:23], a[20:23], 0
    s_mul_i32 s20, s61, 589824
    v_rcp_f32 v213, v213
    v_add_f32 v214, 1.0, v214
    v_mfma_f32_16x16x32_bf16 v[168:171], v[16:19], a[4:7], v[168:171]
    s_add_u32 s20, s20, s26
    v_mul_f32 v77, v77, v213
    v_add_f32 v215, 1.0, v215
    v_mfma_f32_16x16x32_bf16 v[176:179], v[16:19], a[8:11], 0
    v_rcp_f32 v214, v214
    v_mfma_f32_16x16x32_bf16 v[176:179], v[20:23], a[24:27], v[176:179]
    v_mul_f32 v78, v78, v214
    v_rcp_f32 v215, v215
    v_mfma_f32_16x16x32_bf16 v[184:187], v[20:23], a[28:31], 0
    ds_read_b64_tr_b16 v[20:21], v1 offset:36864
    ds_read_b64_tr_b16 v[22:23], v1 offset:37376
    v_mfma_f32_16x16x32_bf16 v[184:187], v[16:19], a[12:15], v[184:187]
    s_waitcnt lgkmcnt(2)
    ds_read_b64_tr_b16 v[16:17], v1 offset:32768
    ds_read_b64_tr_b16 v[18:19], v1 offset:33280
    v_mfma_f32_16x16x32_bf16 v[188:191], v[24:27], a[12:15], 0
    buffer_load_dwordx4 v6, s[96:99], s20 offen lds
    v_mul_f32 v79, v79, v215
    v_mul_f32 v208, s40, v80
    v_mfma_f32_16x16x32_bf16 v[188:191], v[28:31], a[28:31], v[188:191]
    s_add_u32 m0, s19, 8192
    v_exp_f32 v208, v208
    v_mfma_f32_16x16x32_bf16 v[180:183], v[28:31], a[24:27], 0
    s_add_u32 s20, s20, 294912
    v_mul_f32 v209, s40, v81
    v_mul_f32 v210, s40, v82
    v_mfma_f32_16x16x32_bf16 v[180:183], v[24:27], a[8:11], v[180:183]
    s_waitcnt vmcnt(14)
    buffer_store_dword v15, off, s[8:11], s46 sc1
    v_exp_f32 v209, v209
    v_mfma_f32_16x16x32_bf16 v[172:175], v[24:27], a[4:7], 0
    buffer_load_dwordx4 v6, s[96:99], s20 offen lds
    v_add_f32 v208, 1.0, v208
    v_mfma_f32_16x16x32_bf16 v[172:175], v[28:31], a[20:23], v[172:175]
    s_add_u32 m0, s19, 12288
    v_exp_f32 v210, v210
    v_mfma_f32_16x16x32_bf16 v[164:167], v[28:31], a[16:19], 0
    s_mul_i32 s20, s62, 589824
    ds_read_b64_tr_b16 v[28:29], v2 offset:36864
    ds_read_b64_tr_b16 v[30:31], v2 offset:37376
    v_mul_f32 v211, s40, v83
    v_mfma_f32_16x16x32_bf16 v[164:167], v[24:27], a[0:3], v[164:167]
    s_waitcnt lgkmcnt(2)
    ds_read_b64_tr_b16 v[24:25], v2 offset:32768
    ds_read_b64_tr_b16 v[26:27], v2 offset:33280
    v_mfma_f32_16x16x32_bf16 v[32:35], v[16:19], a[32:35], v[32:35]
    s_add_u32 s20, s20, s26
    v_rcp_f32 v208, v208
    v_mfma_f32_16x16x32_bf16 v[32:35], v[20:23], a[48:51], v[32:35]
    v_add_f32 v209, 1.0, v209
    v_mul_f32 v80, v80, v208
    v_mul_f32 v212, s40, v84
    v_mfma_f32_16x16x32_bf16 v[40:43], v[20:23], a[52:55], v[40:43]
    buffer_load_dwordx4 v6, s[96:99], s20 offen lds
    v_add_f32 v210, 1.0, v210
    v_mfma_f32_16x16x32_bf16 v[40:43], v[16:19], a[36:39], v[40:43]
    v_exp_f32 v211, v211
    v_mfma_f32_16x16x32_bf16 v[48:51], v[16:19], a[40:43], v[48:51]
    v_rcp_f32 v209, v209
    s_nop 0
    v_mul_f32 v81, v81, v209
    v_mfma_f32_16x16x32_bf16 v[48:51], v[20:23], a[56:59], v[48:51]
    v_exp_f32 v212, v212
    v_mfma_f32_16x16x32_bf16 v[56:59], v[20:23], a[60:63], v[56:59]
    ds_read_b64_tr_b16 v[20:21], v3 offset:36864
    ds_read_b64_tr_b16 v[22:23], v3 offset:37376
    v_mfma_f32_16x16x32_bf16 v[56:59], v[16:19], a[44:47], v[56:59]
    s_waitcnt lgkmcnt(2)
    ds_read_b64_tr_b16 v[16:17], v3 offset:32768
    ds_read_b64_tr_b16 v[18:19], v3 offset:33280
    buffer_load_dwordx4 a[0:3], v5, s[8:11], s65 offen offset:0 sc1
    v_mfma_f32_16x16x32_bf16 v[60:63], v[24:27], a[44:47], v[60:63]
    v_mul_f32 v213, s40, v85
    v_add_f32 v211, 1.0, v211
    v_mfma_f32_16x16x32_bf16 v[60:63], v[28:31], a[60:63], v[60:63]
    v_rcp_f32 v210, v210
    v_mfma_f32_16x16x32_bf16 v[52:55], v[28:31], a[56:59], v[52:55]
    v_mul_f32 v82, v82, v210
    v_exp_f32 v213, v213
    v_mfma_f32_16x16x32_bf16 v[52:55], v[24:27], a[40:43], v[52:55]
    v_mul_f32 v214, s40, v86
    v_add_f32 v212, 1.0, v212
    v_mfma_f32_16x16x32_bf16 v[44:47], v[24:27], a[36:39], v[44:47]
    v_rcp_f32 v211, v211
    v_mfma_f32_16x16x32_bf16 v[44:47], v[28:31], a[52:55], v[44:47]
    buffer_load_dwordx4 a[4:7], v5, s[8:11], s65 offen offset:1024 sc1
    v_mul_f32 v83, v83, v211
    v_mul_f32 v215, s40, v87
    v_mfma_f32_16x16x32_bf16 v[36:39], v[28:31], a[48:51], v[36:39]
    ds_read_b64_tr_b16 v[28:29], v4 offset:36864
    ds_read_b64_tr_b16 v[30:31], v4 offset:37376
    v_mfma_f32_16x16x32_bf16 v[36:39], v[24:27], a[32:35], v[36:39]
    s_waitcnt lgkmcnt(2)
    ds_read_b64_tr_b16 v[24:25], v4 offset:32768
    ds_read_b64_tr_b16 v[26:27], v4 offset:33280
    v_mfma_f32_16x16x32_bf16 v[160:163], v[16:19], a[32:35], v[160:163]
    v_exp_f32 v214, v214
    v_add_f32 v213, 1.0, v213
    v_mfma_f32_16x16x32_bf16 v[160:163], v[20:23], a[48:51], v[160:163]
    v_rcp_f32 v212, v212
    v_mfma_f32_16x16x32_bf16 v[168:171], v[20:23], a[52:55], v[168:171]
    buffer_load_dwordx4 a[8:11], v5, s[8:11], s65 offen offset:2048 sc1
    v_mul_f32 v84, v84, v212
    v_mfma_f32_16x16x32_bf16 v[168:171], v[16:19], a[36:39], v[168:171]
    v_exp_f32 v215, v215
    v_mul_f32 v208, s40, v88
    v_mfma_f32_16x16x32_bf16 v[176:179], v[16:19], a[40:43], v[176:179]
    v_rcp_f32 v213, v213
    v_mfma_f32_16x16x32_bf16 v[176:179], v[20:23], a[56:59], v[176:179]
    v_add_f32 v214, 1.0, v214
    v_mul_f32 v85, v85, v213
    v_mfma_f32_16x16x32_bf16 v[184:187], v[20:23], a[60:63], v[184:187]
    s_waitcnt vmcnt(9)
    s_barrier
    ds_read_b64_tr_b16 v[20:21], v1 offset:45056
    ds_read_b64_tr_b16 v[22:23], v1 offset:45568
    v_mfma_f32_16x16x32_bf16 v[184:187], v[16:19], a[44:47], v[184:187]
    s_waitcnt lgkmcnt(2)
    ds_read_b64_tr_b16 v[16:17], v1 offset:40960
    ds_read_b64_tr_b16 v[18:19], v1 offset:41472
    v_mfma_f32_16x16x32_bf16 v[188:191], v[24:27], a[44:47], v[188:191]
    buffer_load_dwordx4 a[12:15], v5, s[8:11], s65 offen offset:3072 sc1
    v_mul_f32 v209, s40, v89
    v_mfma_f32_16x16x32_bf16 v[188:191], v[28:31], a[60:63], v[188:191]
    s_add_u32 m0, s19, 16384
    v_exp_f32 v208, v208
    v_add_f32 v215, 1.0, v215
    v_mfma_f32_16x16x32_bf16 v[180:183], v[28:31], a[56:59], v[180:183]
    s_add_u32 s20, s20, 294912
    v_rcp_f32 v214, v214
    v_mfma_f32_16x16x32_bf16 v[180:183], v[24:27], a[40:43], v[180:183]
    v_mul_f32 v86, v86, v214
    v_mul_f32 v210, s40, v90
    v_mfma_f32_16x16x32_bf16 v[172:175], v[24:27], a[36:39], v[172:175]
    v_exp_f32 v209, v209
    v_add_f32 v208, 1.0, v208
    v_mfma_f32_16x16x32_bf16 v[172:175], v[28:31], a[52:55], v[172:175]
    buffer_load_dwordx4 v6, s[96:99], s20 offen lds
    v_mul_f32 v211, s40, v91
    v_mfma_f32_16x16x32_bf16 v[164:167], v[28:31], a[48:51], v[164:167]
    s_add_u32 m0, s19, 20480
    ds_read_b64_tr_b16 v[28:29], v2 offset:45056
    ds_read_b64_tr_b16 v[30:31], v2 offset:45568
    v_mfma_f32_16x16x32_bf16 v[164:167], v[24:27], a[32:35], v[164:167]
    s_waitcnt lgkmcnt(2)
    ds_read_b64_tr_b16 v[24:25], v2 offset:40960
    ds_read_b64_tr_b16 v[26:27], v2 offset:41472
    v_add_f32 v209, 1.0, v209
    v_mfma_f32_16x16x32_bf16 v[32:35], v[16:19], a[64:67], v[32:35]
    s_mul_i32 s20, s63, 589824
    v_rcp_f32 v215, v215
    v_mfma_f32_16x16x32_bf16 v[32:35], v[20:23], a[80:83], v[32:35]
    s_add_u32 s20, s20, s26
    v_mul_f32 v87, v87, v215
    v_mul_f32 v212, s40, v92
    v_mfma_f32_16x16x32_bf16 v[40:43], v[20:23], a[84:87], v[40:43]
    v_exp_f32 v210, v210
    s_nop 0
    v_add_f32 v210, 1.0, v210
    v_mfma_f32_16x16x32_bf16 v[40:43], v[16:19], a[68:71], v[40:43]
    buffer_load_dwordx4 v6, s[96:99], s20 offen lds
    v_mul_f32 v213, s40, v93
    v_mfma_f32_16x16x32_bf16 v[48:51], v[16:19], a[72:75], v[48:51]
    s_add_u32 m0, s19, 24576
    v_rcp_f32 v208, v208
    v_mfma_f32_16x16x32_bf16 v[48:51], v[20:23], a[88:91], v[48:51]
    s_add_u32 s20, s20, 294912
    v_mul_f32 v88, v88, v208
    v_exp_f32 v211, v211
    v_mfma_f32_16x16x32_bf16 v[56:59], v[20:23], a[92:95], v[56:59]
    ds_read_b64_tr_b16 v[20:21], v3 offset:45056
    ds_read_b64_tr_b16 v[22:23], v3 offset:45568
    v_mfma_f32_16x16x32_bf16 v[56:59], v[16:19], a[76:79], v[56:59]
    s_waitcnt lgkmcnt(2)
    ds_read_b64_tr_b16 v[16:17], v3 offset:40960
    ds_read_b64_tr_b16 v[18:19], v3 offset:41472
    v_mfma_f32_16x16x32_bf16 v[60:63], v[24:27], a[76:79], v[60:63]
    buffer_load_dwordx4 v6, s[96:99], s20 offen lds
    v_rcp_f32 v209, v209
    v_mfma_f32_16x16x32_bf16 v[60:63], v[28:31], a[92:95], v[60:63]
    s_add_u32 m0, s19, 28672
    v_mul_f32 v89, v89, v209
    v_add_f32 v211, 1.0, v211
    v_mfma_f32_16x16x32_bf16 v[52:55], v[28:31], a[88:91], v[52:55]
    s_mul_i32 s20, s64, 589824
    v_exp_f32 v212, v212
    v_mfma_f32_16x16x32_bf16 v[52:55], v[24:27], a[72:75], v[52:55]
    s_add_u32 s20, s20, s26
    v_rcp_f32 v210, v210
    s_nop 0
    v_mul_f32 v90, v90, v210
    v_mfma_f32_16x16x32_bf16 v[44:47], v[24:27], a[68:71], v[44:47]
    v_exp_f32 v213, v213
    v_mfma_f32_16x16x32_bf16 v[44:47], v[28:31], a[84:87], v[44:47]
    s_add_u32 s51, s44, 2
    buffer_load_dword v9, v8, s[8:11], s67 offen sc1
    v_mul_f32 v214, s40, v94
    v_mfma_f32_16x16x32_bf16 v[36:39], v[28:31], a[80:83], v[36:39]
    ds_read_b64_tr_b16 v[28:29], v4 offset:45056
    ds_read_b64_tr_b16 v[30:31], v4 offset:45568
    buffer_load_dwordx4 v6, s[96:99], s20 offen lds
    v_mfma_f32_16x16x32_bf16 v[36:39], v[24:27], a[64:67], v[36:39]
    s_waitcnt lgkmcnt(2)
    ds_read_b64_tr_b16 v[24:25], v4 offset:40960
    ds_read_b64_tr_b16 v[26:27], v4 offset:41472
    v_mfma_f32_16x16x32_bf16 v[160:163], v[16:19], a[64:67], v[160:163]
    s_add_u32 s65, s65, 4096
    v_rcp_f32 v211, v211
    v_mfma_f32_16x16x32_bf16 v[160:163], v[20:23], a[80:83], v[160:163]
    v_add_f32 v212, 1.0, v212
    v_mul_f32 v91, v91, v211
    v_mul_f32 v215, s40, v95
    v_mfma_f32_16x16x32_bf16 v[168:171], v[20:23], a[84:87], v[168:171]
    v_exp_f32 v214, v214
    v_mfma_f32_16x16x32_bf16 v[168:171], v[16:19], a[68:71], v[168:171]
    buffer_load_dwordx4 a[16:19], v5, s[8:11], s65 offen offset:0 sc1
    v_add_f32 v213, 1.0, v213
    v_mfma_f32_16x16x32_bf16 v[176:179], v[16:19], a[72:75], v[176:179]
    v_rcp_f32 v212, v212
    s_nop 0
    v_mul_f32 v92, v92, v212
    v_mfma_f32_16x16x32_bf16 v[176:179], v[20:23], a[88:91], v[176:179]
    v_exp_f32 v215, v215
    v_mfma_f32_16x16x32_bf16 v[184:187], v[20:23], a[92:95], v[184:187]
    ds_read_b64_tr_b16 v[20:21], v1 offset:53248
    ds_read_b64_tr_b16 v[22:23], v1 offset:53760
    v_mfma_f32_16x16x32_bf16 v[184:187], v[16:19], a[76:79], v[184:187]
    s_waitcnt lgkmcnt(2)
    ds_read_b64_tr_b16 v[16:17], v1 offset:49152
    ds_read_b64_tr_b16 v[18:19], v1 offset:49664
    v_add_f32 v214, 1.0, v214
    v_mfma_f32_16x16x32_bf16 v[188:191], v[24:27], a[76:79], v[188:191]
    v_rcp_f32 v213, v213
    v_mfma_f32_16x16x32_bf16 v[188:191], v[28:31], a[92:95], v[188:191]
    buffer_load_dwordx4 a[20:23], v5, s[8:11], s65 offen offset:1024 sc1
    v_mul_f32 v93, v93, v213
    v_mfma_f32_16x16x32_bf16 v[180:183], v[28:31], a[88:91], v[180:183]
    v_rcp_f32 v214, v214
    v_add_f32 v215, 1.0, v215
    v_mfma_f32_16x16x32_bf16 v[180:183], v[24:27], a[72:75], v[180:183]
    v_mul_f32 v94, v94, v214
    v_mfma_f32_16x16x32_bf16 v[172:175], v[24:27], a[68:71], v[172:175]
    v_rcp_f32 v215, v215
    v_mfma_f32_16x16x32_bf16 v[172:175], v[28:31], a[84:87], v[172:175]
    v_mul_f32 v95, v95, v215
    v_mul_f32 v208, s40, v96
    v_mul_f32 v209, s40, v97
    v_mfma_f32_16x16x32_bf16 v[164:167], v[28:31], a[80:83], v[164:167]
    ds_read_b64_tr_b16 v[28:29], v2 offset:53248
    ds_read_b64_tr_b16 v[30:31], v2 offset:53760
    v_mfma_f32_16x16x32_bf16 v[164:167], v[24:27], a[64:67], v[164:167]
    s_waitcnt lgkmcnt(2)
    ds_read_b64_tr_b16 v[24:25], v2 offset:49152
    ds_read_b64_tr_b16 v[26:27], v2 offset:49664
    v_mfma_f32_16x16x32_bf16 v[32:35], v[16:19], a[96:99], v[32:35]
    buffer_load_dwordx4 a[24:27], v5, s[8:11], s65 offen offset:2048 sc1
    v_exp_f32 v208, v208
    v_mfma_f32_16x16x32_bf16 v[32:35], v[20:23], a[112:115], v[32:35]
    v_exp_f32 v209, v209
    v_mfma_f32_16x16x32_bf16 v[40:43], v[20:23], a[116:119], v[40:43]
    v_mul_f32 v210, s40, v98
    v_add_f32 v208, 1.0, v208
    v_mfma_f32_16x16x32_bf16 v[40:43], v[16:19], a[100:103], v[40:43]
    v_exp_f32 v210, v210
    v_mul_f32 v211, s40, v99
    v_mfma_f32_16x16x32_bf16 v[48:51], v[16:19], a[104:107], v[48:51]
    buffer_load_dwordx4 a[28:31], v5, s[8:11], s65 offen offset:3072 sc1
    v_add_f32 v209, 1.0, v209
    v_mfma_f32_16x16x32_bf16 v[48:51], v[20:23], a[120:123], v[48:51]
    s_add_u32 s65, s65, 4096
    v_rcp_f32 v208, v208
    v_mfma_f32_16x16x32_bf16 v[56:59], v[20:23], a[124:127], v[56:59]
    ds_read_b64_tr_b16 v[20:21], v3 offset:53248
    ds_read_b64_tr_b16 v[22:23], v3 offset:53760
    v_mul_f32 v96, v96, v208
    v_mfma_f32_16x16x32_bf16 v[56:59], v[16:19], a[108:111], v[56:59]
    s_waitcnt lgkmcnt(2)
    ds_read_b64_tr_b16 v[16:17], v3 offset:49152
    ds_read_b64_tr_b16 v[18:19], v3 offset:49664
    v_mfma_f32_16x16x32_bf16 v[60:63], v[24:27], a[108:111], v[60:63]
    v_exp_f32 v211, v211
    v_mfma_f32_16x16x32_bf16 v[60:63], v[28:31], a[124:127], v[60:63]
    v_mul_f32 v212, s40, v100
    v_rcp_f32 v209, v209
    v_mfma_f32_16x16x32_bf16 v[52:55], v[28:31], a[120:123], v[52:55]
    buffer_load_dwordx4 a[32:35], v5, s[8:11], s65 offen offset:0 sc1
    v_add_f32 v210, 1.0, v210
    v_mfma_f32_16x16x32_bf16 v[52:55], v[24:27], a[104:107], v[52:55]
    v_mul_f32 v97, v97, v209
    v_mul_f32 v213, s40, v101
    v_mfma_f32_16x16x32_bf16 v[44:47], v[24:27], a[100:103], v[44:47]
    v_exp_f32 v212, v212
    v_add_f32 v211, 1.0, v211
    v_mfma_f32_16x16x32_bf16 v[44:47], v[28:31], a[116:119], v[44:47]
    v_rcp_f32 v210, v210
    v_mfma_f32_16x16x32_bf16 v[36:39], v[28:31], a[112:115], v[36:39]
    ds_read_b64_tr_b16 v[28:29], v4 offset:53248
    ds_read_b64_tr_b16 v[30:31], v4 offset:53760
    v_mfma_f32_16x16x32_bf16 v[36:39], v[24:27], a[96:99], v[36:39]
    s_waitcnt lgkmcnt(2)
    ds_read_b64_tr_b16 v[24:25], v4 offset:49152
    ds_read_b64_tr_b16 v[26:27], v4 offset:49664
    buffer_load_dwordx4 a[36:39], v5, s[8:11], s65 offen offset:1024 sc1
    v_mfma_f32_16x16x32_bf16 v[160:163], v[16:19], a[96:99], v[160:163]
    v_mul_f32 v98, v98, v210
    v_mul_f32 v214, s40, v102
    v_mfma_f32_16x16x32_bf16 v[160:163], v[20:23], a[112:115], v[160:163]
    v_exp_f32 v213, v213
    v_mfma_f32_16x16x32_bf16 v[168:171], v[20:23], a[116:119], v[168:171]
    v_rcp_f32 v211, v211
    v_add_f32 v212, 1.0, v212
    v_mfma_f32_16x16x32_bf16 v[168:171], v[16:19], a[100:103], v[168:171]
    v_mul_f32 v99, v99, v211
    v_mul_f32 v215, s40, v103
    v_mfma_f32_16x16x32_bf16 v[176:179], v[16:19], a[104:107], v[176:179]
    v_exp_f32 v214, v214
    v_mfma_f32_16x16x32_bf16 v[176:179], v[20:23], a[120:123], v[176:179]
    buffer_load_dwordx4 a[40:43], v5, s[8:11], s65 offen offset:2048 sc1
    v_rcp_f32 v212, v212
    v_mfma_f32_16x16x32_bf16 v[184:187], v[20:23], a[124:127], v[184:187]
    s_waitcnt vmcnt(17)
    s_barrier
    ds_read_b64_tr_b16 v[20:21], v1 offset:0
    ds_read_b64_tr_b16 v[22:23], v1 offset:512
    v_mfma_f32_16x16x32_bf16 v[184:187], v[16:19], a[108:111], v[184:187]
    s_waitcnt lgkmcnt(2)
    ds_read_b64_tr_b16 v[16:17], v1 offset:57344
    ds_read_b64_tr_b16 v[18:19], v1 offset:57856
    v_mfma_f32_16x16x32_bf16 v[188:191], v[24:27], a[108:111], v[188:191]
    s_add_u32 m0, s19, 32768
    v_add_f32 v213, 1.0, v213
    v_mul_f32 v100, v100, v212
    v_mul_f32 v208, s40, v104
    v_mfma_f32_16x16x32_bf16 v[188:191], v[28:31], a[124:127], v[188:191]
    s_add_u32 s20, s20, 294912
    v_exp_f32 v215, v215
    v_mfma_f32_16x16x32_bf16 v[180:183], v[28:31], a[120:123], v[180:183]
    buffer_load_dwordx4 v6, s[96:99], s20 offen lds
    v_add_f32 v214, 1.0, v214
    v_mfma_f32_16x16x32_bf16 v[180:183], v[24:27], a[104:107], v[180:183]
    v_rcp_f32 v213, v213
    s_nop 0
    v_mul_f32 v101, v101, v213
    v_mfma_f32_16x16x32_bf16 v[172:175], v[24:27], a[100:103], v[172:175]
    v_exp_f32 v208, v208
    v_mfma_f32_16x16x32_bf16 v[172:175], v[28:31], a[116:119], v[172:175]
    v_mul_f32 v209, s40, v105
    v_add_f32 v215, 1.0, v215
    v_mfma_f32_16x16x32_bf16 v[164:167], v[28:31], a[112:115], v[164:167]
    ds_read_b64_tr_b16 v[28:29], v2 offset:0
    ds_read_b64_tr_b16 v[30:31], v2 offset:512
    v_mul_f32 v210, s40, v106
    v_mfma_f32_16x16x32_bf16 v[164:167], v[24:27], a[96:99], v[164:167]
    s_waitcnt lgkmcnt(2)
    ds_read_b64_tr_b16 v[24:25], v2 offset:57344
    ds_read_b64_tr_b16 v[26:27], v2 offset:57856
    v_mfma_f32_16x16x32_bf16 v[32:35], v[16:19], a[128:131], v[32:35]
    buffer_load_dwordx4 a[44:47], v5, s[8:11], s65 offen offset:3072 sc1
    v_add_f32 v208, 1.0, v208
    v_mfma_f32_16x16x32_bf16 v[32:35], v[20:23], a[144:147], v[32:35]
    s_add_u32 s65, s65, 4096
    v_rcp_f32 v214, v214
    s_nop 0
    v_mul_f32 v102, v102, v214
    v_mfma_f32_16x16x32_bf16 v[40:43], v[20:23], a[148:151], v[40:43]
    v_exp_f32 v209, v209
    v_mfma_f32_16x16x32_bf16 v[40:43], v[16:19], a[132:135], v[40:43]
    v_rcp_f32 v215, v215
    v_mfma_f32_16x16x32_bf16 v[48:51], v[16:19], a[136:139], v[48:51]
    v_mul_f32 v103, v103, v215
    v_exp_f32 v210, v210
    v_mfma_f32_16x16x32_bf16 v[48:51], v[20:23], a[152:155], v[48:51]
    buffer_load_dwordx4 a[48:51], v5, s[8:11], s65 offen offset:0 sc1
    v_mul_f32 v211, s40, v107
    v_mfma_f32_16x16x32_bf16 v[56:59], v[20:23], a[156:159], v[56:59]
    ds_read_b64_tr_b16 v[20:21], v1 offset:8192
    ds_read_b64_tr_b16 v[22:23], v1 offset:8704
    v_mfma_f32_16x16x32_bf16 v[56:59], v[16:19], a[140:143], v[56:59]
    s_waitcnt lgkmcnt(2)
    ds_read_b64_tr_b16 v[16:17], v1 offset:4096
    ds_read_b64_tr_b16 v[18:19], v1 offset:4608
    v_add_f32 v209, 1.0, v209
    v_mfma_f32_16x16x32_bf16 v[60:63], v[24:27], a[140:143], v[60:63]
    v_rcp_f32 v208, v208
    v_mfma_f32_16x16x32_bf16 v[60:63], v[28:31], a[156:159], v[60:63]
    v_mul_f32 v104, v104, v208
    v_mul_f32 v212, s40, v108
    v_mfma_f32_16x16x32_bf16 v[52:55], v[28:31], a[152:155], v[52:55]
    v_exp_f32 v211, v211
    v_add_f32 v210, 1.0, v210
    v_mfma_f32_16x16x32_bf16 v[52:55], v[24:27], a[136:139], v[52:55]
    buffer_load_dwordx4 a[52:55], v5, s[8:11], s65 offen offset:1024 sc1
    v_mul_f32 v213, s40, v109
    v_mfma_f32_16x16x32_bf16 v[44:47], v[24:27], a[132:135], v[44:47]
    v_rcp_f32 v209, v209
    v_mfma_f32_16x16x32_bf16 v[44:47], v[28:31], a[148:151], v[44:47]
    v_mul_f32 v105, v105, v209
    v_exp_f32 v212, v212
    v_mfma_f32_16x16x32_bf16 v[36:39], v[28:31], a[144:147], v[36:39]
    ds_read_b64_tr_b16 v[28:29], v2 offset:8192
    ds_read_b64_tr_b16 v[30:31], v2 offset:8704
    v_mfma_f32_16x16x32_bf16 v[36:39], v[24:27], a[128:131], v[36:39]
    s_waitcnt lgkmcnt(2)
    ds_read_b64_tr_b16 v[24:25], v2 offset:4096
    ds_read_b64_tr_b16 v[26:27], v2 offset:4608
    v_mfma_f32_16x16x32_bf16 v[32:35], v[16:19], a[160:163], v[32:35]
    buffer_load_dwordx4 a[56:59], v5, s[8:11], s65 offen offset:2048 sc1
    v_rcp_f32 v210, v210
    v_mfma_f32_16x16x32_bf16 v[32:35], v[20:23], a[176:179], v[32:35]
    v_add_f32 v211, 1.0, v211
    v_mul_f32 v106, v106, v210
    v_mfma_f32_16x16x32_bf16 v[40:43], v[20:23], a[180:183], v[40:43]
    v_exp_f32 v213, v213
    v_mfma_f32_16x16x32_bf16 v[40:43], v[16:19], a[164:167], v[40:43]
    v_mul_f32 v214, s40, v110
    v_rcp_f32 v211, v211
    v_mfma_f32_16x16x32_bf16 v[48:51], v[16:19], a[168:171], v[48:51]
    v_add_f32 v212, 1.0, v212
    v_mul_f32 v107, v107, v211
    v_mfma_f32_16x16x32_bf16 v[48:51], v[20:23], a[184:187], v[48:51]
    v_exp_f32 v214, v214
    v_mfma_f32_16x16x32_bf16 v[56:59], v[20:23], a[188:191], v[56:59]
    s_waitcnt vmcnt(14)
    s_barrier
    ds_read_b64_tr_b16 v[20:21], v1 offset:16384
    ds_read_b64_tr_b16 v[22:23], v1 offset:16896
    v_mfma_f32_16x16x32_bf16 v[56:59], v[16:19], a[172:175], v[56:59]
    s_waitcnt lgkmcnt(2)
    ds_read_b64_tr_b16 v[16:17], v1 offset:12288
    ds_read_b64_tr_b16 v[18:19], v1 offset:12800
    v_mfma_f32_16x16x32_bf16 v[60:63], v[24:27], a[172:175], v[60:63]
    buffer_load_dwordx4 a[60:63], v5, s[8:11], s65 offen offset:3072 sc1
    v_mul_f32 v215, s40, v111
    v_mfma_f32_16x16x32_bf16 v[60:63], v[28:31], a[188:191], v[60:63]
    s_waitcnt vmcnt(14)
    v_subrev_u32 v9, s51, v9
    v_cmp_le_u32 vcc, 6, v9
    s_nop 0
    s_cbranch_vccnz LS_h1
LB_h1:
    v_mfma_f32_16x16x32_bf16 v[52:55], v[28:31], a[184:187], v[52:55]
    s_add_u32 s65, s65, 4096
    v_rcp_f32 v212, v212
    v_mfma_f32_16x16x32_bf16 v[52:55], v[24:27], a[168:171], v[52:55]
    v_add_f32 v213, 1.0, v213
    v_mul_f32 v108, v108, v212
    v_mfma_f32_16x16x32_bf16 v[44:47], v[24:27], a[164:167], v[44:47]
    buffer_load_dwordx4 a[64:67], v5, s[8:11], s65 offen offset:0 sc1
    v_exp_f32 v215, v215
    v_mfma_f32_16x16x32_bf16 v[44:47], v[28:31], a[180:183], v[44:47]
    v_rcp_f32 v213, v213
    v_mfma_f32_16x16x32_bf16 v[36:39], v[28:31], a[176:179], v[36:39]
    ds_read_b64_tr_b16 v[28:29], v2 offset:16384
    ds_read_b64_tr_b16 v[30:31], v2 offset:16896
    v_mfma_f32_16x16x32_bf16 v[36:39], v[24:27], a[160:163], v[36:39]
    s_waitcnt lgkmcnt(2)
    ds_read_b64_tr_b16 v[24:25], v2 offset:12288
    ds_read_b64_tr_b16 v[26:27], v2 offset:12800
    v_add_f32 v214, 1.0, v214
    v_mfma_f32_16x16x32_bf16 v[32:35], v[16:19], a[192:195], v[32:35]
    v_mul_f32 v109, v109, v213
    v_add_f32 v215, 1.0, v215
    v_mfma_f32_16x16x32_bf16 v[32:35], v[20:23], a[208:211], v[32:35]
    v_rcp_f32 v214, v214
    v_mfma_f32_16x16x32_bf16 v[40:43], v[20:23], a[212:215], v[40:43]
    buffer_load_dwordx4 a[68:71], v5, s[8:11], s65 offen offset:1024 sc1
    v_mul_f32 v110, v110, v214
    v_mul_f32 v208, s40, v112
    v_mfma_f32_16x16x32_bf16 v[40:43], v[16:19], a[196:199], v[40:43]
    v_rcp_f32 v215, v215
    v_mfma_f32_16x16x32_bf16 v[48:51], v[16:19], a[200:203], v[48:51]
    v_mul_f32 v111, v111, v215
    v_mul_f32 v209, s40, v113
    v_mfma_f32_16x16x32_bf16 v[48:51], v[20:23], a[216:219], v[48:51]
    v_exp_f32 v208, v208
    v_mul_f32 v210, s40, v114
    v_mfma_f32_16x16x32_bf16 v[56:59], v[20:23], a[220:223], v[56:59]
    ds_read_b64_tr_b16 v[20:21], v1 offset:24576
    ds_read_b64_tr_b16 v[22:23], v1 offset:25088
    v_mfma_f32_16x16x32_bf16 v[56:59], v[16:19], a[204:207], v[56:59]
    s_waitcnt lgkmcnt(2)
    ds_read_b64_tr_b16 v[16:17], v1 offset:20480
    ds_read_b64_tr_b16 v[18:19], v1 offset:20992
    v_mfma_f32_16x16x32_bf16 v[60:63], v[24:27], a[204:207], v[60:63]
    buffer_load_dwordx4 a[72:75], v5, s[8:11], s65 offen offset:2048 sc1
    v_exp_f32 v209, v209
    v_mfma_f32_16x16x32_bf16 v[60:63], v[28:31], a[220:223], v[60:63]
    v_add_f32 v208, 1.0, v208
    v_mul_f32 v211, s40, v115
    v_mfma_f32_16x16x32_bf16 v[52:55], v[28:31], a[216:219], v[52:55]
    v_exp_f32 v210, v210
    v_mfma_f32_16x16x32_bf16 v[52:55], v[24:27], a[200:203], v[52:55]
    v_rcp_f32 v208, v208
    v_add_f32 v209, 1.0, v209
    v_mfma_f32_16x16x32_bf16 v[44:47], v[24:27], a[196:199], v[44:47]
    v_mul_f32 v112, v112, v208
    v_mul_f32 v212, s40, v116
    v_mfma_f32_16x16x32_bf16 v[44:47], v[28:31], a[212:215], v[44:47]
    buffer_load_dwordx4 a[76:79], v5, s[8:11], s65 offen offset:3072 sc1
    v_add_f32 v210, 1.0, v210
    v_mfma_f32_16x16x32_bf16 v[36:39], v[28:31], a[208:211], v[36:39]
    s_add_u32 s65, s65, 4096
    ds_read_b64_tr_b16 v[28:29], v2 offset:24576
    ds_read_b64_tr_b16 v[30:31], v2 offset:25088
    v_mul_f32 v213, s40, v117
    v_mfma_f32_16x16x32_bf16 v[36:39], v[24:27], a[192:195], v[36:39]
    s_waitcnt lgkmcnt(2)
    ds_read_b64_tr_b16 v[24:25], v2 offset:20480
    ds_read_b64_tr_b16 v[26:27], v2 offset:20992
    v_mfma_f32_16x16x32_bf16 v[32:35], v[16:19], a[224:227], v[32:35]
    v_exp_f32 v211, v211
    v_mfma_f32_16x16x32_bf16 v[32:35], v[20:23], a[240:243], v[32:35]
    v_rcp_f32 v209, v209
    s_nop 0
    v_mul_f32 v113, v113, v209
    v_mfma_f32_16x16x32_bf16 v[40:43], v[20:23], a[244:247], v[40:43]
    buffer_load_dwordx4 a[80:83], v5, s[8:11], s65 offen offset:0 sc1
    v_add_f32 v211, 1.0, v211
    v_mfma_f32_16x16x32_bf16 v[40:43], v[16:19], a[228:231], v[40:43]
    v_exp_f32 v212, v212
    v_mfma_f32_16x16x32_bf16 v[48:51], v[16:19], a[232:235], v[48:51]
    v_rcp_f32 v210, v210
    s_nop 0
    v_mul_f32 v114, v114, v210
    v_mfma_f32_16x16x32_bf16 v[48:51], v[20:23], a[248:251], v[48:51]
    v_exp_f32 v213, v213
    v_mfma_f32_16x16x32_bf16 v[56:59], v[20:23], a[252:255], v[56:59]
    s_waitcnt vmcnt(10)
    s_barrier
    ds_read_b64_tr_b16 v[20:21], v1 offset:32768
    ds_read_b64_tr_b16 v[22:23], v1 offset:33280
    v_mfma_f32_16x16x32_bf16 v[56:59], v[16:19], a[236:239], v[56:59]
    s_waitcnt lgkmcnt(2)
    ds_read_b64_tr_b16 v[16:17], v1 offset:28672
    ds_read_b64_tr_b16 v[18:19], v1 offset:29184
    v_mul_f32 v214, s40, v118
    v_mfma_f32_16x16x32_bf16 v[60:63], v[24:27], a[236:239], v[60:63]
    buffer_load_dwordx4 a[84:87], v5, s[8:11], s65 offen offset:1024 sc1
    v_add_f32 v212, 1.0, v212
    v_mfma_f32_16x16x32_bf16 v[60:63], v[28:31], a[252:255], v[60:63]
    v_rcp_f32 v211, v211
    v_mfma_f32_16x16x32_bf16 v[52:55], v[28:31], a[248:251], v[52:55]
    v_mul_f32 v115, v115, v211
    v_exp_f32 v214, v214
    v_mfma_f32_16x16x32_bf16 v[52:55], v[24:27], a[232:235], v[52:55]
    v_mul_f32 v215, s40, v119
    v_add_f32 v213, 1.0, v213
    v_mfma_f32_16x16x32_bf16 v[44:47], v[24:27], a[228:231], v[44:47]
    v_rcp_f32 v212, v212
    v_mfma_f32_16x16x32_bf16 v[44:47], v[28:31], a[244:247], v[44:47]
    buffer_load_dwordx4 a[88:91], v5, s[8:11], s65 offen offset:2048 sc1
    v_mul_f32 v116, v116, v212
    v_mul_f32 v208, s40, v120
    v_mfma_f32_16x16x32_bf16 v[36:39], v[28:31], a[240:243], v[36:39]
    ds_read_b64_tr_b16 v[28:29], v2 offset:32768
    ds_read_b64_tr_b16 v[30:31], v2 offset:33280
    v_mfma_f32_16x16x32_bf16 v[36:39], v[24:27], a[224:227], v[36:39]
    s_waitcnt lgkmcnt(2)
    ds_read_b64_tr_b16 v[24:25], v2 offset:28672
    ds_read_b64_tr_b16 v[26:27], v2 offset:29184
    v_mfma_f32_16x16x32_bf16 v[32:35], v[16:19], v[224:227], v[32:35]
    v_exp_f32 v215, v215
    v_add_f32 v214, 1.0, v214
    v_mfma_f32_16x16x32_bf16 v[32:35], v[20:23], v[240:243], v[32:35]
    v_rcp_f32 v213, v213
    v_mfma_f32_16x16x32_bf16 v[40:43], v[20:23], v[244:247], v[40:43]
    v_mul_f32 v117, v117, v213
    v_mul_f32 v209, s40, v121
    v_mfma_f32_16x16x32_bf16 v[40:43], v[16:19], v[228:231], v[40:43]
    buffer_load_dwordx4 a[92:95], v5, s[8:11], s65 offen offset:3072 sc1
    v_exp_f32 v208, v208
    v_mfma_f32_16x16x32_bf16 v[48:51], v[16:19], v[232:235], v[48:51]
    s_add_u32 m0, s19, 77824
    v_rcp_f32 v214, v214
    v_mfma_f32_16x16x32_bf16 v[48:51], v[20:23], v[248:251], v[48:51]
    s_add_u32 s66, s66, 4096
    v_add_f32 v215, 1.0, v215
    v_mul_f32 v118, v118, v214
    v_mfma_f32_16x16x32_bf16 v[56:59], v[20:23], v[252:255], v[56:59]
    ds_read_b64_tr_b16 v[20:21], v3 offset:0
    ds_read_b64_tr_b16 v[22:23], v3 offset:512
    v_mul_f32 v210, s40, v122
    v_mfma_f32_16x16x32_bf16 v[56:59], v[16:19], v[236:239], v[56:59]
    s_waitcnt lgkmcnt(2)
    ds_read_b64_tr_b16 v[16:17], v3 offset:57344
    ds_read_b64_tr_b16 v[18:19], v3 offset:57856
    v_mfma_f32_16x16x32_bf16 v[60:63], v[24:27], v[236:239], v[60:63]
    buffer_load_dwordx4 v5, s[8:11], s66 offen sc1 lds
    v_add_f32 v208, 1.0, v208
    v_mfma_f32_16x16x32_bf16 v[60:63], v[28:31], v[252:255], v[60:63]
    s_add_u32 m0, s19, 81920
    v_exp_f32 v209, v209
    v_mul_f32 v211, s40, v123
    v_mfma_f32_16x16x32_bf16 v[52:55], v[28:31], v[248:251], v[52:55]
    s_add_u32 s66, s66, 4096
    v_rcp_f32 v215, v215
    v_mfma_f32_16x16x32_bf16 v[52:55], v[24:27], v[232:235], v[52:55]
    v_mul_f32 v119, v119, v215
    v_add_f32 v209, 1.0, v209
    v_mfma_f32_16x16x32_bf16 v[44:47], v[24:27], v[228:231], v[44:47]
    v_exp_f32 v210, v210
    v_mul_f32 v212, s40, v124
    v_mfma_f32_16x16x32_bf16 v[44:47], v[28:31], v[244:247], v[44:47]
    v_rcp_f32 v208, v208
    v_mfma_f32_16x16x32_bf16 v[36:39], v[28:31], v[240:243], v[36:39]
    ds_read_b64_tr_b16 v[28:29], v4 offset:0
    ds_read_b64_tr_b16 v[30:31], v4 offset:512
    v_mfma_f32_16x16x32_bf16 v[36:39], v[24:27], v[224:227], v[36:39]
    s_waitcnt lgkmcnt(2)
    ds_read_b64_tr_b16 v[24:25], v4 offset:57344
    ds_read_b64_tr_b16 v[26:27], v4 offset:57856
    buffer_load_dwordx4 v5, s[8:11], s66 offen sc1 lds
    v_mfma_f32_16x16x32_bf16 v[160:163], v[16:19], a[128:131], v[160:163]
    s_add_u32 m0, s19, 86016
    v_mul_f32 v120, v120, v208
    v_add_f32 v210, 1.0, v210
    v_mfma_f32_16x16x32_bf16 v[160:163], v[20:23], a[144:147], v[160:163]
    s_add_u32 s66, s66, 4096
    v_exp_f32 v211, v211
    v_mfma_f32_16x16x32_bf16 v[168:171], v[20:23], a[148:151], v[168:171]
    v_rcp_f32 v209, v209
    s_nop 0
    v_mul_f32 v121, v121, v209
    v_mfma_f32_16x16x32_bf16 v[168:171], v[16:19], a[132:135], v[168:171]
    buffer_load_dwordx4 v5, s[8:11], s66 offen sc1 lds
    v_mul_f32 v213, s40, v125
    v_mfma_f32_16x16x32_bf16 v[176:179], v[16:19], a[136:139], v[176:179]
    s_add_u32 s65, s65, 4096
    v_exp_f32 v212, v212
    v_mfma_f32_16x16x32_bf16 v[176:179], v[20:23], a[152:155], v[176:179]
    v_rcp_f32 v210, v210
    v_add_f32 v211, 1.0, v211
    v_mfma_f32_16x16x32_bf16 v[184:187], v[20:23], a[156:159], v[184:187]
    ds_read_b64_tr_b16 v[20:21], v3 offset:8192
    ds_read_b64_tr_b16 v[22:23], v3 offset:8704
    v_mfma_f32_16x16x32_bf16 v[184:187], v[16:19], a[140:143], v[184:187]
    s_waitcnt lgkmcnt(2)
    ds_read_b64_tr_b16 v[16:17], v3 offset:4096
    ds_read_b64_tr_b16 v[18:19], v3 offset:4608
    v_mfma_f32_16x16x32_bf16 v[188:191], v[24:27], a[140:143], v[188:191]
    v_mul_f32 v122, v122, v210
    v_exp_f32 v213, v213
    v_mfma_f32_16x16x32_bf16 v[188:191], v[28:31], a[156:159], v[188:191]
    buffer_load_dwordx4 a[96:99], v5, s[8:11], s65 offen offset:0 sc1
    v_mul_f32 v214, s40, v126
    v_mfma_f32_16x16x32_bf16 v[180:183], v[28:31], a[152:155], v[180:183]
    v_rcp_f32 v211, v211
    v_mfma_f32_16x16x32_bf16 v[180:183], v[24:27], a[136:139], v[180:183]
    v_add_f32 v212, 1.0, v212
    v_mul_f32 v123, v123, v211
    v_mul_f32 v215, s40, v127
    v_mfma_f32_16x16x32_bf16 v[172:175], v[24:27], a[132:135], v[172:175]
    v_exp_f32 v214, v214
    v_mfma_f32_16x16x32_bf16 v[172:175], v[28:31], a[148:151], v[172:175]
    v_rcp_f32 v212, v212
    v_mfma_f32_16x16x32_bf16 v[164:167], v[28:31], a[144:147], v[164:167]
    ds_read_b64_tr_b16 v[28:29], v4 offset:8192
    ds_read_b64_tr_b16 v[30:31], v4 offset:8704
    buffer_load_dwordx4 a[100:103], v5, s[8:11], s65 offen offset:1024 sc1
    v_mfma_f32_16x16x32_bf16 v[164:167], v[24:27], a[128:131], v[164:167]
    s_waitcnt lgkmcnt(2)
    ds_read_b64_tr_b16 v[24:25], v4 offset:4096
    ds_read_b64_tr_b16 v[26:27], v4 offset:4608
    v_mfma_f32_16x16x32_bf16 v[160:163], v[16:19], a[160:163], v[160:163]
    v_add_f32 v213, 1.0, v213
    v_mul_f32 v124, v124, v212
    v_mfma_f32_16x16x32_bf16 v[160:163], v[20:23], a[176:179], v[160:163]
    v_exp_f32 v215, v215
    v_add_f32 v214, 1.0, v214
    v_mfma_f32_16x16x32_bf16 v[168:171], v[20:23], a[180:183], v[168:171]
    v_rcp_f32 v213, v213
    v_mfma_f32_16x16x32_bf16 v[168:171], v[16:19], a[164:167], v[168:171]
    v_mul_f32 v125, v125, v213
    v_add_f32 v215, 1.0, v215
    v_mfma_f32_16x16x32_bf16 v[176:179], v[16:19], a[168:171], v[176:179]
    buffer_load_dwordx4 a[104:107], v5, s[8:11], s65 offen offset:2048 sc1
    v_rcp_f32 v214, v214
    v_mfma_f32_16x16x32_bf16 v[176:179], v[20:23], a[184:187], v[176:179]
    v_mul_f32 v126, v126, v214
    v_mfma_f32_16x16x32_bf16 v[184:187], v[20:23], a[188:191], v[184:187]
    ds_read_b64_tr_b16 v[20:21], v3 offset:16384
    ds_read_b64_tr_b16 v[22:23], v3 offset:16896
    v_mfma_f32_16x16x32_bf16 v[184:187], v[16:19], a[172:175], v[184:187]
    s_waitcnt lgkmcnt(2)
    ds_read_b64_tr_b16 v[16:17], v3 offset:12288
    ds_read_b64_tr_b16 v[18:19], v3 offset:12800
    v_mfma_f32_16x16x32_bf16 v[188:191], v[24:27], a[172:175], v[188:191]
    v_rcp_f32 v215, v215
    v_mfma_f32_16x16x32_bf16 v[188:191], v[28:31], a[188:191], v[188:191]
    buffer_load_dwordx4 a[108:111], v5, s[8:11], s65 offen offset:3072 sc1
    v_mul_f32 v127, v127, v215
    v_mfma_f32_16x16x32_bf16 v[180:183], v[28:31], a[184:187], v[180:183]
    s_add_u32 s65, s65, 4096
    v_mul_f32 v32, v32, v64
    v_mul_f32 v33, v33, v65
    v_mul_f32 v34, v34, v66
    v_mfma_f32_16x16x32_bf16 v[180:183], v[24:27], a[168:171], v[180:183]
    v_mul_f32 v35, v35, v67
    v_mul_f32 v36, v36, v68
    v_mfma_f32_16x16x32_bf16 v[172:175], v[24:27], a[164:167], v[172:175]
    v_mul_f32 v37, v37, v69
    v_mul_f32 v38, v38, v70
    v_mfma_f32_16x16x32_bf16 v[172:175], v[28:31], a[180:183], v[172:175]
    v_mul_f32 v39, v39, v71
    v_cvt_pk_bf16_f32 v64, v32, v33
    v_cvt_pk_bf16_f32 v65, v34, v35
    v_mfma_f32_16x16x32_bf16 v[164:167], v[28:31], a[176:179], v[164:167]
    ds_read_b64_tr_b16 v[28:29], v4 offset:16384
    ds_read_b64_tr_b16 v[30:31], v4 offset:16896
    v_mfma_f32_16x16x32_bf16 v[164:167], v[24:27], a[160:163], v[164:167]
    s_waitcnt lgkmcnt(2)
    ds_read_b64_tr_b16 v[24:25], v4 offset:12288
    ds_read_b64_tr_b16 v[26:27], v4 offset:12800
    v_mfma_f32_16x16x32_bf16 v[160:163], v[16:19], a[192:195], v[160:163]
    buffer_load_dwordx4 a[112:115], v5, s[8:11], s65 offen offset:0 sc1
    v_cvt_pk_bf16_f32 v66, v36, v37
    v_cvt_pk_bf16_f32 v67, v38, v39
    v_mfma_f32_16x16x32_bf16 v[160:163], v[20:23], a[208:211], v[160:163]
    s_add_u32 s39, s30, 53248
    buffer_store_dwordx4 v[64:67], v5, s[8:11], s39 offen offset:0 sc1
    v_mul_f32 v40, v40, v72
    v_mfma_f32_16x16x32_bf16 v[168:171], v[20:23], a[212:215], v[168:171]
    v_mul_f32 v41, v41, v73
    v_mul_f32 v42, v42, v74
    v_mfma_f32_16x16x32_bf16 v[168:171], v[16:19], a[196:199], v[168:171]
    v_mul_f32 v43, v43, v75
    v_mul_f32 v44, v44, v76
    v_mul_f32 v45, v45, v77
    v_mfma_f32_16x16x32_bf16 v[176:179], v[16:19], a[200:203], v[176:179]
    buffer_load_dwordx4 a[116:119], v5, s[8:11], s65 offen offset:1024 sc1
    v_mul_f32 v46, v46, v78
    v_mfma_f32_16x16x32_bf16 v[176:179], v[20:23], a[216:219], v[176:179]
    v_mul_f32 v47, v47, v79
    v_cvt_pk_bf16_f32 v72, v40, v41
    v_mfma_f32_16x16x32_bf16 v[184:187], v[20:23], a[220:223], v[184:187]
    ds_read_b64_tr_b16 v[20:21], v3 offset:24576
    ds_read_b64_tr_b16 v[22:23], v3 offset:25088
    v_cvt_pk_bf16_f32 v73, v42, v43
    v_mfma_f32_16x16x32_bf16 v[184:187], v[16:19], a[204:207], v[184:187]
    s_waitcnt lgkmcnt(2)
    ds_read_b64_tr_b16 v[16:17], v3 offset:20480
    ds_read_b64_tr_b16 v[18:19], v3 offset:20992
    v_mfma_f32_16x16x32_bf16 v[188:191], v[24:27], a[204:207], v[188:191]
    v_cvt_pk_bf16_f32 v74, v44, v45
    v_cvt_pk_bf16_f32 v75, v46, v47
    v_mfma_f32_16x16x32_bf16 v[188:191], v[28:31], a[220:223], v[188:191]
    s_add_u32 s39, s30, 53248
    buffer_store_dwordx4 v[72:75], v5, s[8:11], s39 offen offset:1024 sc1
    v_mul_f32 v48, v48, v80
    v_mul_f32 v49, v49, v81
    v_mfma_f32_16x16x32_bf16 v[180:183], v[28:31], a[216:219], v[180:183]
    buffer_load_dwordx4 a[120:123], v5, s[8:11], s65 offen offset:2048 sc1
    v_mul_f32 v50, v50, v82
    v_mfma_f32_16x16x32_bf16 v[180:183], v[24:27], a[200:203], v[180:183]
    v_mul_f32 v51, v51, v83
    v_mul_f32 v52, v52, v84
    v_mfma_f32_16x16x32_bf16 v[172:175], v[24:27], a[196:199], v[172:175]
    v_mul_f32 v53, v53, v85
    v_mul_f32 v54, v54, v86
    v_mul_f32 v55, v55, v87
    v_mfma_f32_16x16x32_bf16 v[172:175], v[28:31], a[212:215], v[172:175]
    v_cvt_pk_bf16_f32 v80, v48, v49
    v_cvt_pk_bf16_f32 v81, v50, v51
    v_mfma_f32_16x16x32_bf16 v[164:167], v[28:31], a[208:211], v[164:167]
    ds_read_b64_tr_b16 v[28:29], v4 offset:24576
    ds_read_b64_tr_b16 v[30:31], v4 offset:25088
    v_mfma_f32_16x16x32_bf16 v[164:167], v[24:27], a[192:195], v[164:167]
    s_waitcnt lgkmcnt(2)
    ds_read_b64_tr_b16 v[24:25], v4 offset:20480
    ds_read_b64_tr_b16 v[26:27], v4 offset:20992
    buffer_load_dwordx4 a[124:127], v5, s[8:11], s65 offen offset:3072 sc1
    v_mfma_f32_16x16x32_bf16 v[160:163], v[16:19], a[224:227], v[160:163]
    s_add_u32 s65, s65, 4096
    v_cvt_pk_bf16_f32 v82, v52, v53
    v_cvt_pk_bf16_f32 v83, v54, v55
    v_mfma_f32_16x16x32_bf16 v[160:163], v[20:23], a[240:243], v[160:163]
    s_add_u32 s39, s30, 139392
    buffer_store_dwordx4 v[80:83], v5, s[8:11], s39 offen offset:0 sc1
    v_mul_f32 v56, v56, v88
    v_mfma_f32_16x16x32_bf16 v[168:171], v[20:23], a[244:247], v[168:171]
    v_mul_f32 v57, v57, v89
    v_mul_f32 v58, v58, v90
    v_mul_f32 v59, v59, v91
    v_mfma_f32_16x16x32_bf16 v[168:171], v[16:19], a[228:231], v[168:171]
    v_mul_f32 v60, v60, v92
    v_mul_f32 v61, v61, v93
    v_mfma_f32_16x16x32_bf16 v[176:179], v[16:19], a[232:235], v[176:179]
    v_mul_f32 v62, v62, v94
    v_mul_f32 v63, v63, v95
    v_mfma_f32_16x16x32_bf16 v[176:179], v[20:23], a[248:251], v[176:179]
    buffer_load_dwordx4 a[128:131], v5, s[8:11], s65 offen offset:0 sc1
    v_cvt_pk_bf16_f32 v88, v56, v57
    v_cvt_pk_bf16_f32 v89, v58, v59
    v_mfma_f32_16x16x32_bf16 v[184:187], v[20:23], a[252:255], v[184:187]
    ds_read_b64_tr_b16 v[20:21], v3 offset:32768
    ds_read_b64_tr_b16 v[22:23], v3 offset:33280
    v_mfma_f32_16x16x32_bf16 v[184:187], v[16:19], a[236:239], v[184:187]
    s_waitcnt lgkmcnt(2)
    ds_read_b64_tr_b16 v[16:17], v3 offset:28672
    ds_read_b64_tr_b16 v[18:19], v3 offset:29184
    v_mfma_f32_16x16x32_bf16 v[188:191], v[24:27], a[236:239], v[188:191]
    v_cvt_pk_bf16_f32 v90, v60, v61
    v_cvt_pk_bf16_f32 v91, v62, v63
    v_mfma_f32_16x16x32_bf16 v[188:191], v[28:31], a[252:255], v[188:191]
    s_add_u32 s39, s30, 139392
    buffer_store_dwordx4 v[88:91], v5, s[8:11], s39 offen offset:1024 sc1
    v_mfma_f32_16x16x32_bf16 v[180:183], v[28:31], a[248:251], v[180:183]
    buffer_load_dwordx4 a[132:135], v5, s[8:11], s65 offen offset:1024 sc1
    v_mfma_f32_16x16x32_bf16 v[180:183], v[24:27], a[232:235], v[180:183]
    v_mfma_f32_16x16x32_bf16 v[172:175], v[24:27], a[228:231], v[172:175]
    v_mfma_f32_16x16x32_bf16 v[172:175], v[28:31], a[244:247], v[172:175]
    v_mfma_f32_16x16x32_bf16 v[164:167], v[28:31], a[240:243], v[164:167]
    ds_read_b64_tr_b16 v[28:29], v4 offset:32768
    ds_read_b64_tr_b16 v[30:31], v4 offset:33280
    v_mfma_f32_16x16x32_bf16 v[164:167], v[24:27], a[224:227], v[164:167]
    s_waitcnt lgkmcnt(2)
    ds_read_b64_tr_b16 v[24:25], v4 offset:28672
    ds_read_b64_tr_b16 v[26:27], v4 offset:29184
    v_mfma_f32_16x16x32_bf16 v[160:163], v[16:19], v[224:227], v[160:163]
    buffer_load_dwordx4 a[136:139], v5, s[8:11], s65 offen offset:2048 sc1
    v_mfma_f32_16x16x32_bf16 v[160:163], v[20:23], v[240:243], v[160:163]
    s_barrier
    ds_read_b128 v[208:211], v7 offset:24576
    v_mfma_f32_16x16x32_bf16 v[168:171], v[20:23], v[244:247], v[168:171]
    v_mfma_f32_16x16x32_bf16 v[168:171], v[16:19], v[228:231], v[168:171]
    v_mfma_f32_16x16x32_bf16 v[176:179], v[16:19], v[232:235], v[176:179]
    v_mfma_f32_16x16x32_bf16 v[176:179], v[20:23], v[248:251], v[176:179]
    ds_read_b128 v[212:215], v7 offset:29696
    buffer_load_dwordx4 a[140:143], v5, s[8:11], s65 offen offset:3072 sc1
    v_mfma_f32_16x16x32_bf16 v[184:187], v[20:23], v[252:255], v[184:187]
    s_add_u32 s65, s65, 4096
    ds_read_b128 v[20:23], v7 offset:31744
    v_mfma_f32_16x16x32_bf16 v[184:187], v[16:19], v[236:239], v[184:187]
    s_waitcnt lgkmcnt(3)
    ds_read_b128 v[16:19], v7 offset:26624
    v_mfma_f32_16x16x32_bf16 v[188:191], v[24:27], v[236:239], v[188:191]
    v_mfma_f32_16x16x32_bf16 v[188:191], v[28:31], v[252:255], v[188:191]
    ds_read_b128 v[216:219], v7 offset:25600
    v_mfma_f32_16x16x32_bf16 v[180:183], v[28:31], v[248:251], v[180:183]
    v_mfma_f32_16x16x32_bf16 v[180:183], v[24:27], v[232:235], v[180:183]
    buffer_load_dwordx4 a[144:147], v5, s[8:11], s65 offen offset:0 sc1
    v_mfma_f32_16x16x32_bf16 v[172:175], v[24:27], v[228:231], v[172:175]
    v_mfma_f32_16x16x32_bf16 v[172:175], v[28:31], v[244:247], v[172:175]
    ds_read_b128 v[220:223], v7 offset:30720
    v_mfma_f32_16x16x32_bf16 v[164:167], v[28:31], v[240:243], v[164:167]
    ds_read_b128 v[28:31], v7 offset:32768
    v_mfma_f32_16x16x32_bf16 v[164:167], v[24:27], v[224:227], v[164:167]
    s_waitcnt lgkmcnt(5)
    ds_read_b128 v[24:27], v7 offset:27648
    v_mfma_f32_16x16x32_bf16 v[192:195], v[208:211], a[0:3], 0
    buffer_load_dwordx4 a[148:151], v5, s[8:11], s65 offen offset:1024 sc1
    v_mfma_f32_16x16x32_bf16 v[192:195], v[212:215], a[8:11], v[192:195]
    v_mfma_f32_16x16x32_bf16 v[196:199], v[212:215], a[12:15], 0
    ds_read_b128 v[212:215], v7 offset:33792
    v_mfma_f32_16x16x32_bf16 v[196:199], v[208:211], a[4:7], v[196:199]
    s_waitcnt lgkmcnt(3)
    ds_read_b128 v[208:211], v7 offset:28672
    v_mfma_f32_16x16x32_bf16 v[132:135], v[216:219], a[4:7], 0
    v_mul_f32 v160, v160, v96
    v_mul_f32 v161, v161, v97
    v_mul_f32 v162, v162, v98
    v_mfma_f32_16x16x32_bf16 v[132:135], v[220:223], a[12:15], v[132:135]
    buffer_load_dwordx4 a[152:155], v5, s[8:11], s65 offen offset:2048 sc1
    v_mul_f32 v163, v163, v99
    v_mul_f32 v164, v164, v100
    v_mfma_f32_16x16x32_bf16 v[128:131], v[220:223], a[8:11], 0
    ds_read_b128 v[220:223], v7 offset:39936
    v_mul_f32 v165, v165, v101
    v_mul_f32 v166, v166, v102
    v_mfma_f32_16x16x32_bf16 v[128:131], v[216:219], a[0:3], v[128:131]
    ds_read_b128 v[216:219], v7 offset:34816
    v_mul_f32 v167, v167, v103
    v_cvt_pk_bf16_f32 v96, v160, v161
    v_mfma_f32_16x16x32_bf16 v[136:139], v[16:19], a[0:3], 0
    v_cvt_pk_bf16_f32 v97, v162, v163
    v_cvt_pk_bf16_f32 v98, v164, v165
    v_cvt_pk_bf16_f32 v99, v166, v167
    v_mfma_f32_16x16x32_bf16 v[136:139], v[20:23], a[8:11], v[136:139]
    s_add_u32 s39, s30, 69632
    buffer_store_dwordx4 v[96:99], v5, s[8:11], s39 offen offset:0 sc1
    v_mul_f32 v168, v168, v104
    v_mul_f32 v169, v169, v105
    v_mfma_f32_16x16x32_bf16 v[140:143], v[20:23], a[12:15], 0
    ds_read_b128 v[20:23], v7 offset:40960
    buffer_load_dwordx4 a[156:159], v5, s[8:11], s65 offen offset:3072 sc1
    v_mul_f32 v170, v170, v106
    v_mfma_f32_16x16x32_bf16 v[140:143], v[16:19], a[4:7], v[140:143]
    s_waitcnt lgkmcnt(5)
    ds_read_b128 v[16:19], v7 offset:35840
    v_mul_f32 v171, v171, v107
    v_mul_f32 v172, v172, v108
    v_mfma_f32_16x16x32_bf16 v[148:151], v[24:27], a[4:7], 0
    s_add_u32 m0, s19, 0
    v_mul_f32 v173, v173, v109
    v_mul_f32 v174, v174, v110
    v_mul_f32 v175, v175, v111
    v_mfma_f32_16x16x32_bf16 v[148:151], v[28:31], a[12:15], v[148:151]
    s_add_u32 s66, s66, 4096
    v_cvt_pk_bf16_f32 v104, v168, v169
    v_cvt_pk_bf16_f32 v105, v170, v171
    v_cvt_pk_bf16_f32 v106, v172, v173
    v_mfma_f32_16x16x32_bf16 v[144:147], v[28:31], a[8:11], 0
    ds_read_b128 v[28:31], v7 offset:41984
    v_cvt_pk_bf16_f32 v107, v174, v175
    v_mul_f32 v176, v176, v112
    v_mfma_f32_16x16x32_bf16 v[144:147], v[24:27], a[0:3], v[144:147]
    s_waitcnt lgkmcnt(5)
    ds_read_b128 v[24:27], v7 offset:36864
    buffer_load_dwordx4 v5, s[8:11], s66 offen sc1 lds
    v_mul_f32 v177, v177, v113
    v_mfma_f32_16x16x32_bf16 v[152:155], v[208:211], a[0:3], 0
    s_add_u32 s39, s30, 69632
    buffer_store_dwordx4 v[104:107], v5, s[8:11], s39 offen offset:1024 sc1
    v_mul_f32 v178, v178, v114
    v_mul_f32 v179, v179, v115
    v_mfma_f32_16x16x32_bf16 v[152:155], v[212:215], a[8:11], v[152:155]
    s_add_u32 m0, s19, 4096
    v_mul_f32 v180, v180, v116
    v_mul_f32 v181, v181, v117
    v_mul_f32 v182, v182, v118
    v_mfma_f32_16x16x32_bf16 v[156:159], v[212:215], a[12:15], 0
    s_add_u32 s66, s66, 4096
    ds_read_b128 v[212:215], v7 offset:43008
    v_mul_f32 v183, v183, v119
    v_cvt_pk_bf16_f32 v112, v176, v177
    v_mfma_f32_16x16x32_bf16 v[156:159], v[208:211], a[4:7], v[156:159]
    s_waitcnt lgkmcnt(5)
    ds_read_b128 v[208:211], v7 offset:37888
    v_cvt_pk_bf16_f32 v113, v178, v179
    v_cvt_pk_bf16_f32 v114, v180, v181
    v_mfma_f32_16x16x32_bf16 v[196:199], v[216:219], a[20:23], v[196:199]
    buffer_load_dwordx4 v5, s[8:11], s66 offen sc1 lds
    v_cvt_pk_bf16_f32 v115, v182, v183
    v_mul_f32 v184, v184, v120
    v_mfma_f32_16x16x32_bf16 v[196:199], v[220:223], a[28:31], v[196:199]
    s_add_u32 m0, s19, 8192
    v_mul_f32 v185, v185, v121
    v_mul_f32 v186, v186, v122
    v_mul_f32 v187, v187, v123
    v_mfma_f32_16x16x32_bf16 v[192:195], v[220:223], a[24:27], v[192:195]
    s_add_u32 s66, s66, 4096
    ds_read_b128 v[220:223], v7 offset:44032
    s_add_u32 s39, s30, 155776
    buffer_store_dwordx4 v[112:115], v5, s[8:11], s39 offen offset:0 sc1
    v_mfma_f32_16x16x32_bf16 v[192:195], v[216:219], a[16:19], v[192:195]
    s_waitcnt lgkmcnt(5)
    ds_read_b128 v[216:219], v7 offset:38912
    v_mul_f32 v188, v188, v124
    v_mul_f32 v189, v189, v125
    v_mfma_f32_16x16x32_bf16 v[128:131], v[16:19], a[16:19], v[128:131]
    v_mul_f32 v190, v190, v126
    v_mul_f32 v191, v191, v127
    v_cvt_pk_bf16_f32 v120, v184, v185
    v_mfma_f32_16x16x32_bf16 v[128:131], v[20:23], a[24:27], v[128:131]
    buffer_load_dwordx4 v5, s[8:11], s66 offen sc1 lds
    v_cvt_pk_bf16_f32 v121, v186, v187
    v_cvt_pk_bf16_f32 v122, v188, v189
    v_mfma_f32_16x16x32_bf16 v[132:135], v[20:23], a[28:31], v[132:135]
    s_add_u32 m0, s19, 12288
    ds_read_b128 v[20:23], v7 offset:50176
    v_cvt_pk_bf16_f32 v123, v190, v191
    s_add_u32 s66, s66, 4096
    v_mfma_f32_16x16x32_bf16 v[132:135], v[16:19], a[20:23], v[132:135]
    s_waitcnt lgkmcnt(5)
    ds_read_b128 v[16:19], v7 offset:45056
    v_mfma_f32_16x16x32_bf16 v[140:143], v[24:27], a[20:23], v[140:143]
    s_add_u32 s39, s30, 155776
    buffer_store_dwordx4 v[120:123], v5, s[8:11], s39 offen offset:1024 sc1
    s_lshl_b32 s36, s33, 18
    s_lshl_b32 s26, s16, 12
    v_mfma_f32_16x16x32_bf16 v[140:143], v[28:31], a[28:31], v[140:143]
    s_add_u32 s28, s44, 4
    v_mov_b32 v15, s28
    s_add_u32 s26, s36, s26
    v_mfma_f32_16x16x32_bf16 v[136:139], v[28:31], a[24:27], v[136:139]
    s_add_u32 s26, s26, 34177024
    ds_read_b128 v[28:31], v7 offset:51200
    buffer_load_dwordx4 v5, s[8:11], s66 offen sc1 lds
    v_mfma_f32_16x16x32_bf16 v[136:139], v[24:27], a[16:19], v[136:139]
    s_waitcnt lgkmcnt(5)
    ds_read_b128 v[24:27], v7 offset:46080
    s_lshl_b32 s36, s32, 14
    v_mfma_f32_16x16x32_bf16 v[144:147], v[208:211], a[16:19], v[144:147]
    s_add_u32 s36, s36, s26
    s_lshl_b32 s37, s32, 16
    s_add_u32 s37, s37, s26
    v_mfma_f32_16x16x32_bf16 v[144:147], v[212:215], a[24:27], v[144:147]
    s_add_u32 s26, s32, 1
    s_and_b32 s26, s26, 3
    s_lshl_b32 s26, s26, 16
    v_mfma_f32_16x16x32_bf16 v[148:151], v[212:215], a[28:31], v[148:151]
    s_add_u32 m0, s19, 16384
    ds_read_b128 v[212:215], v7 offset:52224
    s_add_u32 s20, s26, s36
    v_mfma_f32_16x16x32_bf16 v[148:151], v[208:211], a[20:23], v[148:151]
    s_waitcnt lgkmcnt(5)
    s_add_u32 s66, s66, 4096
    ds_read_b128 v[208:211], v7 offset:47104
    buffer_load_dwordx4 v5, s[8:11], s66 offen sc1 lds
    v_mfma_f32_16x16x32_bf16 v[156:159], v[216:219], a[20:23], v[156:159]
    s_sub_u32 s26, s32, 1
    s_and_b32 s26, s26, 3
    s_lshl_b32 s26, s26, 14
    v_mfma_f32_16x16x32_bf16 v[156:159], v[220:223], a[28:31], v[156:159]
    s_add_u32 s23, s26, s37
    s_add_u32 s26, s32, 2
    s_and_b32 s26, s26, 3
    v_mfma_f32_16x16x32_bf16 v[152:155], v[220:223], a[24:27], v[152:155]
    s_add_u32 m0, s19, 20480
    ds_read_b128 v[220:223], v7 offset:53248
    s_lshl_b32 s26, s26, 16
    v_mfma_f32_16x16x32_bf16 v[152:155], v[216:219], a[16:19], v[152:155]
    s_waitcnt lgkmcnt(5)
    ds_read_b128 v[216:219], v7 offset:48128
    s_add_u32 s21, s26, s36
    v_mfma_f32_16x16x32_bf16 v[192:195], v[16:19], a[32:35], v[192:195]
    s_add_u32 s66, s66, 4096
    buffer_load_dwordx4 v5, s[8:11], s66 offen sc1 lds
    s_sub_u32 s26, s32, 2
    v_mfma_f32_16x16x32_bf16 v[192:195], v[20:23], a[40:43], v[192:195]
    s_waitcnt vmcnt(45)
    s_and_b32 s26, s26, 3
    s_lshl_b32 s26, s26, 14
    v_mfma_f32_16x16x32_bf16 v[196:199], v[20:23], a[44:47], v[196:199]
    s_add_u32 m0, s19, 24576
    ds_read_b128 v[20:23], v7 offset:54272
    s_add_u32 s24, s26, s37
    v_mfma_f32_16x16x32_bf16 v[196:199], v[16:19], a[36:39], v[196:199]
    s_waitcnt lgkmcnt(5)
    ds_read_b128 v[16:19], v7 offset:49152
    s_add_u32 s26, s32, 3
    v_mfma_f32_16x16x32_bf16 v[132:135], v[24:27], a[36:39], v[132:135]
    s_and_b32 s26, s26, 3
    s_lshl_b32 s26, s26, 16
    s_add_u32 s22, s26, s36
    v_mfma_f32_16x16x32_bf16 v[132:135], v[28:31], a[44:47], v[132:135]
    s_add_u32 s66, s66, 4096
    buffer_load_dwordx4 v5, s[8:11], s66 offen sc1 lds
    s_sub_u32 s26, s32, 3
    v_mfma_f32_16x16x32_bf16 v[128:131], v[28:31], a[40:43], v[128:131]
    s_add_u32 s65, s65, 4096
    ds_read_b128 v[28:31], v7 offset:60416
    s_and_b32 s26, s26, 3
    v_mfma_f32_16x16x32_bf16 v[128:131], v[24:27], a[32:35], v[128:131]
    s_waitcnt lgkmcnt(5)
    ds_read_b128 v[24:27], v7 offset:55296
    s_lshl_b32 s26, s26, 14
    v_mfma_f32_16x16x32_bf16 v[136:139], v[208:211], a[32:35], v[136:139]
    s_add_u32 s25, s26, s37
    s_lshl_b32 s26, s33, 15
    s_lshl_b32 s36, s16, 11
    v_mfma_f32_16x16x32_bf16 v[136:139], v[212:215], a[40:43], v[136:139]
    s_add_u32 s26, s26, s36
    s_add_u32 s26, s26, 50954240
    s_lshl_b32 s36, s32, 13
    v_mfma_f32_16x16x32_bf16 v[140:143], v[212:215], a[44:47], v[140:143]
    s_barrier
    ds_read_b128 v[212:215], v7 offset:61440
    s_add_u32 s36, s36, s26
    v_mfma_f32_16x16x32_bf16 v[140:143], v[208:211], a[36:39], v[140:143]
    s_waitcnt lgkmcnt(5)
    ds_read_b128 v[208:211], v7 offset:56320
    buffer_load_dwordx4 a[160:163], v5, s[8:11], s65 offen offset:0 sc1
    v_mfma_f32_16x16x32_bf16 v[148:151], v[216:219], a[36:39], v[148:151]
    s_and_b32 s37, s32, 1
    s_lshl_b32 s37, s37, 9
    s_add_u32 s37, s37, s26
    v_mfma_f32_16x16x32_bf16 v[148:151], v[220:223], a[44:47], v[148:151]
    s_and_b32 s38, s32, 2
    s_lshl_b32 s38, s38, 2
    s_add_u32 s37, s37, s38
    v_mfma_f32_16x16x32_bf16 v[144:147], v[220:223], a[40:43], v[144:147]
    s_add_u32 m0, s19, 28672
    ds_read_b128 v[220:223], v7 offset:62464
    s_add_u32 s38, s37, 16384
    v_mfma_f32_16x16x32_bf16 v[144:147], v[216:219], a[32:35], v[144:147]
    s_waitcnt lgkmcnt(5)
    s_add_u32 s66, s66, 4096
    ds_read_b128 v[216:219], v7 offset:57344
    buffer_load_dwordx4 v5, s[8:11], s66 offen sc1 lds
    v_mfma_f32_16x16x32_bf16 v[152:155], v[16:19], a[32:35], v[152:155]
    s_lshl_b32 s30, s33, 10
    s_lshl_b32 s26, s16, 8
    s_add_u32 s30, s30, s26
    v_mfma_f32_16x16x32_bf16 v[152:155], v[20:23], a[40:43], v[152:155]
    s_add_u32 s30, s30, 55410688
    s_lshl_b32 s26, s32, 6
    s_add_u32 s31, s30, s26
    v_mfma_f32_16x16x32_bf16 v[156:159], v[20:23], a[44:47], v[156:159]
    s_add_u32 m0, s19, 32768
    ds_read_b128 v[20:23], v7 offset:63488
    v_lshrrev_b32 v6, 9, v5
    v_mfma_f32_16x16x32_bf16 v[156:159], v[16:19], a[36:39], v[156:159]
    s_waitcnt vmcnt(46) lgkmcnt(5)
    ds_read_b128 v[16:19], v7 offset:58368
    v_lshlrev_b32 v6, 13, v6
    v_mfma_f32_16x16x32_bf16 v[196:199], v[24:27], a[52:55], v[196:199]
    s_waitcnt vmcnt(44)
    s_add_u32 s66, s66, 4096
    buffer_load_dwordx4 v5, s[8:11], s66 offen sc1 lds
    v_mfma_f32_16x16x32_bf16 v[196:199], v[28:31], a[60:63], v[196:199]
    v_and_b32 v1, 0x1f0, v5
    v_add_u32 v6, v6, v1
    v_mfma_f32_16x16x32_bf16 v[192:195], v[28:31], a[56:59], v[192:195]
    ds_read_b128 v[28:31], v7 offset:64512
    v_bfe_u32 v3, v5, 4, 4
    v_mfma_f32_16x16x32_bf16 v[192:195], v[24:27], a[48:51], v[192:195]
    s_waitcnt lgkmcnt(5)
    ds_read_b128 v[24:27], v7 offset:59392
    v_mul_u32_u24 v3, 1152, v3
    v_mfma_f32_16x16x32_bf16 v[128:131], v[208:211], a[48:51], v[128:131]
    v_bfe_u32 v13, v5, 8, 1
    v_lshl_add_u32 v13, v13, 3, v3
    v_mfma_f32_16x16x32_bf16 v[128:131], v[212:215], a[56:59], v[128:131]
    buffer_load_dwordx4 a[164:167], v5, s[8:11], s65 offen offset:1024 sc1
    v_lshrrev_b32 v1, 8, v5
    v_mfma_f32_16x16x32_bf16 v[132:135], v[212:215], a[60:63], v[132:135]
    ds_read_b128 v[212:215], v12 offset:5120
    v_lshl_add_u32 v3, v1, 4, v3
    v_mfma_f32_16x16x32_bf16 v[132:135], v[208:211], a[52:55], v[132:135]
    s_waitcnt lgkmcnt(5)
    ds_read_b128 v[208:211], v12 offset:0
    v_mfma_f32_16x16x32_bf16 v[140:143], v[216:219], a[52:55], v[140:143]
    v_mfma_f32_16x16x32_bf16 v[140:143], v[220:223], a[60:63], v[140:143]
    v_mfma_f32_16x16x32_bf16 v[136:139], v[220:223], a[56:59], v[136:139]
    ds_read_b128 v[220:223], v12 offset:6144
    buffer_load_dwordx4 a[168:171], v5, s[8:11], s65 offen offset:2048 sc1
    v_mfma_f32_16x16x32_bf16 v[136:139], v[216:219], a[48:51], v[136:139]
    s_waitcnt lgkmcnt(5)
    ds_read_b128 v[216:219], v12 offset:1024
    v_mfma_f32_16x16x32_bf16 v[144:147], v[16:19], a[48:51], v[144:147]
    v_mfma_f32_16x16x32_bf16 v[144:147], v[20:23], a[56:59], v[144:147]
    v_mfma_f32_16x16x32_bf16 v[148:151], v[20:23], a[60:63], v[148:151]
    ds_read_b128 v[20:23], v12 offset:7168
    v_mfma_f32_16x16x32_bf16 v[148:151], v[16:19], a[52:55], v[148:151]
    s_waitcnt lgkmcnt(5)
    ds_read_b128 v[16:19], v12 offset:2048
    buffer_load_dwordx4 a[172:175], v5, s[8:11], s65 offen offset:3072 sc1
    v_mfma_f32_16x16x32_bf16 v[156:159], v[24:27], a[52:55], v[156:159]
    s_add_u32 s65, s65, 4096
    v_mfma_f32_16x16x32_bf16 v[156:159], v[28:31], a[60:63], v[156:159]
    v_mfma_f32_16x16x32_bf16 v[152:155], v[28:31], a[56:59], v[152:155]
    ds_read_b128 v[28:31], v12 offset:8192
    v_mfma_f32_16x16x32_bf16 v[152:155], v[24:27], a[48:51], v[152:155]
    s_waitcnt vmcnt(47) lgkmcnt(5)
    ds_read_b128 v[24:27], v12 offset:3072
    v_mfma_f32_16x16x32_bf16 v[192:195], v[208:211], a[64:67], v[192:195]
    s_waitcnt vmcnt(45)
    buffer_load_dwordx4 a[176:179], v5, s[8:11], s65 offen offset:0 sc1
    v_mfma_f32_16x16x32_bf16 v[192:195], v[212:215], a[72:75], v[192:195]
    s_waitcnt vmcnt(45)
    v_mfma_f32_16x16x32_bf16 v[196:199], v[212:215], a[76:79], v[196:199]
    ds_read_b128 v[212:215], v12 offset:9216
    v_mfma_f32_16x16x32_bf16 v[196:199], v[208:211], a[68:71], v[196:199]
    s_waitcnt lgkmcnt(5)
    ds_read_b128 v[208:211], v12 offset:4096
    v_mfma_f32_16x16x32_bf16 v[132:135], v[216:219], a[68:71], v[132:135]
    v_mfma_f32_16x16x32_bf16 v[132:135], v[220:223], a[76:79], v[132:135]
    buffer_load_dwordx4 a[180:183], v5, s[8:11], s65 offen offset:1024 sc1
    v_mfma_f32_16x16x32_bf16 v[128:131], v[220:223], a[72:75], v[128:131]
    ds_read_b128 v[220:223], v12 offset:15360
    v_mfma_f32_16x16x32_bf16 v[128:131], v[216:219], a[64:67], v[128:131]
    s_waitcnt lgkmcnt(5)
    ds_read_b128 v[216:219], v12 offset:10240
    v_mfma_f32_16x16x32_bf16 v[136:139], v[16:19], a[64:67], v[136:139]
    v_mfma_f32_16x16x32_bf16 v[136:139], v[20:23], a[72:75], v[136:139]
    v_mfma_f32_16x16x32_bf16 v[140:143], v[20:23], a[76:79], v[140:143]
    ds_read_b128 v[20:23], v12 offset:16384
    buffer_load_dwordx4 a[184:187], v5, s[8:11], s65 offen offset:2048 sc1
    v_mfma_f32_16x16x32_bf16 v[140:143], v[16:19], a[68:71], v[140:143]
    s_waitcnt lgkmcnt(5)
    ds_read_b128 v[16:19], v12 offset:11264
    v_mfma_f32_16x16x32_bf16 v[148:151], v[24:27], a[68:71], v[148:151]
    v_mfma_f32_16x16x32_bf16 v[148:151], v[28:31], a[76:79], v[148:151]
    v_mfma_f32_16x16x32_bf16 v[144:147], v[28:31], a[72:75], v[144:147]
    ds_read_b128 v[28:31], v12 offset:17408
    v_mfma_f32_16x16x32_bf16 v[144:147], v[24:27], a[64:67], v[144:147]
    s_waitcnt lgkmcnt(5)
    ds_read_b128 v[24:27], v12 offset:12288
    buffer_load_dwordx4 a[188:191], v5, s[8:11], s65 offen offset:3072 sc1
    v_mfma_f32_16x16x32_bf16 v[152:155], v[208:211], a[64:67], v[152:155]
    s_add_u32 s65, s65, 4096
    v_mfma_f32_16x16x32_bf16 v[152:155], v[212:215], a[72:75], v[152:155]
    v_mfma_f32_16x16x32_bf16 v[156:159], v[212:215], a[76:79], v[156:159]
    ds_read_b128 v[212:215], v12 offset:18432
    v_mfma_f32_16x16x32_bf16 v[156:159], v[208:211], a[68:71], v[156:159]
    s_waitcnt vmcnt(46) lgkmcnt(5)
    ds_read_b128 v[208:211], v12 offset:13312
    v_mfma_f32_16x16x32_bf16 v[196:199], v[216:219], a[84:87], v[196:199]
    s_waitcnt vmcnt(44)
    buffer_load_dwordx4 a[192:195], v5, s[8:11], s65 offen offset:0 sc1
    v_mfma_f32_16x16x32_bf16 v[196:199], v[220:223], a[92:95], v[196:199]
    v_mfma_f32_16x16x32_bf16 v[192:195], v[220:223], a[88:91], v[192:195]
    ds_read_b128 v[220:223], v12 offset:19456
    v_mfma_f32_16x16x32_bf16 v[192:195], v[216:219], a[80:83], v[192:195]
    s_waitcnt lgkmcnt(5)
    ds_read_b128 v[216:219], v12 offset:14336
    v_mfma_f32_16x16x32_bf16 v[128:131], v[16:19], a[80:83], v[128:131]
    v_mfma_f32_16x16x32_bf16 v[128:131], v[20:23], a[88:91], v[128:131]
    buffer_load_dwordx4 a[196:199], v5, s[8:11], s65 offen offset:1024 sc1
    v_mfma_f32_16x16x32_bf16 v[132:135], v[20:23], a[92:95], v[132:135]
    ds_read_b128 v[20:23], v12 offset:25600
    v_mfma_f32_16x16x32_bf16 v[132:135], v[16:19], a[84:87], v[132:135]
    s_waitcnt lgkmcnt(5)
    ds_read_b128 v[16:19], v12 offset:20480
    v_mfma_f32_16x16x32_bf16 v[140:143], v[24:27], a[84:87], v[140:143]
    v_mfma_f32_16x16x32_bf16 v[140:143], v[28:31], a[92:95], v[140:143]
    v_mfma_f32_16x16x32_bf16 v[136:139], v[28:31], a[88:91], v[136:139]
    ds_read_b128 v[28:31], v12 offset:26624
    buffer_load_dwordx4 a[200:203], v5, s[8:11], s65 offen offset:2048 sc1
    v_mfma_f32_16x16x32_bf16 v[136:139], v[24:27], a[80:83], v[136:139]
    s_waitcnt vmcnt(17) lgkmcnt(5)
    ds_read_b128 v[24:27], v12 offset:21504
    buffer_store_dword v15, off, s[8:11], s46 sc1
    v_mfma_f32_16x16x32_bf16 v[144:147], v[208:211], a[80:83], v[144:147]
    v_mfma_f32_16x16x32_bf16 v[144:147], v[212:215], a[88:91], v[144:147]
    v_mfma_f32_16x16x32_bf16 v[148:151], v[212:215], a[92:95], v[148:151]
    ds_read_b128 v[212:215], v12 offset:27648
    v_mfma_f32_16x16x32_bf16 v[148:151], v[208:211], a[84:87], v[148:151]
    s_waitcnt lgkmcnt(5)
    ds_read_b128 v[208:211], v12 offset:22528
    buffer_load_dwordx4 a[204:207], v5, s[8:11], s65 offen offset:3072 sc1
    v_mfma_f32_16x16x32_bf16 v[156:159], v[216:219], a[84:87], v[156:159]
    s_add_u32 m0, s19, 36864
    s_add_u32 s66, s66, 4096
    v_mfma_f32_16x16x32_bf16 v[156:159], v[220:223], a[92:95], v[156:159]
    v_mfma_f32_16x16x32_bf16 v[152:155], v[220:223], a[88:91], v[152:155]
    s_barrier
    ds_read_b128 v[220:223], v12 offset:28672
    v_mfma_f32_16x16x32_bf16 v[152:155], v[216:219], a[80:83], v[152:155]
    s_waitcnt lgkmcnt(5)
    ds_read_b128 v[216:219], v12 offset:23552
    v_mfma_f32_16x16x32_bf16 v[192:195], v[16:19], a[96:99], v[192:195]
    buffer_load_dwordx4 v5, s[8:11], s66 offen sc1 lds
    v_mfma_f32_16x16x32_bf16 v[192:195], v[20:23], a[104:107], v[192:195]
    s_add_u32 m0, s19, 40960
    s_add_u32 s66, s66, 4096
    v_mfma_f32_16x16x32_bf16 v[196:199], v[20:23], a[108:111], v[196:199]
    ds_read_b128 v[20:23], v12 offset:29696
    v_mfma_f32_16x16x32_bf16 v[196:199], v[16:19], a[100:103], v[196:199]
    s_waitcnt lgkmcnt(5)
    ds_read_b128 v[16:19], v12 offset:24576
    v_mfma_f32_16x16x32_bf16 v[132:135], v[24:27], a[100:103], v[132:135]
    v_mfma_f32_16x16x32_bf16 v[132:135], v[28:31], a[108:111], v[132:135]
    buffer_load_dwordx4 v5, s[8:11], s66 offen sc1 lds
    v_mfma_f32_16x16x32_bf16 v[128:131], v[28:31], a[104:107], v[128:131]
    s_add_u32 m0, s19, 45056
    ds_read_b128 v[28:31], v5 offset:64512
    s_add_u32 s66, s66, 4096
    v_mfma_f32_16x16x32_bf16 v[128:131], v[24:27], a[96:99], v[128:131]
    s_waitcnt lgkmcnt(5)
    ds_read_b128 v[24:27], v12 offset:30720
    v_mfma_f32_16x16x32_bf16 v[136:139], v[208:211], a[96:99], v[136:139]
    v_mfma_f32_16x16x32_bf16 v[136:139], v[212:215], a[104:107], v[136:139]
    v_mfma_f32_16x16x32_bf16 v[140:143], v[212:215], a[108:111], v[140:143]
    ds_read_b128 v[212:215], v7 offset:0
    buffer_load_dwordx4 v5, s[8:11], s66 offen sc1 lds
    v_mfma_f32_16x16x32_bf16 v[140:143], v[208:211], a[100:103], v[140:143]
    s_waitcnt lgkmcnt(5)
    ds_read_b128 v[208:211], v12 offset:31744
    s_add_u32 m0, s19, 49152
    v_mfma_f32_16x16x32_bf16 v[148:151], v[216:219], a[100:103], v[148:151]
    s_add_u32 s66, s66, 4096
    v_mfma_f32_16x16x32_bf16 v[148:151], v[220:223], a[108:111], v[148:151]
    v_mfma_f32_16x16x32_bf16 v[144:147], v[220:223], a[104:107], v[144:147]
    ds_read_b128 v[220:223], v7 offset:1024
    v_mfma_f32_16x16x32_bf16 v[144:147], v[216:219], a[96:99], v[144:147]
    s_waitcnt lgkmcnt(5)
    ds_read_b128 v[216:219], v5 offset:61440
    buffer_load_dwordx4 v5, s[8:11], s66 offen sc1 lds
    v_mfma_f32_16x16x32_bf16 v[152:155], v[16:19], a[96:99], v[152:155]
    s_add_u32 m0, s19, 53248
    s_add_u32 s66, s66, 4096
    v_mfma_f32_16x16x32_bf16 v[152:155], v[20:23], a[104:107], v[152:155]
    v_mfma_f32_16x16x32_bf16 v[156:159], v[20:23], a[108:111], v[156:159]
    ds_read_b128 v[20:23], v7 offset:2048
    v_mfma_f32_16x16x32_bf16 v[156:159], v[16:19], a[100:103], v[156:159]
    s_waitcnt lgkmcnt(5)
    ds_read_b128 v[16:19], v5 offset:62464
    v_mfma_f32_16x16x32_bf16 v[196:199], v[24:27], a[116:119], v[196:199]
    buffer_load_dwordx4 v5, s[8:11], s66 offen sc1 lds
    v_mfma_f32_16x16x32_bf16 v[196:199], v[28:31], a[124:127], v[196:199]
    s_add_u32 m0, s19, 57344
    s_add_u32 s66, s66, 4096
    v_mfma_f32_16x16x32_bf16 v[192:195], v[28:31], a[120:123], v[192:195]
    ds_read_b128 v[28:31], v7 offset:3072
    v_mfma_f32_16x16x32_bf16 v[192:195], v[24:27], a[112:115], v[192:195]
    s_waitcnt lgkmcnt(5)
    ds_read_b128 v[24:27], v5 offset:63488
    v_mfma_f32_16x16x32_bf16 v[128:131], v[208:211], a[112:115], v[128:131]
    v_mfma_f32_16x16x32_bf16 v[128:131], v[212:215], a[120:123], v[128:131]
    buffer_load_dwordx4 v5, s[8:11], s66 offen sc1 lds
    v_mfma_f32_16x16x32_bf16 v[132:135], v[212:215], a[124:127], v[132:135]
    s_add_u32 m0, s19, 90112
    ds_read_b128 v[212:215], v7 offset:9216
    s_add_u32 s66, s66, 4096
    v_mfma_f32_16x16x32_bf16 v[132:135], v[208:211], a[116:119], v[132:135]
    s_waitcnt lgkmcnt(5)
    ds_read_b128 v[208:211], v7 offset:4096
    v_mfma_f32_16x16x32_bf16 v[140:143], v[216:219], a[116:119], v[140:143]
    v_mfma_f32_16x16x32_bf16 v[140:143], v[220:223], a[124:127], v[140:143]
    s_add_u32 s51, s44, 4
    buffer_load_dword v9, v8, s[8:11], s67 offen sc1
    v_mfma_f32_16x16x32_bf16 v[136:139], v[220:223], a[120:123], v[136:139]
    ds_read_b128 v[220:223], v7 offset:10240
    buffer_load_dwordx4 v5, s[8:11], s66 offen sc1 lds
    v_mfma_f32_16x16x32_bf16 v[136:139], v[216:219], a[112:115], v[136:139]
    s_waitcnt lgkmcnt(5)
    ds_read_b128 v[216:219], v7 offset:5120
    s_add_u32 m0, s19, 94208
    v_mfma_f32_16x16x32_bf16 v[144:147], v[16:19], a[112:115], v[144:147]
    s_add_u32 s66, s66, 4096
    v_mfma_f32_16x16x32_bf16 v[144:147], v[20:23], a[120:123], v[144:147]
    v_mfma_f32_16x16x32_bf16 v[148:151], v[20:23], a[124:127], v[148:151]
    ds_read_b128 v[20:23], v7 offset:11264
    v_mfma_f32_16x16x32_bf16 v[148:151], v[16:19], a[116:119], v[148:151]
    s_waitcnt lgkmcnt(5)
    ds_read_b128 v[16:19], v7 offset:6144
    buffer_load_dwordx4 v5, s[8:11], s66 offen sc1 lds
    v_mfma_f32_16x16x32_bf16 v[156:159], v[24:27], a[116:119], v[156:159]
    s_add_u32 m0, s19, 98304
    s_add_u32 s66, s66, 4096
    v_mfma_f32_16x16x32_bf16 v[156:159], v[28:31], a[124:127], v[156:159]
    v_mfma_f32_16x16x32_bf16 v[152:155], v[28:31], a[120:123], v[152:155]
    ds_read_b128 v[28:31], v7 offset:12288
    v_mfma_f32_16x16x32_bf16 v[152:155], v[24:27], a[112:115], v[152:155]
    s_waitcnt lgkmcnt(5)
    ds_read_b128 v[24:27], v7 offset:7168
    v_mfma_f32_16x16x32_bf16 v[192:195], v[208:211], a[128:131], v[192:195]
    buffer_load_dwordx4 v5, s[8:11], s66 offen sc1 lds
    v_mfma_f32_16x16x32_bf16 v[192:195], v[212:215], a[136:139], v[192:195]
    s_add_u32 m0, s19, 102400
    s_add_u32 s66, s66, 4096
    v_mfma_f32_16x16x32_bf16 v[196:199], v[212:215], a[140:143], v[196:199]
    ds_read_b128 v[212:215], v7 offset:13312
    v_mfma_f32_16x16x32_bf16 v[196:199], v[208:211], a[132:135], v[196:199]
    s_waitcnt lgkmcnt(5)
    ds_read_b128 v[208:211], v7 offset:8192
    v_mfma_f32_16x16x32_bf16 v[132:135], v[216:219], a[132:135], v[132:135]
    v_mfma_f32_16x16x32_bf16 v[132:135], v[220:223], a[140:143], v[132:135]
    buffer_load_dwordx4 v5, s[8:11], s66 offen sc1 lds
    v_mfma_f32_16x16x32_bf16 v[128:131], v[220:223], a[136:139], v[128:131]
    s_add_u32 m0, s19, 106496
    ds_read_b128 v[220:223], v7 offset:19456
    s_add_u32 s66, s66, 4096
    v_mfma_f32_16x16x32_bf16 v[128:131], v[216:219], a[128:131], v[128:131]
    s_waitcnt lgkmcnt(5)
    ds_read_b128 v[216:219], v7 offset:14336
    v_mfma_f32_16x16x32_bf16 v[136:139], v[16:19], a[128:131], v[136:139]
    v_mfma_f32_16x16x32_bf16 v[136:139], v[20:23], a[136:139], v[136:139]
    v_mfma_f32_16x16x32_bf16 v[140:143], v[20:23], a[140:143], v[140:143]
    ds_read_b128 v[20:23], v7 offset:20480
    buffer_load_dwordx4 v5, s[8:11], s66 offen sc1 lds
    v_mfma_f32_16x16x32_bf16 v[140:143], v[16:19], a[132:135], v[140:143]
    s_waitcnt lgkmcnt(5)
    ds_read_b128 v[16:19], v7 offset:15360
    s_add_u32 m0, s19, 110592
    v_mfma_f32_16x16x32_bf16 v[148:151], v[24:27], a[132:135], v[148:151]
    s_add_u32 s66, s66, 4096
    v_mfma_f32_16x16x32_bf16 v[148:151], v[28:31], a[140:143], v[148:151]
    v_mfma_f32_16x16x32_bf16 v[144:147], v[28:31], a[136:139], v[144:147]
    ds_read_b128 v[28:31], v7 offset:21504
    v_mfma_f32_16x16x32_bf16 v[144:147], v[24:27], a[128:131], v[144:147]
    s_waitcnt lgkmcnt(5)
    ds_read_b128 v[24:27], v7 offset:16384
    buffer_load_dwordx4 v5, s[8:11], s66 offen sc1 lds
    v_mfma_f32_16x16x32_bf16 v[152:155], v[208:211], a[128:131], v[152:155]
    s_add_u32 m0, s19, 114688
    s_add_u32 s66, s66, 4096
    v_mfma_f32_16x16x32_bf16 v[152:155], v[212:215], a[136:139], v[152:155]
    v_mfma_f32_16x16x32_bf16 v[156:159], v[212:215], a[140:143], v[156:159]
    ds_read_b128 v[212:215], v7 offset:22528
    v_mfma_f32_16x16x32_bf16 v[156:159], v[208:211], a[132:135], v[156:159]
    s_waitcnt lgkmcnt(5)
    ds_read_b128 v[208:211], v7 offset:17408
    v_mfma_f32_16x16x32_bf16 v[196:199], v[216:219], a[148:151], v[196:199]
    buffer_load_dwordx4 v5, s[8:11], s66 offen sc1 lds
    v_mfma_f32_16x16x32_bf16 v[196:199], v[220:223], a[156:159], v[196:199]
    s_add_u32 m0, s19, 118784
    s_add_u32 s66, s66, 4096
    v_mfma_f32_16x16x32_bf16 v[192:195], v[220:223], a[152:155], v[192:195]
    ds_read_b128 v[220:223], v7 offset:23552
    v_mfma_f32_16x16x32_bf16 v[192:195], v[216:219], a[144:147], v[192:195]
    s_waitcnt lgkmcnt(5)
    ds_read_b128 v[216:219], v7 offset:18432
    v_mfma_f32_16x16x32_bf16 v[128:131], v[16:19], a[144:147], v[128:131]
    v_mfma_f32_16x16x32_bf16 v[128:131], v[20:23], a[152:155], v[128:131]
    buffer_load_dwordx4 v5, s[8:11], s66 offen sc1 lds
    v_mfma_f32_16x16x32_bf16 v[132:135], v[20:23], a[156:159], v[132:135]
    s_waitcnt vmcnt(27)
    s_barrier
    ds_read_b128 v[20:23], v5 offset:5120
    v_mfma_f32_16x16x32_bf16 v[132:135], v[16:19], a[148:151], v[132:135]
    s_waitcnt lgkmcnt(5)
    ds_read_b128 v[16:19], v5 offset:0
    s_add_u32 m0, s19, 122880
    v_mfma_f32_16x16x32_bf16 v[140:143], v[24:27], a[148:151], v[140:143]
    s_add_u32 s66, s66, 4096
    v_mfma_f32_16x16x32_bf16 v[140:143], v[28:31], a[156:159], v[140:143]
    v_mfma_f32_16x16x32_bf16 v[136:139], v[28:31], a[152:155], v[136:139]
    ds_read_b128 v[28:31], v5 offset:6144
    buffer_load_dwordx4 v5, s[8:11], s66 offen sc1 lds
    v_mfma_f32_16x16x32_bf16 v[136:139], v[24:27], a[144:147], v[136:139]
    s_waitcnt lgkmcnt(5)
    ds_read_b128 v[24:27], v5 offset:1024
    s_add_u32 m0, s19, 126976
    v_mfma_f32_16x16x32_bf16 v[144:147], v[208:211], a[144:147], v[144:147]
    s_add_u32 s66, s66, 4096
    v_mfma_f32_16x16x32_bf16 v[144:147], v[212:215], a[152:155], v[144:147]
    v_mfma_f32_16x16x32_bf16 v[148:151], v[212:215], a[156:159], v[148:151]
    ds_read_b128 v[212:215], v5 offset:7168
    v_mfma_f32_16x16x32_bf16 v[148:151], v[208:211], a[148:151], v[148:151]
    s_waitcnt lgkmcnt(5)
    ds_read_b128 v[208:211], v5 offset:2048
    buffer_load_dwordx4 v5, s[8:11], s66 offen sc1 lds
    v_mfma_f32_16x16x32_bf16 v[156:159], v[216:219], a[148:151], v[156:159]
    s_add_u32 m0, s19, 131072
    s_add_u32 s66, s66, 4096
    v_mfma_f32_16x16x32_bf16 v[156:159], v[220:223], a[156:159], v[156:159]
    v_mfma_f32_16x16x32_bf16 v[152:155], v[220:223], a[152:155], v[152:155]
    ds_read_b128 v[220:223], v5 offset:8192
    v_mfma_f32_16x16x32_bf16 v[152:155], v[216:219], a[144:147], v[152:155]
    s_waitcnt lgkmcnt(5)
    ds_read_b128 v[216:219], v5 offset:3072
    v_mfma_f32_16x16x32_bf16 v[192:195], v[16:19], a[160:163], v[192:195]
    s_waitcnt vmcnt(27)
    buffer_load_dwordx4 v5, s[8:11], s66 offen sc1 lds
    v_mfma_f32_16x16x32_bf16 v[192:195], v[20:23], a[168:171], v[192:195]
    s_waitcnt vmcnt(27)
    s_add_u32 m0, s19, 135168
    s_add_u32 s66, s66, 4096
    v_mfma_f32_16x16x32_bf16 v[196:199], v[20:23], a[172:175], v[196:199]
    ds_read_b128 v[20:23], v5 offset:9216
    v_mfma_f32_16x16x32_bf16 v[196:199], v[16:19], a[164:167], v[196:199]
    s_waitcnt lgkmcnt(5)
    ds_read_b128 v[16:19], v5 offset:4096
    v_mfma_f32_16x16x32_bf16 v[132:135], v[24:27], a[164:167], v[132:135]
    v_mfma_f32_16x16x32_bf16 v[132:135], v[28:31], a[172:175], v[132:135]
    buffer_load_dwordx4 v5, s[8:11], s66 offen sc1 lds
    v_mfma_f32_16x16x32_bf16 v[128:131], v[28:31], a[168:171], v[128:131]
    s_add_u32 m0, s19, 139264
    ds_read_b128 v[28:31], v5 offset:15360
    s_add_u32 s66, s66, 4096
    v_mfma_f32_16x16x32_bf16 v[128:131], v[24:27], a[160:163], v[128:131]
    s_waitcnt lgkmcnt(5)
    ds_read_b128 v[24:27], v5 offset:10240
    v_mfma_f32_16x16x32_bf16 v[136:139], v[208:211], a[160:163], v[136:139]
    v_mfma_f32_16x16x32_bf16 v[136:139], v[212:215], a[168:171], v[136:139]
    v_mfma_f32_16x16x32_bf16 v[140:143], v[212:215], a[172:175], v[140:143]
    ds_read_b128 v[212:215], v5 offset:16384
    buffer_load_dwordx4 v5, s[8:11], s66 offen sc1 lds
    v_mfma_f32_16x16x32_bf16 v[140:143], v[208:211], a[164:167], v[140:143]
    s_waitcnt lgkmcnt(5)
    ds_read_b128 v[208:211], v5 offset:11264
    s_add_u32 m0, s19, 143360
    v_mfma_f32_16x16x32_bf16 v[148:151], v[216:219], a[164:167], v[148:151]
    s_add_u32 s66, s66, 4096
    v_mfma_f32_16x16x32_bf16 v[148:151], v[220:223], a[172:175], v[148:151]
    v_mfma_f32_16x16x32_bf16 v[144:147], v[220:223], a[168:171], v[144:147]
    ds_read_b128 v[220:223], v5 offset:17408
    v_mfma_f32_16x16x32_bf16 v[144:147], v[216:219], a[160:163], v[144:147]
    s_waitcnt lgkmcnt(5)
    ds_read_b128 v[216:219], v5 offset:12288
    buffer_load_dwordx4 v5, s[8:11], s66 offen sc1 lds
    v_mfma_f32_16x16x32_bf16 v[152:155], v[16:19], a[160:163], v[152:155]
    s_add_u32 m0, s19, 147456
    s_add_u32 s66, s66, 4096
    v_mfma_f32_16x16x32_bf16 v[152:155], v[20:23], a[168:171], v[152:155]
    v_mfma_f32_16x16x32_bf16 v[156:159], v[20:23], a[172:175], v[156:159]
    ds_read_b128 v[20:23], v5 offset:18432
    v_mfma_f32_16x16x32_bf16 v[156:159], v[16:19], a[164:167], v[156:159]
    s_waitcnt vmcnt(28) lgkmcnt(5)
    ds_read_b128 v[16:19], v5 offset:13312
    v_mfma_f32_16x16x32_bf16 v[196:199], v[24:27], a[180:183], v[196:199]
    s_waitcnt vmcnt(26)
    buffer_load_dwordx4 v5, s[8:11], s66 offen sc1 lds
    v_mfma_f32_16x16x32_bf16 v[196:199], v[28:31], a[188:191], v[196:199]
    s_add_u32 m0, s19, 151552
    s_add_u32 s66, s66, 4096
    v_mfma_f32_16x16x32_bf16 v[192:195], v[28:31], a[184:187], v[192:195]
    ds_read_b128 v[28:31], v5 offset:19456
    v_mfma_f32_16x16x32_bf16 v[192:195], v[24:27], a[176:179], v[192:195]
    s_waitcnt lgkmcnt(5)
    ds_read_b128 v[24:27], v5 offset:14336
    v_mfma_f32_16x16x32_bf16 v[128:131], v[208:211], a[176:179], v[128:131]
    s_waitcnt vmcnt(15)
    v_subrev_u32 v9, s51, v9
    v_cmp_le_u32 vcc, 4, v9
    s_nop 0
    s_cbranch_vccnz LS_h2
LB_h2:
    v_mfma_f32_16x16x32_bf16 v[128:131], v[212:215], a[184:187], v[128:131]
    buffer_load_dwordx4 v5, s[8:11], s66 offen sc1 lds
    v_and_b32 v8, 0xc0, v8
    v_mfma_f32_16x16x32_bf16 v[132:135], v[212:215], a[188:191], v[132:135]
    s_add_u32 s65, s65, 4096
    ds_read_b128 v[212:215], v5 offset:25600
    v_mfma_f32_16x16x32_bf16 v[132:135], v[208:211], a[180:183], v[132:135]
    s_waitcnt lgkmcnt(5)
    ds_read_b128 v[208:211], v5 offset:20480
    v_mfma_f32_16x16x32_bf16 v[140:143], v[216:219], a[180:183], v[140:143]
    buffer_load_dwordx4 a[208:211], v5, s[8:11], s65 offen offset:0 sc1
    v_mfma_f32_16x16x32_bf16 v[140:143], v[220:223], a[188:191], v[140:143]
    v_mfma_f32_16x16x32_bf16 v[136:139], v[220:223], a[184:187], v[136:139]
    ds_read_b128 v[220:223], v5 offset:26624
    v_mfma_f32_16x16x32_bf16 v[136:139], v[216:219], a[176:179], v[136:139]
    s_waitcnt lgkmcnt(5)
    ds_read_b128 v[216:219], v5 offset:21504
    buffer_load_dwordx4 a[212:215], v5, s[8:11], s65 offen offset:1024 sc1
    v_mfma_f32_16x16x32_bf16 v[144:147], v[16:19], a[176:179], v[144:147]
    v_mfma_f32_16x16x32_bf16 v[144:147], v[20:23], a[184:187], v[144:147]
    v_mfma_f32_16x16x32_bf16 v[148:151], v[20:23], a[188:191], v[148:151]
    ds_read_b128 v[20:23], v5 offset:27648
    buffer_load_dwordx4 a[216:219], v5, s[8:11], s65 offen offset:2048 sc1
    v_mfma_f32_16x16x32_bf16 v[148:151], v[16:19], a[180:183], v[148:151]
    s_waitcnt lgkmcnt(5)
    ds_read_b128 v[16:19], v5 offset:22528
    v_mfma_f32_16x16x32_bf16 v[156:159], v[24:27], a[180:183], v[156:159]
    v_mfma_f32_16x16x32_bf16 v[156:159], v[28:31], a[188:191], v[156:159]
    buffer_load_dwordx4 a[220:223], v5, s[8:11], s65 offen offset:3072 sc1
    v_mfma_f32_16x16x32_bf16 v[152:155], v[28:31], a[184:187], v[152:155]
    s_add_u32 s65, s65, 4096
    ds_read_b128 v[28:31], v5 offset:28672
    v_mfma_f32_16x16x32_bf16 v[152:155], v[24:27], a[176:179], v[152:155]
    s_waitcnt lgkmcnt(5)
    ds_read_b128 v[24:27], v5 offset:23552
    v_mfma_f32_16x16x32_bf16 v[192:195], v[208:211], a[192:195], v[192:195]
    buffer_load_dwordx4 a[224:227], v5, s[8:11], s65 offen offset:0 sc1
    v_mfma_f32_16x16x32_bf16 v[192:195], v[212:215], a[200:203], v[192:195]
    v_mfma_f32_16x16x32_bf16 v[196:199], v[212:215], a[204:207], v[196:199]
    ds_read_b128 v[212:215], v5 offset:29696
    v_mfma_f32_16x16x32_bf16 v[196:199], v[208:211], a[196:199], v[196:199]
    s_waitcnt lgkmcnt(5)
    ds_read_b128 v[208:211], v5 offset:24576
    buffer_load_dwordx4 a[228:231], v5, s[8:11], s65 offen offset:1024 sc1
    v_mfma_f32_16x16x32_bf16 v[132:135], v[216:219], a[196:199], v[132:135]
    v_mfma_f32_16x16x32_bf16 v[132:135], v[220:223], a[204:207], v[132:135]
    v_mfma_f32_16x16x32_bf16 v[128:131], v[220:223], a[200:203], v[128:131]
    ds_read_b128 v[220:223], v5 offset:35840
    buffer_load_dwordx4 a[232:235], v5, s[8:11], s65 offen offset:2048 sc1
    v_mfma_f32_16x16x32_bf16 v[128:131], v[216:219], a[192:195], v[128:131]
    s_waitcnt lgkmcnt(5)
    ds_read_b128 v[216:219], v5 offset:30720
    v_mfma_f32_16x16x32_bf16 v[136:139], v[16:19], a[192:195], v[136:139]
    v_mfma_f32_16x16x32_bf16 v[136:139], v[20:23], a[200:203], v[136:139]
    buffer_load_dwordx4 a[236:239], v5, s[8:11], s65 offen offset:3072 sc1
    v_mfma_f32_16x16x32_bf16 v[140:143], v[20:23], a[204:207], v[140:143]
    s_waitcnt vmcnt(22)
    s_barrier
    ds_read_b128 v[20:23], v5 offset:36864
    v_mfma_f32_16x16x32_bf16 v[140:143], v[16:19], a[196:199], v[140:143]
    s_waitcnt lgkmcnt(5)
    ds_read_b128 v[16:19], v5 offset:31744
    s_add_u32 s65, s65, 4096
    v_mfma_f32_16x16x32_bf16 v[148:151], v[24:27], a[196:199], v[148:151]
    buffer_load_dwordx4 a[240:243], v5, s[8:11], s65 offen offset:0 sc1
    v_mfma_f32_16x16x32_bf16 v[148:151], v[28:31], a[204:207], v[148:151]
    v_mfma_f32_16x16x32_bf16 v[144:147], v[28:31], a[200:203], v[144:147]
    ds_read_b128 v[28:31], v5 offset:37888
    v_mfma_f32_16x16x32_bf16 v[144:147], v[24:27], a[192:195], v[144:147]
    s_waitcnt lgkmcnt(5)
    ds_read_b128 v[24:27], v5 offset:32768
    buffer_load_dwordx4 a[244:247], v5, s[8:11], s65 offen offset:1024 sc1
    v_mfma_f32_16x16x32_bf16 v[152:155], v[208:211], a[192:195], v[152:155]
    v_mfma_f32_16x16x32_bf16 v[152:155], v[212:215], a[200:203], v[152:155]
    v_mfma_f32_16x16x32_bf16 v[156:159], v[212:215], a[204:207], v[156:159]
    ds_read_b128 v[212:215], v5 offset:38912
    buffer_load_dwordx4 a[248:251], v5, s[8:11], s65 offen offset:2048 sc1
    v_mfma_f32_16x16x32_bf16 v[156:159], v[208:211], a[196:199], v[156:159]
    s_waitcnt vmcnt(9) lgkmcnt(5)
    ds_read_b128 v[208:211], v5 offset:33792
    v_mfma_f32_16x16x32_bf16 v[196:199], v[216:219], a[212:215], v[196:199]
    s_waitcnt vmcnt(7)
    v_mfma_f32_16x16x32_bf16 v[196:199], v[220:223], a[220:223], v[196:199]
    buffer_load_dwordx4 a[252:255], v5, s[8:11], s65 offen offset:3072 sc1
    v_mfma_f32_16x16x32_bf16 v[192:195], v[220:223], a[216:219], v[192:195]
    s_add_u32 s65, s65, 4096
    ds_read_b128 v[220:223], v5 offset:39936
    v_mfma_f32_16x16x32_bf16 v[192:195], v[216:219], a[208:211], v[192:195]
    s_waitcnt lgkmcnt(5)
    ds_read_b128 v[216:219], v5 offset:34816
    v_mfma_f32_16x16x32_bf16 v[128:131], v[16:19], a[208:211], v[128:131]
    v_mfma_f32_16x16x32_bf16 v[128:131], v[20:23], a[216:219], v[128:131]
    v_mfma_f32_16x16x32_bf16 v[132:135], v[20:23], a[220:223], v[132:135]
    ds_read_b128 v[20:23], v5 offset:46080
    buffer_load_dwordx4 v[224:227], v5, s[8:11], s65 offen offset:0 sc1
    v_mfma_f32_16x16x32_bf16 v[132:135], v[16:19], a[212:215], v[132:135]
    s_waitcnt lgkmcnt(5)
    ds_read_b128 v[16:19], v5 offset:40960
    v_mfma_f32_16x16x32_bf16 v[140:143], v[24:27], a[212:215], v[140:143]
    v_mfma_f32_16x16x32_bf16 v[140:143], v[28:31], a[220:223], v[140:143]
    v_mfma_f32_16x16x32_bf16 v[136:139], v[28:31], a[216:219], v[136:139]
    ds_read_b128 v[28:31], v5 offset:47104
    v_mfma_f32_16x16x32_bf16 v[136:139], v[24:27], a[208:211], v[136:139]
    s_waitcnt lgkmcnt(5)
    ds_read_b128 v[24:27], v5 offset:41984
    buffer_load_dwordx4 v[228:231], v5, s[8:11], s65 offen offset:1024 sc1
    v_mfma_f32_16x16x32_bf16 v[144:147], v[208:211], a[208:211], v[144:147]
    v_mfma_f32_16x16x32_bf16 v[144:147], v[212:215], a[216:219], v[144:147]
    v_mfma_f32_16x16x32_bf16 v[148:151], v[212:215], a[220:223], v[148:151]
    ds_read_b128 v[212:215], v5 offset:48128
    buffer_load_dwordx4 v[232:235], v5, s[8:11], s65 offen offset:2048 sc1
    v_mfma_f32_16x16x32_bf16 v[148:151], v[208:211], a[212:215], v[148:151]
    s_waitcnt lgkmcnt(5)
    ds_read_b128 v[208:211], v5 offset:43008
    v_mfma_f32_16x16x32_bf16 v[156:159], v[216:219], a[212:215], v[156:159]
    v_mfma_f32_16x16x32_bf16 v[156:159], v[220:223], a[220:223], v[156:159]
    buffer_load_dwordx4 v[236:239], v5, s[8:11], s65 offen offset:3072 sc1
    v_mfma_f32_16x16x32_bf16 v[152:155], v[220:223], a[216:219], v[152:155]
    s_add_u32 s65, s65, 4096
    ds_read_b128 v[220:223], v5 offset:49152
    v_mfma_f32_16x16x32_bf16 v[152:155], v[216:219], a[208:211], v[152:155]
    s_waitcnt vmcnt(11) lgkmcnt(5)
    ds_read_b128 v[216:219], v5 offset:44032
    v_mfma_f32_16x16x32_bf16 v[192:195], v[16:19], a[224:227], v[192:195]
    s_waitcnt vmcnt(9)
    v_mfma_f32_16x16x32_bf16 v[192:195], v[20:23], a[232:235], v[192:195]
    s_waitcnt vmcnt(8)
    v_mfma_f32_16x16x32_bf16 v[196:199], v[20:23], a[236:239], v[196:199]
    ds_read_b128 v[20:23], v5 offset:50176
    buffer_load_dwordx4 v[240:243], v5, s[8:11], s65 offen offset:0 sc1
    v_mfma_f32_16x16x32_bf16 v[196:199], v[16:19], a[228:231], v[196:199]
    s_waitcnt lgkmcnt(5)
    ds_read_b128 v[16:19], v5 offset:45056
    v_mfma_f32_16x16x32_bf16 v[132:135], v[24:27], a[228:231], v[132:135]
    v_mfma_f32_16x16x32_bf16 v[132:135], v[28:31], a[236:239], v[132:135]
    buffer_load_dwordx4 v[244:247], v5, s[8:11], s65 offen offset:1024 sc1
    v_mfma_f32_16x16x32_bf16 v[128:131], v[28:31], a[232:235], v[128:131]
    ds_read_b128 v[28:31], v5 offset:56320
    v_mfma_f32_16x16x32_bf16 v[128:131], v[24:27], a[224:227], v[128:131]
    s_waitcnt lgkmcnt(5)
    ds_read_b128 v[24:27], v5 offset:51200
    v_mfma_f32_16x16x32_bf16 v[136:139], v[208:211], a[224:227], v[136:139]
    buffer_load_dwordx4 v[248:251], v5, s[8:11], s65 offen offset:2048 sc1
    v_mfma_f32_16x16x32_bf16 v[136:139], v[212:215], a[232:235], v[136:139]
    v_mfma_f32_16x16x32_bf16 v[140:143], v[212:215], a[236:239], v[140:143]
    ds_read_b128 v[212:215], v5 offset:57344
    v_mfma_f32_16x16x32_bf16 v[140:143], v[208:211], a[228:231], v[140:143]
    s_waitcnt lgkmcnt(5)
    ds_read_b128 v[208:211], v5 offset:52224
    buffer_load_dwordx4 v[252:255], v5, s[8:11], s65 offen offset:3072 sc1
    v_mfma_f32_16x16x32_bf16 v[148:151], v[216:219], a[228:231], v[148:151]
    s_add_u32 s65, s65, 4096
    v_mfma_f32_16x16x32_bf16 v[148:151], v[220:223], a[236:239], v[148:151]
    v_mfma_f32_16x16x32_bf16 v[144:147], v[220:223], a[232:235], v[144:147]
    ds_read_b128 v[220:223], v5 offset:58368
    v_mfma_f32_16x16x32_bf16 v[144:147], v[216:219], a[224:227], v[144:147]
    s_waitcnt lgkmcnt(5)
    ds_read_b128 v[216:219], v5 offset:53248
    buffer_load_dwordx4 v[96:99], v5, s[8:11], s65 offen offset:0 sc1
    v_mfma_f32_16x16x32_bf16 v[152:155], v[16:19], a[224:227], v[152:155]
    v_mfma_f32_16x16x32_bf16 v[152:155], v[20:23], a[232:235], v[152:155]
    buffer_load_dwordx4 v[100:103], v5, s[8:11], s65 offen offset:1024 sc1
    v_mfma_f32_16x16x32_bf16 v[156:159], v[20:23], a[236:239], v[156:159]
    ds_read_b128 v[20:23], v5 offset:59392
    v_mfma_f32_16x16x32_bf16 v[156:159], v[16:19], a[228:231], v[156:159]
    s_waitcnt vmcnt(12) lgkmcnt(5)
    ds_read_b128 v[16:19], v5 offset:54272
    v_mfma_f32_16x16x32_bf16 v[196:199], v[24:27], a[244:247], v[196:199]
    s_waitcnt vmcnt(10)
    buffer_load_dwordx4 v[104:107], v5, s[8:11], s65 offen offset:2048 sc1
    v_mfma_f32_16x16x32_bf16 v[196:199], v[28:31], a[252:255], v[196:199]
    v_mfma_f32_16x16x32_bf16 v[192:195], v[28:31], a[248:251], v[192:195]
    ds_read_b128 v[28:31], v5 offset:60416
    v_mfma_f32_16x16x32_bf16 v[192:195], v[24:27], a[240:243], v[192:195]
    s_waitcnt lgkmcnt(5)
    ds_read_b128 v[24:27], v5 offset:55296
    buffer_load_dwordx4 v[108:111], v5, s[8:11], s65 offen offset:3072 sc1
    v_mfma_f32_16x16x32_bf16 v[128:131], v[208:211], a[240:243], v[128:131]
    s_add_u32 s65, s65, 4096
    v_mfma_f32_16x16x32_bf16 v[128:131], v[212:215], a[248:251], v[128:131]
    v_mfma_f32_16x16x32_bf16 v[132:135], v[212:215], a[252:255], v[132:135]
    ds_read_b128 v[212:215], v7 offset:27648
    v_mfma_f32_16x16x32_bf16 v[132:135], v[208:211], a[244:247], v[132:135]
    s_waitcnt lgkmcnt(5)
    ds_read_b128 v[208:211], v7 offset:24576
    buffer_load_dwordx4 v[112:115], v5, s[8:11], s65 offen offset:0 sc1
    v_mfma_f32_16x16x32_bf16 v[140:143], v[216:219], a[244:247], v[140:143]
    v_mfma_f32_16x16x32_bf16 v[140:143], v[220:223], a[252:255], v[140:143]
    buffer_load_dwordx4 v[116:119], v5, s[8:11], s65 offen offset:1024 sc1
    v_mfma_f32_16x16x32_bf16 v[136:139], v[220:223], a[248:251], v[136:139]
    ds_read_b128 v[220:223], v7 offset:28672
    v_mfma_f32_16x16x32_bf16 v[136:139], v[216:219], a[240:243], v[136:139]
    s_waitcnt lgkmcnt(5)
    ds_read_b128 v[216:219], v7 offset:25600
    v_mfma_f32_16x16x32_bf16 v[144:147], v[16:19], a[240:243], v[144:147]
    buffer_load_dwordx4 v[120:123], v5, s[8:11], s65 offen offset:2048 sc1
    v_mfma_f32_16x16x32_bf16 v[144:147], v[20:23], a[248:251], v[144:147]
    v_mfma_f32_16x16x32_bf16 v[148:151], v[20:23], a[252:255], v[148:151]
    ds_read_b128 v[20:23], v7 offset:29696
    v_mfma_f32_16x16x32_bf16 v[148:151], v[16:19], a[244:247], v[148:151]
    s_waitcnt lgkmcnt(5)
    ds_read_b128 v[16:19], v7 offset:26624
    buffer_load_dwordx4 v[124:127], v5, s[8:11], s65 offen offset:3072 sc1
    v_mfma_f32_16x16x32_bf16 v[156:159], v[24:27], a[244:247], v[156:159]
    s_add_u32 s65, s65, 4096
    v_mfma_f32_16x16x32_bf16 v[156:159], v[28:31], a[252:255], v[156:159]
    v_mfma_f32_16x16x32_bf16 v[152:155], v[28:31], a[248:251], v[152:155]
    s_barrier
    ds_read_b128 v[28:31], v7 offset:33792
    v_mfma_f32_16x16x32_bf16 v[152:155], v[24:27], a[240:243], v[152:155]
    s_waitcnt vmcnt(15) lgkmcnt(5)
    ds_read_b128 v[24:27], v7 offset:30720
    buffer_load_dwordx4 v[32:35], v5, s[8:11], s65 offen offset:0 sc1
    v_mfma_f32_16x16x32_bf16 v[192:195], v[208:211], v[224:227], v[192:195]
    s_waitcnt vmcnt(14)
    v_mfma_f32_16x16x32_bf16 v[192:195], v[212:215], v[232:235], v[192:195]
    s_waitcnt vmcnt(13)
    buffer_load_dwordx4 v[36:39], v5, s[8:11], s65 offen offset:1024 sc1
    v_mfma_f32_16x16x32_bf16 v[196:199], v[212:215], v[236:239], v[196:199]
    ds_read_b128 v[212:215], v7 offset:34816
    v_mfma_f32_16x16x32_bf16 v[196:199], v[208:211], v[228:231], v[196:199]
    s_waitcnt lgkmcnt(5)
    ds_read_b128 v[208:211], v7 offset:31744
    v_mfma_f32_16x16x32_bf16 v[132:135], v[216:219], v[228:231], v[132:135]
    buffer_load_dwordx4 v[40:43], v5, s[8:11], s65 offen offset:2048 sc1
    v_mfma_f32_16x16x32_bf16 v[132:135], v[220:223], v[236:239], v[132:135]
    v_mfma_f32_16x16x32_bf16 v[128:131], v[220:223], v[232:235], v[128:131]
    ds_read_b128 v[220:223], v7 offset:35840
    v_mfma_f32_16x16x32_bf16 v[128:131], v[216:219], v[224:227], v[128:131]
    s_waitcnt lgkmcnt(5)
    ds_read_b128 v[216:219], v7 offset:32768
    buffer_load_dwordx4 v[44:47], v5, s[8:11], s65 offen offset:3072 sc1
    v_mfma_f32_16x16x32_bf16 v[136:139], v[16:19], v[224:227], v[136:139]
    s_add_u32 m0, s19, 155648
    s_add_u32 s66, s66, 4096
    v_mfma_f32_16x16x32_bf16 v[136:139], v[20:23], v[232:235], v[136:139]
    v_mfma_f32_16x16x32_bf16 v[140:143], v[20:23], v[236:239], v[140:143]
    ds_read_b128 v[20:23], v7 offset:39936
    v_mfma_f32_16x16x32_bf16 v[140:143], v[16:19], v[228:231], v[140:143]
    s_waitcnt vmcnt(14) lgkmcnt(5)
    ds_read_b128 v[16:19], v7 offset:36864
    v_mfma_f32_16x16x32_bf16 v[196:199], v[24:27], v[244:247], v[196:199]
    s_waitcnt vmcnt(12)
    buffer_load_dwordx4 v5, s[8:11], s66 offen sc1 lds
    v_mfma_f32_16x16x32_bf16 v[196:199], v[28:31], v[252:255], v[196:199]
    s_add_u32 m0, s19, 159744
    s_add_u32 s66, s66, 4096
    v_mfma_f32_16x16x32_bf16 v[192:195], v[28:31], v[248:251], v[192:195]
    ds_read_b128 v[28:31], v7 offset:40960
    v_mfma_f32_16x16x32_bf16 v[192:195], v[24:27], v[240:243], v[192:195]
    s_waitcnt lgkmcnt(5)
    ds_read_b128 v[24:27], v7 offset:37888
    buffer_load_dwordx4 v5, s[8:11], s66 offen sc1 lds
    v_mfma_f32_16x16x32_bf16 v[128:131], v[208:211], v[240:243], v[128:131]
    s_add_u32 m0, s19, 61440
    s_add_u32 s66, s66, 4096
    v_mfma_f32_16x16x32_bf16 v[128:131], v[212:215], v[248:251], v[128:131]
    v_mfma_f32_16x16x32_bf16 v[132:135], v[212:215], v[252:255], v[132:135]
    ds_read_b128 v[212:215], v7 offset:41984
    v_mfma_f32_16x16x32_bf16 v[132:135], v[208:211], v[244:247], v[132:135]
    s_waitcnt lgkmcnt(5)
    ds_read_b128 v[208:211], v7 offset:38912
    v_mfma_f32_16x16x32_bf16 v[140:143], v[216:219], v[244:247], v[140:143]
    buffer_load_dwordx4 v5, s[8:11], s66 offen sc1 lds
    v_mfma_f32_16x16x32_bf16 v[140:143], v[220:223], v[252:255], v[140:143]
    s_add_u32 m0, s19, 65536
    s_add_u32 s66, s66, 4096
    v_mfma_f32_16x16x32_bf16 v[136:139], v[220:223], v[248:251], v[136:139]
    ds_read_b128 v[220:223], v7 offset:46080
    v_mfma_f32_16x16x32_bf16 v[136:139], v[216:219], v[240:243], v[136:139]
    s_waitcnt vmcnt(14) lgkmcnt(5)
    ds_read_b128 v[216:219], v7 offset:43008
    v_mfma_f32_16x16x32_bf16 v[192:195], v[16:19], v[96:99], v[192:195]
    s_waitcnt vmcnt(12)
    v_mfma_f32_16x16x32_bf16 v[192:195], v[20:23], v[104:107], v[192:195]
    s_waitcnt vmcnt(11)
    buffer_load_dwordx4 v5, s[8:11], s66 offen sc1 lds
    v_mfma_f32_16x16x32_bf16 v[196:199], v[20:23], v[108:111], v[196:199]
    s_add_u32 m0, s19, 69632
    ds_read_b128 v[20:23], v7 offset:47104
    s_add_u32 s66, s66, 4096
    v_mfma_f32_16x16x32_bf16 v[196:199], v[16:19], v[100:103], v[196:199]
    s_waitcnt lgkmcnt(5)
    ds_read_b128 v[16:19], v7 offset:44032
    v_mfma_f32_16x16x32_bf16 v[132:135], v[24:27], v[100:103], v[132:135]
    v_mfma_f32_16x16x32_bf16 v[132:135], v[28:31], v[108:111], v[132:135]
    v_mfma_f32_16x16x32_bf16 v[128:131], v[28:31], v[104:107], v[128:131]
    ds_read_b128 v[28:31], v7 offset:48128
    buffer_load_dwordx4 v5, s[8:11], s66 offen sc1 lds
    v_mfma_f32_16x16x32_bf16 v[128:131], v[24:27], v[96:99], v[128:131]
    s_waitcnt lgkmcnt(5)
    ds_read_b128 v[24:27], v7 offset:45056
    s_add_u32 m0, s19, 73728
    v_mfma_f32_16x16x32_bf16 v[136:139], v[208:211], v[96:99], v[136:139]
    s_add_u32 s66, s66, 4096
    v_mfma_f32_16x16x32_bf16 v[136:139], v[212:215], v[104:107], v[136:139]
    v_mfma_f32_16x16x32_bf16 v[140:143], v[212:215], v[108:111], v[140:143]
    ds_read_b128 v[212:215], v7 offset:52224
    v_mfma_f32_16x16x32_bf16 v[140:143], v[208:211], v[100:103], v[140:143]
    s_waitcnt vmcnt(11) lgkmcnt(5)
    ds_read_b128 v[208:211], v7 offset:49152
    buffer_load_dwordx4 v5, s[8:11], s66 offen sc1 lds
    v_mfma_f32_16x16x32_bf16 v[196:199], v[216:219], v[116:119], v[196:199]
    s_waitcnt vmcnt(10)
    s_add_u32 m0, s19, 77824
    s_add_u32 s66, s66, 4096
    v_mfma_f32_16x16x32_bf16 v[196:199], v[220:223], v[124:127], v[196:199]
    v_mfma_f32_16x16x32_bf16 v[192:195], v[220:223], v[120:123], v[192:195]
    ds_read_b128 v[220:223], v7 offset:53248
    v_mfma_f32_16x16x32_bf16 v[192:195], v[216:219], v[112:115], v[192:195]
    s_waitcnt lgkmcnt(5)
    ds_read_b128 v[216:219], v7 offset:50176
    v_mfma_f32_16x16x32_bf16 v[128:131], v[16:19], v[112:115], v[128:131]
    buffer_load_dwordx4 v5, s[8:11], s66 offen sc1 lds
    v_mfma_f32_16x16x32_bf16 v[128:131], v[20:23], v[120:123], v[128:131]
    s_add_u32 m0, s19, 81920
    s_add_u32 s66, s66, 4096
    v_mfma_f32_16x16x32_bf16 v[132:135], v[20:23], v[124:127], v[132:135]
    ds_read_b128 v[20:23], v7 offset:54272
    v_mfma_f32_16x16x32_bf16 v[132:135], v[16:19], v[116:119], v[132:135]
    s_waitcnt lgkmcnt(5)
    ds_read_b128 v[16:19], v7 offset:51200
    v_mfma_f32_16x16x32_bf16 v[140:143], v[24:27], v[116:119], v[140:143]
    v_mfma_f32_16x16x32_bf16 v[140:143], v[28:31], v[124:127], v[140:143]
    buffer_load_dwordx4 v5, s[8:11], s66 offen sc1 lds
    v_mfma_f32_16x16x32_bf16 v[136:139], v[28:31], v[120:123], v[136:139]
    s_add_u32 m0, s19, 86016
    ds_read_b128 v[28:31], v7 offset:57344
    s_add_u32 s66, s66, 4096
    v_mfma_f32_16x16x32_bf16 v[136:139], v[24:27], v[112:115], v[136:139]
    s_waitcnt vmcnt(11) lgkmcnt(5)
    ds_read_b128 v[24:27], v7 offset:55296
    v_mfma_f32_16x16x32_bf16 v[192:195], v[208:211], v[32:35], v[192:195]
    s_waitcnt vmcnt(9)
    v_mfma_f32_16x16x32_bf16 v[192:195], v[212:215], v[40:43], v[192:195]
    s_waitcnt vmcnt(8)
    v_mfma_f32_16x16x32_bf16 v[196:199], v[212:215], v[44:47], v[196:199]
    ds_read_b128 v[212:215], v7 offset:58368
    buffer_load_dwordx4 v5, s[8:11], s66 offen sc1 lds
    v_mfma_f32_16x16x32_bf16 v[196:199], v[208:211], v[36:39], v[196:199]
    s_waitcnt lgkmcnt(5)
    ds_read_b128 v[208:211], v7 offset:56320
    s_add_u32 m0, s19, 0
    v_mfma_f32_16x16x32_bf16 v[132:135], v[216:219], v[36:39], v[132:135]
    s_add_u32 s66, s66, 4096
    v_mfma_f32_16x16x32_bf16 v[132:135], v[220:223], v[44:47], v[132:135]
    v_mfma_f32_16x16x32_bf16 v[128:131], v[220:223], v[40:43], v[128:131]
    ds_read_b128 v[220:223], v7 offset:61440
    v_mfma_f32_16x16x32_bf16 v[128:131], v[216:219], v[32:35], v[128:131]
    s_waitcnt lgkmcnt(5)
    ds_read_b128 v[216:219], v7 offset:59392
    buffer_load_dwordx4 v5, s[8:11], s66 offen sc1 lds
    v_mfma_f32_16x16x32_bf16 v[136:139], v[16:19], v[32:35], v[136:139]
    s_add_u32 m0, s19, 4096
    v_cvt_pk_bf16_f32 v192, v192, v193
    v_cvt_pk_bf16_f32 v193, v194, v195
    v_mfma_f32_16x16x32_bf16 v[136:139], v[20:23], v[40:43], v[136:139]
    s_add_u32 s66, s66, 4096
    v_cvt_pk_bf16_f32 v194, v196, v197
    v_cvt_pk_bf16_f32 v195, v198, v199
    v_mfma_f32_16x16x32_bf16 v[140:143], v[20:23], v[44:47], v[140:143]
    ds_read_b128 v[20:23], v7 offset:62464
    buffer_store_dwordx4 v[192:195], v5, s[8:11], s36 offen sc1
    v_mfma_f32_16x16x32_bf16 v[140:143], v[16:19], v[36:39], v[140:143]
    s_waitcnt lgkmcnt(5)
    ds_read_b128 v[16:19], v7 offset:60416
    v_mfma_f32_16x16x32_bf16 v[148:151], v[24:27], v[228:231], v[148:151]
    buffer_load_dwordx4 v5, s[8:11], s66 offen sc1 lds
    v_mfma_f32_16x16x32_bf16 v[148:151], v[28:31], v[236:239], v[148:151]
    s_add_u32 m0, s19, 8192
    s_add_u32 s66, s66, 4096
    v_mfma_f32_16x16x32_bf16 v[144:147], v[28:31], v[232:235], v[144:147]
    s_waitcnt vmcnt(10)
    s_barrier
    ds_read_b128 v[28:31], v12 offset:0
    v_mfma_f32_16x16x32_bf16 v[144:147], v[24:27], v[224:227], v[144:147]
    s_waitcnt lgkmcnt(5)
    ds_read_b128 v[24:27], v7 offset:63488
    v_cvt_pk_bf16_f32 v128, v128, v129
    v_mfma_f32_16x16x32_bf16 v[152:155], v[208:211], v[224:227], v[152:155]
    v_cvt_pk_bf16_f32 v129, v130, v131
    v_cvt_pk_bf16_f32 v130, v136, v137
    v_mfma_f32_16x16x32_bf16 v[152:155], v[212:215], v[232:235], v[152:155]
    buffer_load_dwordx4 v5, s[8:11], s66 offen sc1 lds
    v_cvt_pk_bf16_f32 v131, v138, v139
    v_mfma_f32_16x16x32_bf16 v[156:159], v[212:215], v[236:239], v[156:159]
    s_add_u32 m0, s19, 12288
    ds_read_b128 v[212:215], v12 offset:1024
    buffer_store_dwordx4 v[128:131], v5, s[8:11], s20 offen offset:0 sc1
    v_mfma_f32_16x16x32_bf16 v[156:159], v[208:211], v[228:231], v[156:159]
    s_waitcnt lgkmcnt(5)
    ds_read_b128 v[208:211], v7 offset:64512
    v_cvt_pk_bf16_f32 v132, v132, v133
    v_mfma_f32_16x16x32_bf16 v[148:151], v[216:219], v[244:247], v[148:151]
    s_add_u32 s66, s66, 4096
    v_cvt_pk_bf16_f32 v133, v134, v135
    v_cvt_pk_bf16_f32 v134, v140, v141
    v_mfma_f32_16x16x32_bf16 v[148:151], v[220:223], v[252:255], v[148:151]
    v_cvt_pk_bf16_f32 v135, v142, v143
    v_mfma_f32_16x16x32_bf16 v[144:147], v[220:223], v[248:251], v[144:147]
    ds_read_b128 v[220:223], v12 offset:4096
    buffer_load_dwordx4 v5, s[8:11], s66 offen sc1 lds
    v_mfma_f32_16x16x32_bf16 v[144:147], v[216:219], v[240:243], v[144:147]
    s_waitcnt lgkmcnt(5)
    ds_read_b128 v[216:219], v12 offset:2048
    s_add_u32 m0, s19, 16384
    v_mfma_f32_16x16x32_bf16 v[152:155], v[16:19], v[240:243], v[152:155]
    s_add_u32 s66, s66, 4096
    buffer_store_dwordx4 v[132:135], v5, s[8:11], s20 offen offset:1024 sc1
    v_mfma_f32_16x16x32_bf16 v[152:155], v[20:23], v[248:251], v[152:155]
    v_mfma_f32_16x16x32_bf16 v[156:159], v[20:23], v[252:255], v[156:159]
    ds_read_b128 v[20:23], v12 offset:5120
    v_mfma_f32_16x16x32_bf16 v[156:159], v[16:19], v[244:247], v[156:159]
    s_waitcnt lgkmcnt(5)
    ds_read_b128 v[16:19], v12 offset:3072
    buffer_load_dwordx4 v5, s[8:11], s66 offen sc1 lds
    v_mfma_f32_16x16x32_bf16 v[148:151], v[24:27], v[100:103], v[148:151]
    s_add_u32 m0, s19, 20480
    s_add_u32 s66, s66, 4096
    v_mfma_f32_16x16x32_bf16 v[148:151], v[28:31], v[108:111], v[148:151]
    v_mfma_f32_16x16x32_bf16 v[144:147], v[28:31], v[104:107], v[144:147]
    ds_read_b128 v[28:31], v12 offset:8192
    v_mfma_f32_16x16x32_bf16 v[144:147], v[24:27], v[96:99], v[144:147]
    s_waitcnt lgkmcnt(5)
    ds_read_b128 v[24:27], v12 offset:6144
    v_mfma_f32_16x16x32_bf16 v[152:155], v[208:211], v[96:99], v[152:155]
    buffer_load_dwordx4 v5, s[8:11], s66 offen sc1 lds
    v_mfma_f32_16x16x32_bf16 v[152:155], v[212:215], v[104:107], v[152:155]
    s_add_u32 m0, s19, 24576
    s_add_u32 s66, s66, 4096
    v_mfma_f32_16x16x32_bf16 v[156:159], v[212:215], v[108:111], v[156:159]
    ds_read_b128 v[212:215], v12 offset:9216
    v_mfma_f32_16x16x32_bf16 v[156:159], v[208:211], v[100:103], v[156:159]
    s_waitcnt lgkmcnt(5)
    ds_read_b128 v[208:211], v12 offset:7168
    v_mfma_f32_16x16x32_bf16 v[148:151], v[216:219], v[116:119], v[148:151]
    v_mfma_f32_16x16x32_bf16 v[148:151], v[220:223], v[124:127], v[148:151]
    buffer_load_dwordx4 v5, s[8:11], s66 offen sc1 lds
    v_mfma_f32_16x16x32_bf16 v[144:147], v[220:223], v[120:123], v[144:147]
    s_add_u32 m0, s19, 28672
    ds_read_b128 v[220:223], v12 offset:12288
    s_add_u32 s66, s66, 4096
    v_mfma_f32_16x16x32_bf16 v[144:147], v[216:219], v[112:115], v[144:147]
    s_waitcnt lgkmcnt(5)
    ds_read_b128 v[216:219], v12 offset:10240
    v_mfma_f32_16x16x32_bf16 v[152:155], v[16:19], v[112:115], v[152:155]
    v_mfma_f32_16x16x32_bf16 v[152:155], v[20:23], v[120:123], v[152:155]
    v_mfma_f32_16x16x32_bf16 v[156:159], v[20:23], v[124:127], v[156:159]
    ds_read_b128 v[20:23], v12 offset:13312
    buffer_load_dwordx4 v5, s[8:11], s66 offen sc1 lds
    v_mfma_f32_16x16x32_bf16 v[156:159], v[16:19], v[116:119], v[156:159]
    s_waitcnt lgkmcnt(5)
    ds_read_b128 v[16:19], v12 offset:11264
    s_add_u32 m0, s19, 32768
    v_mfma_f32_16x16x32_bf16 v[148:151], v[24:27], v[36:39], v[148:151]
    s_add_u32 s66, s66, 4096
    v_mfma_f32_16x16x32_bf16 v[148:151], v[28:31], v[44:47], v[148:151]
    v_mfma_f32_16x16x32_bf16 v[144:147], v[28:31], v[40:43], v[144:147]
    ds_read_b128 v[28:31], v12 offset:16384
    v_mfma_f32_16x16x32_bf16 v[144:147], v[24:27], v[32:35], v[144:147]
    s_waitcnt lgkmcnt(5)
    ds_read_b128 v[24:27], v12 offset:14336
    buffer_load_dwordx4 v5, s[8:11], s66 offen sc1 lds
    v_mfma_f32_16x16x32_bf16 v[152:155], v[208:211], v[32:35], v[152:155]
    s_add_u32 m0, s19, 36864
    s_add_u32 s66, s66, 4096
    v_mfma_f32_16x16x32_bf16 v[152:155], v[212:215], v[40:43], v[152:155]
    v_mfma_f32_16x16x32_bf16 v[156:159], v[212:215], v[44:47], v[156:159]
    ds_read_b128 v[212:215], v12 offset:17408
    v_mfma_f32_16x16x32_bf16 v[156:159], v[208:211], v[36:39], v[156:159]
    s_waitcnt lgkmcnt(5)
    ds_read_b128 v[208:211], v12 offset:15360
    v_mfma_f32_16x16x32_bf16 v[68:71], v[216:219], a[4:7], 0
    buffer_load_dwordx4 v5, s[8:11], s66 offen sc1 lds
    v_mfma_f32_16x16x32_bf16 v[68:71], v[220:223], a[12:15], v[68:71]
    s_add_u32 m0, s19, 40960
    s_add_u32 s66, s66, 4096
    v_mfma_f32_16x16x32_bf16 v[64:67], v[220:223], a[8:11], 0
    ds_read_b128 v[220:223], v12 offset:20480
    v_cvt_pk_bf16_f32 v144, v144, v145
    v_mfma_f32_16x16x32_bf16 v[64:67], v[216:219], a[0:3], v[64:67]
    s_waitcnt lgkmcnt(5)
    ds_read_b128 v[216:219], v12 offset:18432
    v_cvt_pk_bf16_f32 v145, v146, v147
    v_mfma_f32_16x16x32_bf16 v[72:75], v[16:19], a[0:3], 0
    v_cvt_pk_bf16_f32 v146, v152, v153
    v_cvt_pk_bf16_f32 v147, v154, v155
    v_mfma_f32_16x16x32_bf16 v[72:75], v[20:23], a[8:11], v[72:75]
    buffer_load_dwordx4 v5, s[8:11], s66 offen sc1 lds
    buffer_store_dwordx4 v[144:147], v5, s[8:11], s21 offen offset:0 sc1
    v_mfma_f32_16x16x32_bf16 v[76:79], v[20:23], a[12:15], 0
    s_add_u32 m0, s19, 45056
    ds_read_b128 v[20:23], v12 offset:21504
    v_cvt_pk_bf16_f32 v148, v148, v149
    v_mfma_f32_16x16x32_bf16 v[76:79], v[16:19], a[4:7], v[76:79]
    s_waitcnt lgkmcnt(5)
    ds_read_b128 v[16:19], v12 offset:19456
    v_cvt_pk_bf16_f32 v149, v150, v151
    v_mfma_f32_16x16x32_bf16 v[68:71], v[24:27], a[20:23], v[68:71]
    s_add_u32 s66, s66, 4096
    v_cvt_pk_bf16_f32 v150, v156, v157
    v_cvt_pk_bf16_f32 v151, v158, v159
    v_mfma_f32_16x16x32_bf16 v[68:71], v[28:31], a[28:31], v[68:71]
    v_mfma_f32_16x16x32_bf16 v[64:67], v[28:31], a[24:27], v[64:67]
    ds_read_b128 v[28:31], v12 offset:24576
    buffer_load_dwordx4 v5, s[8:11], s66 offen sc1 lds
    v_mfma_f32_16x16x32_bf16 v[64:67], v[24:27], a[16:19], v[64:67]
    s_waitcnt lgkmcnt(5)
    ds_read_b128 v[24:27], v12 offset:22528
    buffer_store_dwordx4 v[148:151], v5, s[8:11], s21 offen offset:1024 sc1
    v_mfma_f32_16x16x32_bf16 v[72:75], v[208:211], a[16:19], v[72:75]
    s_add_u32 s28, s44, 1
    v_mov_b32 v15, s28
    v_mfma_f32_16x16x32_bf16 v[72:75], v[212:215], a[24:27], v[72:75]
    s_add_u32 m0, s19, 49152
    v_lshlrev_b32 v168, 16, v200
    s_add_u32 s66, s66, 4096
    v_mfma_f32_16x16x32_bf16 v[76:79], v[212:215], a[28:31], v[76:79]
    ds_read_b128 v[212:215], v12 offset:25600
    v_and_b32 v169, s47, v200
    v_mfma_f32_16x16x32_bf16 v[76:79], v[208:211], a[20:23], v[76:79]
    s_waitcnt lgkmcnt(5)
    ds_read_b128 v[208:211], v12 offset:23552
    buffer_load_dwordx4 v5, s[8:11], s66 offen sc1 lds
    v_mfma_f32_16x16x32_bf16 v[68:71], v[216:219], a[36:39], v[68:71]
    s_add_u32 m0, s19, 53248
    v_lshlrev_b32 v170, 16, v201
    s_add_u32 s66, s66, 4096
    v_mfma_f32_16x16x32_bf16 v[68:71], v[220:223], a[44:47], v[68:71]
    v_and_b32 v171, s47, v201
    v_mfma_f32_16x16x32_bf16 v[64:67], v[220:223], a[40:43], v[64:67]
    ds_read_b128 v[220:223], v12 offset:28672
    v_lshlrev_b32 v172, 16, v202
    v_mfma_f32_16x16x32_bf16 v[64:67], v[216:219], a[32:35], v[64:67]
    s_waitcnt lgkmcnt(5)
    ds_read_b128 v[216:219], v12 offset:26624
    v_and_b32 v173, s47, v202
    v_mfma_f32_16x16x32_bf16 v[72:75], v[16:19], a[32:35], v[72:75]
    buffer_load_dwordx4 v5, s[8:11], s66 offen sc1 lds
    v_lshlrev_b32 v174, 16, v203
    v_mfma_f32_16x16x32_bf16 v[72:75], v[20:23], a[40:43], v[72:75]
    s_add_u32 m0, s19, 57344
    v_and_b32 v175, s47, v203
    s_add_u32 s66, s66, 4096
    v_mfma_f32_16x16x32_bf16 v[76:79], v[20:23], a[44:47], v[76:79]
    ds_read_b128 v[20:23], v12 offset:29696
    v_lshlrev_b32 v184, 16, v204
    v_mfma_f32_16x16x32_bf16 v[76:79], v[16:19], a[36:39], v[76:79]
    s_waitcnt lgkmcnt(5)
    ds_read_b128 v[16:19], v12 offset:27648
    v_and_b32 v185, s47, v204
    v_mfma_f32_16x16x32_bf16 v[68:71], v[24:27], a[52:55], v[68:71]
    v_lshlrev_b32 v186, 16, v205
    v_mfma_f32_16x16x32_bf16 v[68:71], v[28:31], a[60:63], v[68:71]
    buffer_load_dwordx4 v5, s[8:11], s66 offen sc1 lds
    v_and_b32 v187, s47, v205
    v_mfma_f32_16x16x32_bf16 v[64:67], v[28:31], a[56:59], v[64:67]
    s_waitcnt vmcnt(19)
    s_barrier
    ds_read_b128 v[28:31], v5 offset:61440
    v_mfma_f32_16x16x32_bf16 v[64:67], v[24:27], a[48:51], v[64:67]
    s_waitcnt lgkmcnt(5)
    ds_read_b128 v[24:27], v12 offset:30720
    v_lshlrev_b32 v188, 16, v206
    v_mfma_f32_16x16x32_bf16 v[72:75], v[208:211], a[48:51], v[72:75]
    s_add_u32 m0, s19, 90112
    v_and_b32 v189, s47, v206
    s_add_u32 s66, s66, 4096
    v_mfma_f32_16x16x32_bf16 v[72:75], v[212:215], a[56:59], v[72:75]
    v_lshlrev_b32 v190, 16, v207
    v_mfma_f32_16x16x32_bf16 v[76:79], v[212:215], a[60:63], v[76:79]
    ds_read_b128 v[212:215], v5 offset:62464
    buffer_load_dwordx4 v5, s[8:11], s66 offen sc1 lds
    v_mfma_f32_16x16x32_bf16 v[76:79], v[208:211], a[52:55], v[76:79]
    s_waitcnt lgkmcnt(5)
    ds_read_b128 v[208:211], v12 offset:31744
    v_and_b32 v191, s47, v207
    v_mfma_f32_16x16x32_bf16 v[68:71], v[216:219], a[68:71], v[68:71]
    s_add_u32 m0, s19, 94208
    s_add_u32 s66, s66, 4096
    v_mfma_f32_16x16x32_bf16 v[68:71], v[220:223], a[76:79], v[68:71]
    v_mfma_f32_16x16x32_bf16 v[64:67], v[220:223], a[72:75], v[64:67]
    ds_read_b128 v[220:223], v7 offset:0
    v_mfma_f32_16x16x32_bf16 v[64:67], v[216:219], a[64:67], v[64:67]
    s_waitcnt lgkmcnt(5)
    ds_read_b128 v[216:219], v5 offset:63488
    buffer_load_dwordx4 v5, s[8:11], s66 offen sc1 lds
    v_mfma_f32_16x16x32_bf16 v[72:75], v[16:19], a[64:67], v[72:75]
    s_add_u32 m0, s19, 98304
    s_add_u32 s66, s66, 4096
    v_mfma_f32_16x16x32_bf16 v[72:75], v[20:23], a[72:75], v[72:75]
    v_mfma_f32_16x16x32_bf16 v[76:79], v[20:23], a[76:79], v[76:79]
    ds_read_b128 v[20:23], v7 offset:1024
    v_mfma_f32_16x16x32_bf16 v[76:79], v[16:19], a[68:71], v[76:79]
    s_waitcnt lgkmcnt(5)
    ds_read_b128 v[16:19], v5 offset:64512
    v_mfma_f32_16x16x32_bf16 v[68:71], v[24:27], a[84:87], v[68:71]
    buffer_load_dwordx4 v5, s[8:11], s66 offen sc1 lds
    v_mfma_f32_16x16x32_bf16 v[68:71], v[28:31], a[92:95], v[68:71]
    s_add_u32 m0, s19, 102400
    s_add_u32 s66, s66, 4096
    v_mfma_f32_16x16x32_bf16 v[64:67], v[28:31], a[88:91], v[64:67]
    ds_read_b128 v[28:31], v7 offset:4096
    v_mfma_f32_16x16x32_bf16 v[64:67], v[24:27], a[80:83], v[64:67]
    s_waitcnt lgkmcnt(5)
    ds_read_b128 v[24:27], v7 offset:2048
    v_mfma_f32_16x16x32_bf16 v[72:75], v[208:211], a[80:83], v[72:75]
    v_mfma_f32_16x16x32_bf16 v[72:75], v[212:215], a[88:91], v[72:75]
    buffer_load_dwordx4 v5, s[8:11], s66 offen sc1 lds
    v_mfma_f32_16x16x32_bf16 v[76:79], v[212:215], a[92:95], v[76:79]
    s_add_u32 m0, s19, 106496
    ds_read_b128 v[212:215], v7 offset:5120
    s_add_u32 s66, s66, 4096
    v_mfma_f32_16x16x32_bf16 v[76:79], v[208:211], a[84:87], v[76:79]
    s_waitcnt lgkmcnt(5)
    ds_read_b128 v[208:211], v7 offset:3072
    v_mfma_f32_16x16x32_bf16 v[68:71], v[216:219], a[100:103], v[68:71]
    v_mfma_f32_16x16x32_bf16 v[68:71], v[220:223], a[108:111], v[68:71]
    v_mfma_f32_16x16x32_bf16 v[64:67], v[220:223], a[104:107], v[64:67]
    ds_read_b128 v[220:223], v7 offset:8192
    buffer_load_dwordx4 v5, s[8:11], s66 offen sc1 lds
    v_mfma_f32_16x16x32_bf16 v[64:67], v[216:219], a[96:99], v[64:67]
    s_waitcnt lgkmcnt(5)
    ds_read_b128 v[216:219], v7 offset:6144
    s_add_u32 m0, s19, 110592
    v_mfma_f32_16x16x32_bf16 v[72:75], v[16:19], a[96:99], v[72:75]
    s_add_u32 s66, s66, 4096
    v_mfma_f32_16x16x32_bf16 v[72:75], v[20:23], a[104:107], v[72:75]
    v_mfma_f32_16x16x32_bf16 v[76:79], v[20:23], a[108:111], v[76:79]
    ds_read_b128 v[20:23], v7 offset:9216
    v_mfma_f32_16x16x32_bf16 v[76:79], v[16:19], a[100:103], v[76:79]
    s_waitcnt lgkmcnt(5)
    ds_read_b128 v[16:19], v7 offset:7168
    buffer_load_dwordx4 v5, s[8:11], s66 offen sc1 lds
    v_mfma_f32_16x16x32_bf16 v[68:71], v[24:27], a[116:119], v[68:71]
    s_add_u32 m0, s19, 114688
    s_add_u32 s66, s66, 4096
    v_mfma_f32_16x16x32_bf16 v[68:71], v[28:31], a[124:127], v[68:71]
    v_mfma_f32_16x16x32_bf16 v[64:67], v[28:31], a[120:123], v[64:67]
    ds_read_b128 v[28:31], v7 offset:12288
    v_mfma_f32_16x16x32_bf16 v[64:67], v[24:27], a[112:115], v[64:67]
    s_waitcnt lgkmcnt(5)
    ds_read_b128 v[24:27], v7 offset:10240
    v_mfma_f32_16x16x32_bf16 v[72:75], v[208:211], a[112:115], v[72:75]
    buffer_load_dwordx4 v5, s[8:11], s66 offen sc1 lds
    v_mfma_f32_16x16x32_bf16 v[72:75], v[212:215], a[120:123], v[72:75]
    s_add_u32 m0, s19, 118784
    s_add_u32 s66, s66, 4096
    v_mfma_f32_16x16x32_bf16 v[76:79], v[212:215], a[124:127], v[76:79]
    ds_read_b128 v[212:215], v7 offset:13312
    v_mfma_f32_16x16x32_bf16 v[76:79], v[208:211], a[116:119], v[76:79]
    s_waitcnt lgkmcnt(5)
    ds_read_b128 v[208:211], v7 offset:11264
    v_mfma_f32_16x16x32_bf16 v[68:71], v[216:219], a[132:135], v[68:71]
    v_mfma_f32_16x16x32_bf16 v[68:71], v[220:223], a[140:143], v[68:71]
    buffer_load_dwordx4 v5, s[8:11], s66 offen sc1 lds
    v_mfma_f32_16x16x32_bf16 v[64:67], v[220:223], a[136:139], v[64:67]
    s_add_u32 m0, s19, 122880
    ds_read_b128 v[220:223], v7 offset:16384
    s_add_u32 s66, s66, 4096
    v_mfma_f32_16x16x32_bf16 v[64:67], v[216:219], a[128:131], v[64:67]
    s_waitcnt lgkmcnt(5)
    ds_read_b128 v[216:219], v7 offset:14336
    v_mfma_f32_16x16x32_bf16 v[72:75], v[16:19], a[128:131], v[72:75]
    v_mfma_f32_16x16x32_bf16 v[72:75], v[20:23], a[136:139], v[72:75]
    v_mfma_f32_16x16x32_bf16 v[76:79], v[20:23], a[140:143], v[76:79]
    ds_read_b128 v[20:23], v7 offset:17408
    buffer_load_dwordx4 v5, s[8:11], s66 offen sc1 lds
    v_mfma_f32_16x16x32_bf16 v[76:79], v[16:19], a[132:135], v[76:79]
    s_waitcnt lgkmcnt(5)
    ds_read_b128 v[16:19], v7 offset:15360
    s_add_u32 m0, s19, 126976
    v_mfma_f32_16x16x32_bf16 v[68:71], v[24:27], a[148:151], v[68:71]
    s_add_u32 s66, s66, 4096
    v_mfma_f32_16x16x32_bf16 v[68:71], v[28:31], a[156:159], v[68:71]
    v_mfma_f32_16x16x32_bf16 v[64:67], v[28:31], a[152:155], v[64:67]
    ds_read_b128 v[28:31], v7 offset:20480
    v_mfma_f32_16x16x32_bf16 v[64:67], v[24:27], a[144:147], v[64:67]
    s_waitcnt lgkmcnt(5)
    ds_read_b128 v[24:27], v7 offset:18432
    buffer_load_dwordx4 v5, s[8:11], s66 offen sc1 lds
    v_mfma_f32_16x16x32_bf16 v[72:75], v[208:211], a[144:147], v[72:75]
    s_add_u32 m0, s19, 131072
    s_add_u32 s66, s66, 4096
    v_mfma_f32_16x16x32_bf16 v[72:75], v[212:215], a[152:155], v[72:75]
    v_mfma_f32_16x16x32_bf16 v[76:79], v[212:215], a[156:159], v[76:79]
    ds_read_b128 v[212:215], v7 offset:21504
    v_mfma_f32_16x16x32_bf16 v[76:79], v[208:211], a[148:151], v[76:79]
    s_waitcnt lgkmcnt(5)
    ds_read_b128 v[208:211], v7 offset:19456
    v_mfma_f32_16x16x32_bf16 v[68:71], v[216:219], a[164:167], v[68:71]
    buffer_load_dwordx4 v5, s[8:11], s66 offen sc1 lds
    v_mfma_f32_16x16x32_bf16 v[68:71], v[220:223], a[172:175], v[68:71]
    s_add_u32 m0, s19, 135168
    s_add_u32 s66, s66, 4096
    v_mfma_f32_16x16x32_bf16 v[64:67], v[220:223], a[168:171], v[64:67]
    ds_read_b128 v[220:223], v5 offset:0
    v_mfma_f32_16x16x32_bf16 v[64:67], v[216:219], a[160:163], v[64:67]
    s_waitcnt lgkmcnt(5)
    ds_read_b128 v[216:219], v7 offset:22528
    v_mfma_f32_16x16x32_bf16 v[72:75], v[16:19], a[160:163], v[72:75]
    v_mfma_f32_16x16x32_bf16 v[72:75], v[20:23], a[168:171], v[72:75]
    buffer_load_dwordx4 v5, s[8:11], s66 offen sc1 lds
    v_mfma_f32_16x16x32_bf16 v[76:79], v[20:23], a[172:175], v[76:79]
    s_waitcnt vmcnt(15)
    ds_read_b128 v[20:23], v5 offset:1024
    buffer_store_dword v15, off, s[8:11], s31 sc1
    v_mfma_f32_16x16x32_bf16 v[76:79], v[16:19], a[164:167], v[76:79]
    s_waitcnt lgkmcnt(5)
    ds_read_b128 v[16:19], v7 offset:23552
    s_add_u32 m0, s19, 139264
    v_mfma_f32_16x16x32_bf16 v[68:71], v[24:27], a[180:183], v[68:71]
    s_add_u32 s66, s66, 4096
    v_mfma_f32_16x16x32_bf16 v[68:71], v[28:31], a[188:191], v[68:71]
    v_mfma_f32_16x16x32_bf16 v[64:67], v[28:31], a[184:187], v[64:67]
    s_barrier
    ds_read_b128 v[28:31], v5 offset:4096
    v_mfma_f32_16x16x32_bf16 v[64:67], v[24:27], a[176:179], v[64:67]
    s_waitcnt lgkmcnt(5)
    ds_read_b128 v[24:27], v5 offset:2048
    buffer_load_dwordx4 v5, s[8:11], s66 offen sc1 lds
    v_mfma_f32_16x16x32_bf16 v[72:75], v[208:211], a[176:179], v[72:75]
    s_add_u32 m0, s19, 143360
    s_add_u32 s66, s66, 4096
    v_mfma_f32_16x16x32_bf16 v[72:75], v[212:215], a[184:187], v[72:75]
    v_mfma_f32_16x16x32_bf16 v[76:79], v[212:215], a[188:191], v[76:79]
    ds_read_b128 v[212:215], v5 offset:5120
    v_mfma_f32_16x16x32_bf16 v[76:79], v[208:211], a[180:183], v[76:79]
    s_waitcnt lgkmcnt(5)
    ds_read_b128 v[208:211], v5 offset:3072
    buffer_load_dwordx4 v5, s[8:11], s66 offen sc1 lds
    v_mfma_f32_16x16x32_bf16 v[68:71], v[216:219], a[196:199], v[68:71]
    s_add_u32 m0, s19, 147456
    s_add_u32 s66, s66, 4096
    v_mfma_f32_16x16x32_bf16 v[68:71], v[220:223], a[204:207], v[68:71]
    v_mfma_f32_16x16x32_bf16 v[64:67], v[220:223], a[200:203], v[64:67]
    ds_read_b128 v[220:223], v5 offset:8192
    v_mfma_f32_16x16x32_bf16 v[64:67], v[216:219], a[192:195], v[64:67]
    s_waitcnt lgkmcnt(5)
    ds_read_b128 v[216:219], v5 offset:6144
    v_mfma_f32_16x16x32_bf16 v[72:75], v[16:19], a[192:195], v[72:75]
    buffer_load_dwordx4 v5, s[8:11], s66 offen sc1 lds
    v_mfma_f32_16x16x32_bf16 v[72:75], v[20:23], a[200:203], v[72:75]
    v_mfma_f32_16x16x32_bf16 v[76:79], v[20:23], a[204:207], v[76:79]
    ds_read_b128 v[20:23], v5 offset:9216
    v_mfma_f32_16x16x32_bf16 v[76:79], v[16:19], a[196:199], v[76:79]
    s_waitcnt lgkmcnt(5)
    ds_read_b128 v[16:19], v5 offset:7168
    v_mfma_f32_16x16x32_bf16 v[68:71], v[24:27], a[212:215], v[68:71]
    v_mfma_f32_16x16x32_bf16 v[68:71], v[28:31], a[220:223], v[68:71]
    v_mfma_f32_16x16x32_bf16 v[64:67], v[28:31], a[216:219], v[64:67]
    ds_read_b128 v[28:31], v5 offset:12288
    v_mfma_f32_16x16x32_bf16 v[64:67], v[24:27], a[208:211], v[64:67]
    s_waitcnt lgkmcnt(5)
    ds_read_b128 v[24:27], v5 offset:10240
    v_mfma_f32_16x16x32_bf16 v[72:75], v[208:211], a[208:211], v[72:75]
    v_mfma_f32_16x16x32_bf16 v[72:75], v[212:215], a[216:219], v[72:75]
    v_mfma_f32_16x16x32_bf16 v[76:79], v[212:215], a[220:223], v[76:79]
    ds_read_b128 v[212:215], v5 offset:13312
    v_mfma_f32_16x16x32_bf16 v[76:79], v[208:211], a[212:215], v[76:79]
    s_waitcnt lgkmcnt(5)
    ds_read_b128 v[208:211], v5 offset:11264
    v_mfma_f32_16x16x32_bf16 v[68:71], v[216:219], a[228:231], v[68:71]
    v_mfma_f32_16x16x32_bf16 v[68:71], v[220:223], a[236:239], v[68:71]
    v_mfma_f32_16x16x32_bf16 v[64:67], v[220:223], a[232:235], v[64:67]
    ds_read_b128 v[220:223], v5 offset:16384
    v_mfma_f32_16x16x32_bf16 v[64:67], v[216:219], a[224:227], v[64:67]
    s_waitcnt lgkmcnt(5)
    ds_read_b128 v[216:219], v5 offset:14336
    v_mfma_f32_16x16x32_bf16 v[72:75], v[16:19], a[224:227], v[72:75]
    v_mfma_f32_16x16x32_bf16 v[72:75], v[20:23], a[232:235], v[72:75]
    v_mfma_f32_16x16x32_bf16 v[76:79], v[20:23], a[236:239], v[76:79]
    ds_read_b128 v[20:23], v5 offset:17408
    v_mfma_f32_16x16x32_bf16 v[76:79], v[16:19], a[228:231], v[76:79]
    s_waitcnt lgkmcnt(5)
    ds_read_b128 v[16:19], v5 offset:15360
    v_mfma_f32_16x16x32_bf16 v[68:71], v[24:27], a[244:247], v[68:71]
    v_mfma_f32_16x16x32_bf16 v[68:71], v[28:31], a[252:255], v[68:71]
    v_mfma_f32_16x16x32_bf16 v[64:67], v[28:31], a[248:251], v[64:67]
    ds_read_b128 v[28:31], v5 offset:20480
    v_mfma_f32_16x16x32_bf16 v[64:67], v[24:27], a[240:243], v[64:67]
    s_waitcnt lgkmcnt(5)
    ds_read_b128 v[24:27], v5 offset:18432
    v_mfma_f32_16x16x32_bf16 v[72:75], v[208:211], a[240:243], v[72:75]
    s_add_u32 s51, s44, 1
    buffer_load_dword v9, v8, s[8:11], s30 offen sc1
    v_mfma_f32_16x16x32_bf16 v[72:75], v[212:215], a[248:251], v[72:75]
    v_mfma_f32_16x16x32_bf16 v[76:79], v[212:215], a[252:255], v[76:79]
    ds_read_b128 v[212:215], v5 offset:21504
    v_mfma_f32_16x16x32_bf16 v[76:79], v[208:211], a[244:247], v[76:79]
    s_waitcnt lgkmcnt(5)
    ds_read_b128 v[208:211], v5 offset:19456
    v_mfma_f32_16x16x32_bf16 v[68:71], v[216:219], v[228:231], v[68:71]
    v_mfma_f32_16x16x32_bf16 v[68:71], v[220:223], v[236:239], v[68:71]
    v_mfma_f32_16x16x32_bf16 v[64:67], v[220:223], v[232:235], v[64:67]
    ds_read_b128 v[220:223], v5 offset:24576
    v_mfma_f32_16x16x32_bf16 v[64:67], v[216:219], v[224:227], v[64:67]
    s_waitcnt lgkmcnt(5)
    ds_read_b128 v[216:219], v5 offset:22528
    v_mfma_f32_16x16x32_bf16 v[72:75], v[16:19], v[224:227], v[72:75]
    v_mfma_f32_16x16x32_bf16 v[72:75], v[20:23], v[232:235], v[72:75]
    v_mfma_f32_16x16x32_bf16 v[76:79], v[20:23], v[236:239], v[76:79]
    ds_read_b128 v[20:23], v5 offset:25600
    v_mfma_f32_16x16x32_bf16 v[76:79], v[16:19], v[228:231], v[76:79]
    s_waitcnt lgkmcnt(5)
    ds_read_b128 v[16:19], v5 offset:23552
    v_mfma_f32_16x16x32_bf16 v[68:71], v[24:27], v[244:247], v[68:71]
    v_mfma_f32_16x16x32_bf16 v[68:71], v[28:31], v[252:255], v[68:71]
    v_mfma_f32_16x16x32_bf16 v[64:67], v[28:31], v[248:251], v[64:67]
    ds_read_b128 v[28:31], v5 offset:28672
    v_mfma_f32_16x16x32_bf16 v[64:67], v[24:27], v[240:243], v[64:67]
    s_waitcnt lgkmcnt(5)
    ds_read_b128 v[24:27], v5 offset:26624
    v_mfma_f32_16x16x32_bf16 v[72:75], v[208:211], v[240:243], v[72:75]
    v_mfma_f32_16x16x32_bf16 v[72:75], v[212:215], v[248:251], v[72:75]
    v_mfma_f32_16x16x32_bf16 v[76:79], v[212:215], v[252:255], v[76:79]
    ds_read_b128 v[212:215], v5 offset:29696
    v_mfma_f32_16x16x32_bf16 v[76:79], v[208:211], v[244:247], v[76:79]
    s_waitcnt lgkmcnt(5)
    ds_read_b128 v[208:211], v5 offset:27648
    v_mfma_f32_16x16x32_bf16 v[68:71], v[216:219], v[100:103], v[68:71]
    v_mfma_f32_16x16x32_bf16 v[68:71], v[220:223], v[108:111], v[68:71]
    v_mfma_f32_16x16x32_bf16 v[64:67], v[220:223], v[104:107], v[64:67]
    ds_read_b128 v[220:223], v5 offset:32768
    v_mfma_f32_16x16x32_bf16 v[64:67], v[216:219], v[96:99], v[64:67]
    s_waitcnt lgkmcnt(5)
    ds_read_b128 v[216:219], v5 offset:30720
    v_mfma_f32_16x16x32_bf16 v[72:75], v[16:19], v[96:99], v[72:75]
    v_mfma_f32_16x16x32_bf16 v[72:75], v[20:23], v[104:107], v[72:75]
    v_mfma_f32_16x16x32_bf16 v[76:79], v[20:23], v[108:111], v[76:79]
    ds_read_b128 v[20:23], v5 offset:33792
    v_mfma_f32_16x16x32_bf16 v[76:79], v[16:19], v[100:103], v[76:79]
    s_waitcnt lgkmcnt(5)
    ds_read_b128 v[16:19], v5 offset:31744
    v_mfma_f32_16x16x32_bf16 v[68:71], v[24:27], v[116:119], v[68:71]
    v_mfma_f32_16x16x32_bf16 v[68:71], v[28:31], v[124:127], v[68:71]
    v_mfma_f32_16x16x32_bf16 v[64:67], v[28:31], v[120:123], v[64:67]
    s_waitcnt vmcnt(15)
    s_barrier
    ds_read_b128 v[28:31], v5 offset:36864
    v_mfma_f32_16x16x32_bf16 v[64:67], v[24:27], v[112:115], v[64:67]
    s_waitcnt lgkmcnt(5)
    ds_read_b128 v[24:27], v5 offset:34816
    v_mfma_f32_16x16x32_bf16 v[72:75], v[208:211], v[112:115], v[72:75]
    v_mfma_f32_16x16x32_bf16 v[72:75], v[212:215], v[120:123], v[72:75]
    v_mfma_f32_16x16x32_bf16 v[76:79], v[212:215], v[124:127], v[76:79]
    ds_read_b128 v[212:215], v5 offset:37888
    v_mfma_f32_16x16x32_bf16 v[76:79], v[208:211], v[116:119], v[76:79]
    s_waitcnt lgkmcnt(5)
    ds_read_b128 v[208:211], v5 offset:35840
    v_mfma_f32_16x16x32_bf16 v[68:71], v[216:219], v[36:39], v[68:71]
    v_mfma_f32_16x16x32_bf16 v[68:71], v[220:223], v[44:47], v[68:71]
    v_mfma_f32_16x16x32_bf16 v[64:67], v[220:223], v[40:43], v[64:67]
    ds_read_b128 v[220:223], v5 offset:40960
    v_mfma_f32_16x16x32_bf16 v[64:67], v[216:219], v[32:35], v[64:67]
    s_waitcnt lgkmcnt(5)
    ds_read_b128 v[216:219], v5 offset:38912
    v_mfma_f32_16x16x32_bf16 v[72:75], v[16:19], v[32:35], v[72:75]
    v_mfma_f32_16x16x32_bf16 v[72:75], v[20:23], v[40:43], v[72:75]
    v_mfma_f32_16x16x32_bf16 v[76:79], v[20:23], v[44:47], v[76:79]
    ds_read_b128 v[20:23], v5 offset:41984
    v_mfma_f32_16x16x32_bf16 v[76:79], v[16:19], v[36:39], v[76:79]
    s_waitcnt lgkmcnt(5)
    ds_read_b128 v[16:19], v5 offset:39936
    v_mfma_f32_16x16x32_bf16 v[84:87], v[24:27], a[4:7], 0
    v_mfma_f32_16x16x32_bf16 v[84:87], v[28:31], a[12:15], v[84:87]
    v_mfma_f32_16x16x32_bf16 v[80:83], v[28:31], a[8:11], 0
    ds_read_b128 v[28:31], v5 offset:45056
    v_cvt_pk_bf16_f32 v64, v64, v65
    v_mfma_f32_16x16x32_bf16 v[80:83], v[24:27], a[0:3], v[80:83]
    s_waitcnt lgkmcnt(5)
    ds_read_b128 v[24:27], v5 offset:43008
    v_cvt_pk_bf16_f32 v65, v66, v67
    v_mfma_f32_16x16x32_bf16 v[88:91], v[208:211], a[0:3], 0
    v_cvt_pk_bf16_f32 v66, v72, v73
    v_cvt_pk_bf16_f32 v67, v74, v75
    v_mfma_f32_16x16x32_bf16 v[88:91], v[212:215], a[8:11], v[88:91]
    buffer_store_dwordx4 v[64:67], v5, s[8:11], s22 offen offset:0 sc1
    v_cvt_pk_bf16_f32 v68, v68, v69
    v_mfma_f32_16x16x32_bf16 v[92:95], v[212:215], a[12:15], 0
    ds_read_b128 v[212:215], v5 offset:46080
    v_cvt_pk_bf16_f32 v69, v70, v71
    v_mfma_f32_16x16x32_bf16 v[92:95], v[208:211], a[4:7], v[92:95]
    s_waitcnt lgkmcnt(5)
    ds_read_b128 v[208:211], v5 offset:44032
    v_cvt_pk_bf16_f32 v70, v76, v77
    v_mfma_f32_16x16x32_bf16 v[84:87], v[216:219], a[20:23], v[84:87]
    v_cvt_pk_bf16_f32 v71, v78, v79
    v_mfma_f32_16x16x32_bf16 v[84:87], v[220:223], a[28:31], v[84:87]
    v_mfma_f32_16x16x32_bf16 v[80:83], v[220:223], a[24:27], v[80:83]
    ds_read_b128 v[220:223], v5 offset:49152
    v_mfma_f32_16x16x32_bf16 v[80:83], v[216:219], a[16:19], v[80:83]
    s_waitcnt lgkmcnt(5)
    ds_read_b128 v[216:219], v5 offset:47104
    buffer_store_dwordx4 v[68:71], v5, s[8:11], s22 offen offset:1024 sc1
    v_mfma_f32_16x16x32_bf16 v[88:91], v[16:19], a[16:19], v[88:91]
    s_add_u32 s28, s44, 2
    v_mov_b32 v15, s28
    v_mfma_f32_16x16x32_bf16 v[88:91], v[20:23], a[24:27], v[88:91]
    v_mfma_f32_16x16x32_bf16 v[92:95], v[20:23], a[28:31], v[92:95]
    ds_read_b128 v[20:23], v5 offset:50176
    v_mfma_f32_16x16x32_bf16 v[92:95], v[16:19], a[20:23], v[92:95]
    s_waitcnt lgkmcnt(5)
    ds_read_b128 v[16:19], v5 offset:48128
    v_mfma_f32_16x16x32_bf16 v[84:87], v[24:27], a[36:39], v[84:87]
    v_mfma_f32_16x16x32_bf16 v[84:87], v[28:31], a[44:47], v[84:87]
    v_mfma_f32_16x16x32_bf16 v[80:83], v[28:31], a[40:43], v[80:83]
    ds_read_b128 v[28:31], v5 offset:53248
    v_mfma_f32_16x16x32_bf16 v[80:83], v[24:27], a[32:35], v[80:83]
    s_waitcnt lgkmcnt(5)
    ds_read_b128 v[24:27], v5 offset:51200
    v_mfma_f32_16x16x32_bf16 v[88:91], v[208:211], a[32:35], v[88:91]
    v_mfma_f32_16x16x32_bf16 v[88:91], v[212:215], a[40:43], v[88:91]
    v_mfma_f32_16x16x32_bf16 v[92:95], v[212:215], a[44:47], v[92:95]
    ds_read_b128 v[212:215], v5 offset:54272
    v_mfma_f32_16x16x32_bf16 v[92:95], v[208:211], a[36:39], v[92:95]
    s_waitcnt lgkmcnt(5)
    ds_read_b128 v[208:211], v5 offset:52224
    v_mfma_f32_16x16x32_bf16 v[84:87], v[216:219], a[52:55], v[84:87]
    v_mfma_f32_16x16x32_bf16 v[84:87], v[220:223], a[60:63], v[84:87]
    v_mfma_f32_16x16x32_bf16 v[80:83], v[220:223], a[56:59], v[80:83]
    ds_read_b128 v[220:223], v5 offset:57344
    v_mfma_f32_16x16x32_bf16 v[80:83], v[216:219], a[48:51], v[80:83]
    s_waitcnt lgkmcnt(5)
    ds_read_b128 v[216:219], v5 offset:55296
    v_mfma_f32_16x16x32_bf16 v[88:91], v[16:19], a[48:51], v[88:91]
    v_mfma_f32_16x16x32_bf16 v[88:91], v[20:23], a[56:59], v[88:91]
    v_mfma_f32_16x16x32_bf16 v[92:95], v[20:23], a[60:63], v[92:95]
    ds_read_b128 v[20:23], v5 offset:58368
    v_mfma_f32_16x16x32_bf16 v[92:95], v[16:19], a[52:55], v[92:95]
    s_waitcnt lgkmcnt(5)
    ds_read_b128 v[16:19], v5 offset:56320
    v_mfma_f32_16x16x32_bf16 v[84:87], v[24:27], a[68:71], v[84:87]
    s_waitcnt vmcnt(2)
    v_subrev_u32 v9, s51, v9
    v_cmp_le_u32 vcc, 7, v9
    s_nop 0
    s_cbranch_vccnz LS_x1
LB_x1:
    v_mfma_f32_16x16x32_bf16 v[84:87], v[28:31], a[76:79], v[84:87]
    buffer_load_dwordx4 v[160:163], v5, s[8:11], s23 offen offset:0 sc1
    v_mfma_f32_16x16x32_bf16 v[80:83], v[28:31], a[72:75], v[80:83]
    ds_read_b128 v[28:31], v7 offset:24576
    v_mfma_f32_16x16x32_bf16 v[80:83], v[24:27], a[64:67], v[80:83]
    s_waitcnt lgkmcnt(5)
    ds_read_b128 v[24:27], v5 offset:59392
    v_mfma_f32_16x16x32_bf16 v[88:91], v[208:211], a[64:67], v[88:91]
    buffer_load_dwordx4 v[164:167], v5, s[8:11], s23 offen offset:1024 sc1
    v_mfma_f32_16x16x32_bf16 v[88:91], v[212:215], a[72:75], v[88:91]
    v_mfma_f32_16x16x32_bf16 v[92:95], v[212:215], a[76:79], v[92:95]
    ds_read_b128 v[212:215], v7 offset:25600
    v_mfma_f32_16x16x32_bf16 v[92:95], v[208:211], a[68:71], v[92:95]
    s_waitcnt lgkmcnt(5)
    ds_read_b128 v[208:211], v5 offset:60416
    v_mfma_f32_16x16x32_bf16 v[84:87], v[216:219], a[84:87], v[84:87]
    buffer_load_dwordx4 v[176:179], v5, s[8:11], s24 offen offset:0 sc1
    v_mfma_f32_16x16x32_bf16 v[84:87], v[220:223], a[92:95], v[84:87]
    v_mfma_f32_16x16x32_bf16 v[80:83], v[220:223], a[88:91], v[80:83]
    ds_read_b128 v[220:223], v7 offset:28672
    v_mfma_f32_16x16x32_bf16 v[80:83], v[216:219], a[80:83], v[80:83]
    s_waitcnt lgkmcnt(5)
    ds_read_b128 v[216:219], v7 offset:26624
    v_mfma_f32_16x16x32_bf16 v[88:91], v[16:19], a[80:83], v[88:91]
    buffer_load_dwordx4 v[180:183], v5, s[8:11], s24 offen offset:1024 sc1
    v_mfma_f32_16x16x32_bf16 v[88:91], v[20:23], a[88:91], v[88:91]
    v_mfma_f32_16x16x32_bf16 v[92:95], v[20:23], a[92:95], v[92:95]
    ds_read_b128 v[20:23], v7 offset:29696
    v_mfma_f32_16x16x32_bf16 v[92:95], v[16:19], a[84:87], v[92:95]
    s_waitcnt lgkmcnt(5)
    ds_read_b128 v[16:19], v7 offset:27648
    v_mfma_f32_16x16x32_bf16 v[84:87], v[24:27], a[100:103], v[84:87]
    buffer_load_dwordx2 v[192:193], v6, s[8:11], s37 offen sc1
    v_mfma_f32_16x16x32_bf16 v[84:87], v[28:31], a[108:111], v[84:87]
    v_mfma_f32_16x16x32_bf16 v[80:83], v[28:31], a[104:107], v[80:83]
    s_barrier
    ds_read_b128 v[28:31], v7 offset:32768
    v_mfma_f32_16x16x32_bf16 v[80:83], v[24:27], a[96:99], v[80:83]
    s_waitcnt lgkmcnt(5)
    ds_read_b128 v[24:27], v7 offset:30720
    v_mfma_f32_16x16x32_bf16 v[88:91], v[208:211], a[96:99], v[88:91]
    buffer_load_dwordx2 v[196:197], v6, s[8:11], s38 offen sc1
    v_mfma_f32_16x16x32_bf16 v[88:91], v[212:215], a[104:107], v[88:91]
    s_add_u32 s39, s32, 1
    s_and_b32 s39, s39, 3
    s_lshl_b32 s39, s39, 6
    v_mov_b32 v8, s39
    v_mfma_f32_16x16x32_bf16 v[92:95], v[212:215], a[108:111], v[92:95]
    ds_read_b128 v[212:215], v7 offset:33792
    v_mfma_f32_16x16x32_bf16 v[92:95], v[208:211], a[100:103], v[92:95]
    s_waitcnt lgkmcnt(5)
    ds_read_b128 v[208:211], v7 offset:31744
    v_mfma_f32_16x16x32_bf16 v[84:87], v[216:219], a[116:119], v[84:87]
    v_mfma_f32_16x16x32_bf16 v[84:87], v[220:223], a[124:127], v[84:87]
    v_mfma_f32_16x16x32_bf16 v[80:83], v[220:223], a[120:123], v[80:83]
    ds_read_b128 v[220:223], v7 offset:36864
    v_mfma_f32_16x16x32_bf16 v[80:83], v[216:219], a[112:115], v[80:83]
    s_waitcnt lgkmcnt(5)
    ds_read_b128 v[216:219], v7 offset:34816
    v_mfma_f32_16x16x32_bf16 v[88:91], v[16:19], a[112:115], v[88:91]
    v_mfma_f32_16x16x32_bf16 v[88:91], v[20:23], a[120:123], v[88:91]
    v_mfma_f32_16x16x32_bf16 v[92:95], v[20:23], a[124:127], v[92:95]
    ds_read_b128 v[20:23], v7 offset:37888
    v_mfma_f32_16x16x32_bf16 v[92:95], v[16:19], a[116:119], v[92:95]
    s_waitcnt lgkmcnt(5)
    ds_read_b128 v[16:19], v7 offset:35840
    v_mfma_f32_16x16x32_bf16 v[84:87], v[24:27], a[132:135], v[84:87]
    v_mfma_f32_16x16x32_bf16 v[84:87], v[28:31], a[140:143], v[84:87]
    v_mfma_f32_16x16x32_bf16 v[80:83], v[28:31], a[136:139], v[80:83]
    ds_read_b128 v[28:31], v7 offset:40960
    v_mfma_f32_16x16x32_bf16 v[80:83], v[24:27], a[128:131], v[80:83]
    s_waitcnt lgkmcnt(5)
    ds_read_b128 v[24:27], v7 offset:38912
    v_mfma_f32_16x16x32_bf16 v[88:91], v[208:211], a[128:131], v[88:91]
    v_mfma_f32_16x16x32_bf16 v[88:91], v[212:215], a[136:139], v[88:91]
    v_mfma_f32_16x16x32_bf16 v[92:95], v[212:215], a[140:143], v[92:95]
    ds_read_b128 v[212:215], v7 offset:41984
    v_mfma_f32_16x16x32_bf16 v[92:95], v[208:211], a[132:135], v[92:95]
    s_waitcnt lgkmcnt(5)
    ds_read_b128 v[208:211], v7 offset:39936
    v_mfma_f32_16x16x32_bf16 v[84:87], v[216:219], a[148:151], v[84:87]
    v_mfma_f32_16x16x32_bf16 v[84:87], v[220:223], a[156:159], v[84:87]
    v_mfma_f32_16x16x32_bf16 v[80:83], v[220:223], a[152:155], v[80:83]
    s_waitcnt vmcnt(6)
    ds_read_b128 v[220:223], v7 offset:45056
    buffer_store_dword v15, off, s[8:11], s31 sc1
    v_mfma_f32_16x16x32_bf16 v[80:83], v[216:219], a[144:147], v[80:83]
    s_waitcnt lgkmcnt(5)
    ds_read_b128 v[216:219], v7 offset:43008
    v_mfma_f32_16x16x32_bf16 v[88:91], v[16:19], a[144:147], v[88:91]
    v_mfma_f32_16x16x32_bf16 v[88:91], v[20:23], a[152:155], v[88:91]
    v_mfma_f32_16x16x32_bf16 v[92:95], v[20:23], a[156:159], v[92:95]
    ds_read_b128 v[20:23], v7 offset:46080
    v_mfma_f32_16x16x32_bf16 v[92:95], v[16:19], a[148:151], v[92:95]
    s_waitcnt lgkmcnt(5)
    ds_read_b128 v[16:19], v7 offset:44032
    v_mfma_f32_16x16x32_bf16 v[84:87], v[24:27], a[164:167], v[84:87]
    v_mfma_f32_16x16x32_bf16 v[84:87], v[28:31], a[172:175], v[84:87]
    v_mfma_f32_16x16x32_bf16 v[80:83], v[28:31], a[168:171], v[80:83]
    ds_read_b128 v[28:31], v7 offset:49152
    v_mfma_f32_16x16x32_bf16 v[80:83], v[24:27], a[160:163], v[80:83]
    s_waitcnt lgkmcnt(5)
    ds_read_b128 v[24:27], v7 offset:47104
    v_mfma_f32_16x16x32_bf16 v[88:91], v[208:211], a[160:163], v[88:91]
    v_mfma_f32_16x16x32_bf16 v[88:91], v[212:215], a[168:171], v[88:91]
    v_mfma_f32_16x16x32_bf16 v[92:95], v[212:215], a[172:175], v[92:95]
    ds_read_b128 v[212:215], v7 offset:50176
    v_mfma_f32_16x16x32_bf16 v[92:95], v[208:211], a[164:167], v[92:95]
    s_waitcnt lgkmcnt(5)
    ds_read_b128 v[208:211], v7 offset:48128
    v_mfma_f32_16x16x32_bf16 v[84:87], v[216:219], a[180:183], v[84:87]
    s_add_u32 s51, s44, 2
    buffer_load_dword v9, v8, s[8:11], s30 offen sc1
    v_mfma_f32_16x16x32_bf16 v[84:87], v[220:223], a[188:191], v[84:87]
    v_mfma_f32_16x16x32_bf16 v[80:83], v[220:223], a[184:187], v[80:83]
    ds_read_b128 v[220:223], v7 offset:53248
    v_mfma_f32_16x16x32_bf16 v[80:83], v[216:219], a[176:179], v[80:83]
    s_waitcnt lgkmcnt(5)
    ds_read_b128 v[216:219], v7 offset:51200
    v_mfma_f32_16x16x32_bf16 v[88:91], v[16:19], a[176:179], v[88:91]
    v_mfma_f32_16x16x32_bf16 v[88:91], v[20:23], a[184:187], v[88:91]
    v_mfma_f32_16x16x32_bf16 v[92:95], v[20:23], a[188:191], v[92:95]
    ds_read_b128 v[20:23], v7 offset:54272
    v_mfma_f32_16x16x32_bf16 v[92:95], v[16:19], a[180:183], v[92:95]
    s_waitcnt lgkmcnt(5)
    ds_read_b128 v[16:19], v7 offset:52224
    v_mfma_f32_16x16x32_bf16 v[84:87], v[24:27], a[196:199], v[84:87]
    s_waitcnt vmcnt(7)
    v_lshlrev_b32 v1, 16, v160
    v_mfma_f32_16x16x32_bf16 v[84:87], v[28:31], a[204:207], v[84:87]
    v_and_b32 v2, s47, v160
    v_mfma_f32_16x16x32_bf16 v[80:83], v[28:31], a[200:203], v[80:83]
    ds_read_b128 v[28:31], v7 offset:57344
    v_add_f32 v168, v168, v1
    v_mfma_f32_16x16x32_bf16 v[80:83], v[24:27], a[192:195], v[80:83]
    s_waitcnt lgkmcnt(5)
    ds_read_b128 v[24:27], v7 offset:55296
    v_add_f32 v169, v169, v2
    v_mfma_f32_16x16x32_bf16 v[88:91], v[208:211], a[192:195], v[88:91]
    v_lshlrev_b32 v1, 16, v161
    v_mfma_f32_16x16x32_bf16 v[88:91], v[212:215], a[200:203], v[88:91]
    v_and_b32 v2, s47, v161
    v_mfma_f32_16x16x32_bf16 v[92:95], v[212:215], a[204:207], v[92:95]
    ds_read_b128 v[212:215], v7 offset:58368
    v_add_f32 v170, v170, v1
    v_mfma_f32_16x16x32_bf16 v[92:95], v[208:211], a[196:199], v[92:95]
    s_waitcnt lgkmcnt(5)
    ds_read_b128 v[208:211], v7 offset:56320
    v_add_f32 v171, v171, v2
    v_mfma_f32_16x16x32_bf16 v[84:87], v[216:219], a[212:215], v[84:87]
    v_lshlrev_b32 v1, 16, v162
    v_mfma_f32_16x16x32_bf16 v[84:87], v[220:223], a[220:223], v[84:87]
    v_and_b32 v2, s47, v162
    v_mfma_f32_16x16x32_bf16 v[80:83], v[220:223], a[216:219], v[80:83]
    ds_read_b128 v[220:223], v7 offset:61440
    v_add_f32 v172, v172, v1
    v_mfma_f32_16x16x32_bf16 v[80:83], v[216:219], a[208:211], v[80:83]
    s_waitcnt lgkmcnt(5)
    ds_read_b128 v[216:219], v7 offset:59392
    v_add_f32 v173, v173, v2
    v_mfma_f32_16x16x32_bf16 v[88:91], v[16:19], a[208:211], v[88:91]
    v_lshlrev_b32 v1, 16, v163
    v_mfma_f32_16x16x32_bf16 v[88:91], v[20:23], a[216:219], v[88:91]
    v_and_b32 v2, s47, v163
    v_mfma_f32_16x16x32_bf16 v[92:95], v[20:23], a[220:223], v[92:95]
    ds_read_b128 v[20:23], v7 offset:62464
    v_add_f32 v174, v174, v1
    v_mfma_f32_16x16x32_bf16 v[92:95], v[16:19], a[212:215], v[92:95]
    s_waitcnt lgkmcnt(5)
    ds_read_b128 v[16:19], v7 offset:60416
    v_add_f32 v175, v175, v2
    v_mfma_f32_16x16x32_bf16 v[84:87], v[24:27], a[228:231], v[84:87]
    s_waitcnt vmcnt(6)
    v_lshlrev_b32 v1, 16, v164
    v_mfma_f32_16x16x32_bf16 v[84:87], v[28:31], a[236:239], v[84:87]
    v_and_b32 v2, s47, v164
    v_mfma_f32_16x16x32_bf16 v[80:83], v[28:31], a[232:235], v[80:83]
    s_barrier
    ds_read_b128 v[28:31], v12 offset:0
    v_mfma_f32_16x16x32_bf16 v[80:83], v[24:27], a[224:227], v[80:83]
    s_waitcnt lgkmcnt(5)
    ds_read_b128 v[24:27], v7 offset:63488
    v_add_f32 v184, v184, v1
    v_mfma_f32_16x16x32_bf16 v[88:91], v[208:211], a[224:227], v[88:91]
    v_add_f32 v185, v185, v2
    v_mfma_f32_16x16x32_bf16 v[88:91], v[212:215], a[232:235], v[88:91]
    v_lshlrev_b32 v1, 16, v165
    v_mfma_f32_16x16x32_bf16 v[92:95], v[212:215], a[236:239], v[92:95]
    ds_read_b128 v[212:215], v12 offset:1024
    v_and_b32 v2, s47, v165
    v_mfma_f32_16x16x32_bf16 v[92:95], v[208:211], a[228:231], v[92:95]
    s_waitcnt lgkmcnt(5)
    ds_read_b128 v[208:211], v7 offset:64512
    v_add_f32 v186, v186, v1
    v_mfma_f32_16x16x32_bf16 v[84:87], v[216:219], a[244:247], v[84:87]
    v_add_f32 v187, v187, v2
    v_mfma_f32_16x16x32_bf16 v[84:87], v[220:223], a[252:255], v[84:87]
    v_lshlrev_b32 v1, 16, v166
    v_mfma_f32_16x16x32_bf16 v[80:83], v[220:223], a[248:251], v[80:83]
    ds_read_b128 v[220:223], v12 offset:4096
    v_and_b32 v2, s47, v166
    v_mfma_f32_16x16x32_bf16 v[80:83], v[216:219], a[240:243], v[80:83]
    s_waitcnt lgkmcnt(5)
    ds_read_b128 v[216:219], v12 offset:2048
    v_add_f32 v188, v188, v1
    v_mfma_f32_16x16x32_bf16 v[88:91], v[16:19], a[240:243], v[88:91]
    v_add_f32 v189, v189, v2
    v_mfma_f32_16x16x32_bf16 v[88:91], v[20:23], a[248:251], v[88:91]
    v_lshlrev_b32 v1, 16, v167
    v_mfma_f32_16x16x32_bf16 v[92:95], v[20:23], a[252:255], v[92:95]
    ds_read_b128 v[20:23], v12 offset:5120
    v_and_b32 v2, s47, v167
    v_mfma_f32_16x16x32_bf16 v[92:95], v[16:19], a[244:247], v[92:95]
    s_waitcnt lgkmcnt(5)
    ds_read_b128 v[16:19], v12 offset:3072
    v_add_f32 v190, v190, v1
    v_mfma_f32_16x16x32_bf16 v[84:87], v[24:27], v[228:231], v[84:87]
    v_add_f32 v191, v191, v2
    v_mfma_f32_16x16x32_bf16 v[84:87], v[28:31], v[236:239], v[84:87]
    s_waitcnt vmcnt(5)
    v_lshlrev_b32 v1, 16, v176
    v_mfma_f32_16x16x32_bf16 v[80:83], v[28:31], v[232:235], v[80:83]
    ds_read_b128 v[28:31], v12 offset:8192
    v_and_b32 v2, s47, v176
    v_mfma_f32_16x16x32_bf16 v[80:83], v[24:27], v[224:227], v[80:83]
    s_waitcnt lgkmcnt(5)
    ds_read_b128 v[24:27], v12 offset:6144
    v_add_f32 v168, v168, v1
    v_mfma_f32_16x16x32_bf16 v[88:91], v[208:211], v[224:227], v[88:91]
    s_waitcnt vmcnt(0)
    v_subrev_u32 v9, s51, v9
    v_cmp_le_u32 vcc, 6, v9
    s_nop 0
    s_cbranch_vccnz LS_x2
LB_x2:
    v_mfma_f32_16x16x32_bf16 v[88:91], v[212:215], v[232:235], v[88:91]
    buffer_load_dwordx4 v[48:51], v5, s[8:11], s25 offen offset:0 sc1
    v_add_f32 v169, v169, v2
    v_mfma_f32_16x16x32_bf16 v[92:95], v[212:215], v[236:239], v[92:95]
    ds_read_b128 v[212:215], v12 offset:9216
    v_lshlrev_b32 v1, 16, v177
    v_mfma_f32_16x16x32_bf16 v[92:95], v[208:211], v[228:231], v[92:95]
    s_waitcnt lgkmcnt(5)
    ds_read_b128 v[208:211], v12 offset:7168
    v_and_b32 v2, s47, v177
    v_mfma_f32_16x16x32_bf16 v[84:87], v[216:219], v[244:247], v[84:87]
    buffer_load_dwordx4 v[52:55], v5, s[8:11], s25 offen offset:1024 sc1
    v_add_f32 v170, v170, v1
    v_mfma_f32_16x16x32_bf16 v[84:87], v[220:223], v[252:255], v[84:87]
    v_add_f32 v171, v171, v2
    v_mfma_f32_16x16x32_bf16 v[80:83], v[220:223], v[248:251], v[80:83]
    ds_read_b128 v[220:223], v12 offset:12288
    v_lshlrev_b32 v1, 16, v178
    v_mfma_f32_16x16x32_bf16 v[80:83], v[216:219], v[240:243], v[80:83]
    s_waitcnt lgkmcnt(5)
    ds_read_b128 v[216:219], v12 offset:10240
    v_and_b32 v2, s47, v178
    v_mfma_f32_16x16x32_bf16 v[88:91], v[16:19], v[240:243], v[88:91]
    v_add_f32 v172, v172, v1
    v_mfma_f32_16x16x32_bf16 v[88:91], v[20:23], v[248:251], v[88:91]
    v_add_f32 v173, v173, v2
    v_mfma_f32_16x16x32_bf16 v[92:95], v[20:23], v[252:255], v[92:95]
    ds_read_b128 v[20:23], v12 offset:13312
    v_lshlrev_b32 v1, 16, v179
    v_mfma_f32_16x16x32_bf16 v[92:95], v[16:19], v[244:247], v[92:95]
    s_waitcnt lgkmcnt(5)
    ds_read_b128 v[16:19], v12 offset:11264
    v_and_b32 v2, s47, v179
    v_mfma_f32_16x16x32_bf16 v[84:87], v[24:27], v[100:103], v[84:87]
    v_add_f32 v174, v174, v1
    v_mfma_f32_16x16x32_bf16 v[84:87], v[28:31], v[108:111], v[84:87]
    v_add_f32 v175, v175, v2
    v_mfma_f32_16x16x32_bf16 v[80:83], v[28:31], v[104:107], v[80:83]
    ds_read_b128 v[28:31], v12 offset:16384
    v_lshlrev_b32 v1, 16, v180
    v_mfma_f32_16x16x32_bf16 v[80:83], v[24:27], v[96:99], v[80:83]
    s_waitcnt lgkmcnt(5)
    ds_read_b128 v[24:27], v12 offset:14336
    v_and_b32 v2, s47, v180
    v_mfma_f32_16x16x32_bf16 v[88:91], v[208:211], v[96:99], v[88:91]
    v_add_f32 v184, v184, v1
    v_mfma_f32_16x16x32_bf16 v[88:91], v[212:215], v[104:107], v[88:91]
    v_add_f32 v185, v185, v2
    v_mfma_f32_16x16x32_bf16 v[92:95], v[212:215], v[108:111], v[92:95]
    ds_read_b128 v[212:215], v12 offset:17408
    v_lshlrev_b32 v1, 16, v181
    v_mfma_f32_16x16x32_bf16 v[92:95], v[208:211], v[100:103], v[92:95]
    s_waitcnt lgkmcnt(5)
    ds_read_b128 v[208:211], v12 offset:15360
    v_and_b32 v2, s47, v181
    v_mfma_f32_16x16x32_bf16 v[84:87], v[216:219], v[116:119], v[84:87]
    v_add_f32 v186, v186, v1
    v_mfma_f32_16x16x32_bf16 v[84:87], v[220:223], v[124:127], v[84:87]
    v_add_f32 v187, v187, v2
    v_mfma_f32_16x16x32_bf16 v[80:83], v[220:223], v[120:123], v[80:83]
    v_lshlrev_b32 v1, 16, v182
    v_mfma_f32_16x16x32_bf16 v[80:83], v[216:219], v[112:115], v[80:83]
    s_waitcnt lgkmcnt(4)
    v_and_b32 v2, s47, v182
    v_mfma_f32_16x16x32_bf16 v[88:91], v[16:19], v[112:115], v[88:91]
    v_add_f32 v188, v188, v1
    v_mfma_f32_16x16x32_bf16 v[88:91], v[20:23], v[120:123], v[88:91]
    v_add_f32 v189, v189, v2
    v_mfma_f32_16x16x32_bf16 v[92:95], v[20:23], v[124:127], v[92:95]
    v_lshlrev_b32 v1, 16, v183
    v_mfma_f32_16x16x32_bf16 v[92:95], v[16:19], v[116:119], v[92:95]
    s_waitcnt lgkmcnt(2)
    v_and_b32 v2, s47, v183
    v_mfma_f32_16x16x32_bf16 v[84:87], v[24:27], v[36:39], v[84:87]
    v_add_f32 v190, v190, v1
    v_mfma_f32_16x16x32_bf16 v[84:87], v[28:31], v[44:47], v[84:87]
    v_add_f32 v191, v191, v2
    v_mfma_f32_16x16x32_bf16 v[80:83], v[28:31], v[40:43], v[80:83]
    v_and_b32 v195, s47, v193
    v_mfma_f32_16x16x32_bf16 v[80:83], v[24:27], v[32:35], v[80:83]
    s_waitcnt lgkmcnt(0)
    v_lshlrev_b32 v194, 16, v193
    v_mfma_f32_16x16x32_bf16 v[88:91], v[208:211], v[32:35], v[88:91]
    v_and_b32 v193, s47, v192
    v_mfma_f32_16x16x32_bf16 v[88:91], v[212:215], v[40:43], v[88:91]
    v_lshlrev_b32 v192, 16, v192
    v_mfma_f32_16x16x32_bf16 v[92:95], v[212:215], v[44:47], v[92:95]
    v_and_b32 v199, s47, v197
    v_mfma_f32_16x16x32_bf16 v[92:95], v[208:211], v[36:39], v[92:95]
    v_lshlrev_b32 v198, 16, v197
    v_and_b32 v197, s47, v196
    v_lshlrev_b32 v196, 16, v196
    v_add_f32 v192, v192, v196
    v_add_f32 v193, v193, v197
    v_add_f32 v194, v194, v198
    v_add_f32 v195, v195, v199
    v_mov_b32 v196, v192
    v_mov_b32 v197, v193
    v_mov_b32 v198, v194
    v_mov_b32 v199, v195
    v_permlane32_swap_b32 v192, v196
    v_permlane32_swap_b32 v193, v197
    v_permlane32_swap_b32 v194, v198
    v_permlane32_swap_b32 v195, v199
    v_add_f32 v192, v192, v196
    v_add_f32 v193, v193, v197
    v_add_f32 v194, v194, v198
    v_add_f32 v195, v195, v199
    v_lshlrev_b32 v1, 16, v10
    v_and_b32 v2, s47, v10
    v_add_f32 v192, v192, v1
    v_add_f32 v193, v193, v2
    v_cvt_pk_bf16_f32 v196, v192, v193
    v_lshlrev_b32 v1, 16, v11
    v_and_b32 v2, s47, v11
    v_add_f32 v194, v194, v1
    v_add_f32 v195, v195, v2
    v_cvt_pk_bf16_f32 v197, v194, v195
    buffer_store_dwordx2 v[196:197], v13, s[52:55], s35 offen
    v_add_f32 v80, v80, v168
    v_add_f32 v81, v81, v169
    v_add_f32 v82, v82, v170
    v_add_f32 v83, v83, v171
    v_add_f32 v88, v88, v172
    v_add_f32 v89, v89, v173
    v_add_f32 v90, v90, v174
    v_add_f32 v91, v91, v175
    v_add_f32 v84, v84, v184
    v_add_f32 v85, v85, v185
    v_add_f32 v86, v86, v186
    v_add_f32 v87, v87, v187
    v_add_f32 v92, v92, v188
    v_add_f32 v93, v93, v189
    v_add_f32 v94, v94, v190
    v_add_f32 v95, v95, v191
    s_waitcnt vmcnt(2)
    v_lshlrev_b32 v1, 16, v48
    v_and_b32 v2, s47, v48
    v_add_f32 v80, v80, v1
    v_add_f32 v81, v81, v2
    v_cvt_pk_bf16_f32 v200, v80, v81
    v_lshlrev_b32 v1, 16, v49
    v_and_b32 v2, s47, v49
    v_add_f32 v82, v82, v1
    v_add_f32 v83, v83, v2
    v_cvt_pk_bf16_f32 v201, v82, v83
    v_lshlrev_b32 v1, 16, v50
    v_and_b32 v2, s47, v50
    v_add_f32 v88, v88, v1
    v_add_f32 v89, v89, v2
    v_cvt_pk_bf16_f32 v202, v88, v89
    v_lshlrev_b32 v1, 16, v51
    v_and_b32 v2, s47, v51
    v_add_f32 v90, v90, v1
    v_add_f32 v91, v91, v2
    v_cvt_pk_bf16_f32 v203, v90, v91
    buffer_store_dwordx4 v[200:203], v3, s[52:55], s34 offen
    s_waitcnt vmcnt(2)
    v_lshlrev_b32 v1, 16, v52
    v_and_b32 v2, s47, v52
    v_add_f32 v84, v84, v1
    v_add_f32 v85, v85, v2
    v_cvt_pk_bf16_f32 v204, v84, v85
    v_lshlrev_b32 v1, 16, v53
    v_and_b32 v2, s47, v53
    v_add_f32 v86, v86, v1
    v_add_f32 v87, v87, v2
    v_cvt_pk_bf16_f32 v205, v86, v87
    v_lshlrev_b32 v1, 16, v54
    v_and_b32 v2, s47, v54
    v_add_f32 v92, v92, v1
    v_add_f32 v93, v93, v2
    v_cvt_pk_bf16_f32 v206, v92, v93
    v_lshlrev_b32 v1, 16, v55
    v_and_b32 v2, s47, v55
    v_add_f32 v94, v94, v1
    v_add_f32 v95, v95, v2
    v_cvt_pk_bf16_f32 v207, v94, v95
    buffer_store_dwordx4 v[204:207], v3, s[52:55], s68 offen
LF_end:
    s_endpgm
    s_waitcnt vmcnt(0) lgkmcnt(0)
LS_q:
    s_mov_b32 s28, 0
LL_q:
    buffer_load_dwordx2 v[210:211], v206, s[8:11], 0 offen sc1
    s_add_u32 s28, s28, 1
    s_cmp_gt_u32 s28, 0x80000
    s_waitcnt vmcnt(0)
    s_cbranch_scc1 LB_q
    v_cmp_ne_u64 vcc, s[44:45], v[210:211]
    s_nop 0
    s_cbranch_vccnz LL_q
    s_branch LB_q
LS_w:
    s_mov_b32 s28, 0
LL_w:
    buffer_load_dword v9, v8, s[8:11], 0 offen sc1
    s_add_u32 s28, s28, 1
    s_cmp_gt_u32 s28, 0x80000
    s_waitcnt vmcnt(0)
    s_cbranch_scc1 LB_w
    v_subrev_u32 v9, s51, v9
    v_cmp_le_u32 vcc, 7, v9
    s_nop 0
    s_cbranch_vccnz LL_w
    s_branch LB_w
LS_e:
    s_mov_b32 s28, 0
LL_e:
    buffer_load_dword v9, v8, s[8:11], s82 offen sc1
    s_add_u32 s28, s28, 1
    s_cmp_gt_u32 s28, 0x80000
    s_waitcnt vmcnt(0)
    s_cbranch_scc1 LB_e
    v_subrev_u32 v9, s51, v9
    v_cmp_le_u32 vcc, 7, v9
    s_nop 0
    s_and_b64 vcc, vcc, s[84:85]
    s_cbranch_vccnz LL_e
    s_branch LB_e
LS_h1:
    s_mov_b32 s28, 0
LL_h1:
    buffer_load_dword v9, v8, s[8:11], s67 offen sc1
    s_add_u32 s28, s28, 1
    s_cmp_gt_u32 s28, 0x80000
    s_waitcnt vmcnt(0)
    s_cbranch_scc1 LB_h1
    v_subrev_u32 v9, s51, v9
    v_cmp_le_u32 vcc, 6, v9
    s_nop 0
    s_cbranch_vccnz LL_h1
    s_branch LB_h1
LS_h2:
    s_mov_b32 s28, 0
LL_h2:
    buffer_load_dword v9, v8, s[8:11], s67 offen sc1
    s_add_u32 s28, s28, 1
    s_cmp_gt_u32 s28, 0x80000
    s_waitcnt vmcnt(0)
    s_cbranch_scc1 LB_h2
    v_subrev_u32 v9, s51, v9
    v_cmp_le_u32 vcc, 4, v9
    s_nop 0
    s_cbranch_vccnz LL_h2
    s_branch LB_h2
LS_x1:
    s_mov_b32 s28, 0
LL_x1:
    buffer_load_dword v9, v8, s[8:11], s30 offen sc1
    s_add_u32 s28, s28, 1
    s_cmp_gt_u32 s28, 0x80000
    s_waitcnt vmcnt(0)
    s_cbranch_scc1 LB_x1
    v_subrev_u32 v9, s51, v9
    v_cmp_le_u32 vcc, 7, v9
    s_nop 0
    s_cbranch_vccnz LL_x1
    s_branch LB_x1
LS_x2:
    s_mov_b32 s28, 0
LL_x2:
    buffer_load_dword v9, v8, s[8:11], s30 offen sc1
    s_add_u32 s28, s28, 1
    s_cmp_gt_u32 s28, 0x80000
    s_waitcnt vmcnt(0)
    s_cbranch_scc1 LB_x2
    v_subrev_u32 v9, s51, v9
    v_cmp_le_u32 vcc, 6, v9
    s_nop 0
    s_cbranch_vccnz LL_x2
    s_branch LB_x2
LF_codeend:
.section .rodata,"a"
.p2align 6
.amdhsa_kernel parallel_sum__sliding_local_dilated__glu_gated_swiglu__prompt_kernel
  .amdhsa_next_free_vgpr 512
  .amdhsa_next_free_sgpr 102
  .amdhsa_accum_offset 256
  .amdhsa_group_segment_fixed_size 0
  .amdhsa_kernarg_size 80
  .amdhsa_user_sgpr_count 2
  .amdhsa_user_sgpr_kernarg_segment_ptr 1
  .amdhsa_system_sgpr_workgroup_id_x 1
.end_amdhsa_kernel
```
